```python
import torch

def _softmax(x, axis=-1):
    return torch.softmax(x, dim=axis)
def _gelu(x):
    return torch.nn.functional.gelu(x, approximate="tanh")
def _silu(x):
    return torch.nn.functional.silu(x)
def _sigmoid(x):
    return torch.sigmoid(x)
def _layernorm(x, axis=-1, eps=1e-5):
    m = x.mean(dim=axis, keepdim=True)
    v = x.var(dim=axis, keepdim=True, unbiased=False)
    return (x - m) / torch.sqrt(v + eps)
def _scatter_add(tgt, idx, src, axis=0):
    return tgt.clone().index_add_(axis, idx, src)
def _segment_sum(src, seg, n):
    out = torch.zeros((n,) + src.shape[1:], dtype=src.dtype)
    return out.index_add_(0, seg, src)
def _pad(x, pw):
    flat = tuple(v for pair in reversed(pw) for v in pair)
    return torch.nn.functional.pad(x, flat)

kernel_name = 'parallel_sum__linear_kernel_hedgehog__dense_activation_mish__prompt'

def setup_inputs():

    _w = (lambda a: (lambda t: t.to(torch.bfloat16) if t.is_floating_point() else t)(torch.as_tensor(a)))
    def _A_setup():
        B, S, D, H = 1, 2048, 640, 32
        Dh = D // H
        return {
            "x": _w((lambda *s: torch.randn(*s, dtype=torch.bfloat16) * 0.05)(B, S, D)),
            "wqkv": _w((lambda *s: torch.randn(*s, dtype=torch.bfloat16) * 0.2)(D, 3 * D)),
            "w_phi": _w((lambda *s: torch.randn(*s, dtype=torch.bfloat16) * 0.2)(H, Dh, Dh) * (Dh ** -0.5)),
            "wo": _w((lambda *s: torch.randn(*s, dtype=torch.bfloat16) * 0.05)(D, D)),
        }
    _A_in = _A_setup()

    def _B_setup():
        B, S, D, F = 1, 2048, 640, 1728
        return {
            "x": _w((lambda *s: torch.randn(*s, dtype=torch.bfloat16) * 0.05)(B, S, D)),
            "w1": _w((lambda *s: torch.randn(*s, dtype=torch.bfloat16) * 0.8)(D, F) * (D ** -0.5)),
            "b1": _w((lambda *s: torch.randn(*s, dtype=torch.bfloat16) * 0.4)(F)),
            "w2": _w((lambda *s: torch.randn(*s, dtype=torch.bfloat16) * 0.1)(F, D) * (F ** -0.5)),
        }
    _B_in = _B_setup()

    return {
        "A_x": _A_in["x"],
        "A_wqkv": _A_in["wqkv"],
        "A_w_phi": _A_in["w_phi"],
        "A_wo": _A_in["wo"],
        "B_x": _B_in["x"],
        "B_w1": _B_in["w1"],
        "B_b1": _B_in["b1"],
        "B_w2": _B_in["w2"],
    }

def reference(A_x, A_wqkv, A_w_phi, A_wo, B_x, B_w1, B_b1, B_w2):
    def _A_ref(x, wqkv, w_phi, wo):
        B, S, D = x.shape
        H = 32; Dh = D // H
        qkv = (lambda x, *d: x.permute(*d))((x @ wqkv).reshape(B, S, 3, H, Dh), 2, 0, 3, 1, 4)
        q, k, v = qkv[0], qkv[1], qkv[2]
        pq = torch.einsum("bhsd,hdf->bhsf", q, w_phi)
        pk = torch.einsum("bhsd,hdf->bhsf", k, w_phi)
        phi_q = torch.concatenate([_softmax(pq, axis=-1), _softmax(-pq, axis=-1)], axis=-1)
        phi_k = torch.concatenate([_softmax(pk, axis=-1), _softmax(-pk, axis=-1)], axis=-1)
        kv = torch.einsum("bhsf,bhsd->bhfd", phi_k, v)
        z  = torch.einsum("bhsf->bhf", phi_k)
        num = torch.einsum("bhqf,bhfd->bhqd", phi_q, kv)
        den = torch.einsum("bhqf,bhf->bhq", phi_q, z)[..., None] + 1e-6
        o = num / den
        return (lambda x, *d: x.permute(*d))(o, 0, 2, 1, 3).reshape(B, S, D) @ wo

    def _B_ref(x, w1, b1, w2):
        h = torch.einsum("bsd,df->bsf", x, w1) + b1
        sp = torch.log1p(torch.exp(-torch.abs(h))) + torch.where(h > 0, h, torch.zeros_like(h))
        act = h * torch.tanh(sp)
        return torch.einsum("bsf,fd->bsd", act, w2)

    x = A_x
    xn = _layernorm(x, axis=-1)
    return x + _A_ref(xn, A_wqkv, A_w_phi, A_wo) + _B_ref(xn, B_w1, B_b1, B_w2)
```

```asm
; @launch grid=(256,1,1) block=(256,1,1) lds=163840
.amdgcn_target "amdgcn-amd-amdhsa--gfx950"
.text
.globl parallel_sum__linear_kernel_hedgehog__dense_activation_mish__prompt_kernel
.p2align 8
.type parallel_sum__linear_kernel_hedgehog__dense_activation_mish__prompt_kernel,@function
parallel_sum__linear_kernel_hedgehog__dense_activation_mish__prompt_kernel:
f_start:
  s_getpc_b64 s[68:69]
  s_cmp_ge_u32 s2, 256
  s_cbranch_scc1 f_end
  s_xor_b32 s2, s2, 128
  s_load_dwordx16 s[4:19], s[0:1], 0
  s_load_dwordx2 s[20:21], s[0:1], 80
  s_load_dwordx2 s[22:23], s[0:1], 64
  s_bfe_u32 s70, s2, 0x30003
  s_lshl_b32 s70, s70, 13
  v_lshrrev_b32 v1, 6, v0
  v_and_b32 v2, 15, v0
  v_lshl_add_u32 v2, v1, 4, v2
  v_lshl_add_u32 v2, v2, 7, s70
  v_min_u32 v2, f_end-f_start-8, v2
  v_mov_b32 v3, s69
  v_add_co_u32 v2, vcc, s68, v2
  s_nop 1
  v_addc_co_u32 v3, vcc, 0, v3, vcc
  global_load_dword v255, v[2:3], off
  v_readfirstlane_b32 s3, v1
  v_mov_b32 v8, v0
  v_and_b32 v0, 63, v0
  s_and_b32 s68, s2, 7
  s_lshr_b32 s69, s2, 3
  s_lshr_b32 s60, s68, 2
  s_lshl_b32 s60, s60, 3
  s_and_b32 s70, s69, 7
  s_add_u32 s60, s60, s70
  s_and_b32 s61, s68, 3
  s_lshl_b32 s61, s61, 1
  s_bfe_u32 s70, s69, 0x10003
  s_add_u32 s61, s61, s70
  s_lshr_b32 s62, s68, 1
  s_lshl_b32 s62, s62, 3
  s_lshr_b32 s70, s69, 2
  s_add_u32 s62, s62, s70
  s_and_b32 s63, s68, 1
  s_lshl_b32 s63, s63, 2
  s_and_b32 s70, s69, 3
  s_add_u32 s63, s63, s70
  v_lshrrev_b32 v1, 3, v0
  v_and_b32 v2, 7, v0
  s_lshl_b32 s68, s3, 5
  v_lshrrev_b32 v4, 4, v0
  v_xor_b32 v4, v4, v2
  v_add_u32 v3, s68, v1
  v_mul_u32_u24 v3, 1280, v3
  v_lshl_add_u32 v16, v4, 4, v3
  v_xor_b32 v5, 64, v16
  v_add_u32 v17, 9216, v5
  v_add_u32 v18, 18432, v16
  v_add_u32 v19, 27648, v5
  s_mul_i32 s65, s60, 163840
  s_mul_i32 s66, s3, 13312
  v_lshlrev_b32 v12, 4, v0
  v_add_u32 v13, 4096, v12
  s_cmp_ge_u32 s2, 128
  s_cbranch_scc1 f_prole
  s_lshl_b32 s68, s3, 3
  s_mul_i32 s69, s61, 160
  s_add_u32 s69, s69, 1280
  v_add_u32 v1, 0, v0
  v_mul_u32_u24 v2, 3277, v1
  v_lshrrev_b32 v2, 16, v2
  v_mul_u32_u24 v3, 20, v2
  v_sub_u32 v3, v1, v3
  v_mul_u32_u24 v4, 13108, v3
  v_lshrrev_b32 v4, 16, v4
  v_and_b32 v5, 1, v4
  v_lshrrev_b32 v4, 1, v4
  v_mul_u32_u24 v5, 1200, v5
  v_mul_u32_u24 v4, 80, v4
  v_add_u32 v2, s68, v2
  v_mul_u32_u24 v2, 3840, v2
  v_lshl_add_u32 v2, v3, 4, v2
  v_add_u32 v2, v2, v5
  v_sub_u32 v2, v2, v4
  v_add_u32 v24, s69, v2
  v_add_u32 v1, 64, v0
  v_mul_u32_u24 v2, 3277, v1
  v_lshrrev_b32 v2, 16, v2
  v_mul_u32_u24 v3, 20, v2
  v_sub_u32 v3, v1, v3
  v_mul_u32_u24 v4, 13108, v3
  v_lshrrev_b32 v4, 16, v4
  v_and_b32 v5, 1, v4
  v_lshrrev_b32 v4, 1, v4
  v_mul_u32_u24 v5, 1200, v5
  v_mul_u32_u24 v4, 80, v4
  v_add_u32 v2, s68, v2
  v_mul_u32_u24 v2, 3840, v2
  v_lshl_add_u32 v2, v3, 4, v2
  v_add_u32 v2, v2, v5
  v_sub_u32 v2, v2, v4
  v_add_u32 v25, s69, v2
  v_subrev_u32 v25, 1024, v25
  v_add_u32 v1, 128, v0
  v_mul_u32_u24 v2, 3277, v1
  v_lshrrev_b32 v2, 16, v2
  v_mul_u32_u24 v3, 20, v2
  v_sub_u32 v3, v1, v3
  v_mul_u32_u24 v4, 13108, v3
  v_lshrrev_b32 v4, 16, v4
  v_and_b32 v5, 1, v4
  v_lshrrev_b32 v4, 1, v4
  v_mul_u32_u24 v5, 1200, v5
  v_mul_u32_u24 v4, 80, v4
  v_add_u32 v2, s68, v2
  v_mul_u32_u24 v2, 3840, v2
  v_lshl_add_u32 v2, v3, 4, v2
  v_add_u32 v2, v2, v5
  v_sub_u32 v2, v2, v4
  v_add_u32 v26, s69, v2
  v_subrev_u32 v26, 2048, v26
  v_mov_b32 v1, 0x40000000
  v_cmp_gt_u32 vcc, 32, v0
  s_nop 1
  v_cndmask_b32 v26, v1, v26, vcc
  s_mul_i32 s67, s3, 3072
  s_add_u32 s67, s67, 53248
  v_lshrrev_b32 v1, 3, v0
  v_and_b32 v2, 7, v0
  v_bfe_u32 v3, v0, 4, 1
  v_lshlrev_b32 v3, 2, v3
  v_xor_b32 v3, v3, v2
  v_add_u32 v4, s68, v1
  v_mul_u32_u24 v4, 3840, v4
  v_lshl_add_u32 v4, v3, 4, v4
  s_lshl_b32 s69, s61, 7
  v_add_u32 v29, s69, v4
  s_waitcnt lgkmcnt(0)
  s_mov_b32 s24, s4
  s_and_b32 s25, s5, 0xffff
  s_mov_b32 s26, 0x280000
  s_mov_b32 s27, 0x20000
  s_mov_b32 s36, s20
  s_and_b32 s37, s21, 0xffff
  s_mov_b32 s38, 0x10000000
  s_mov_b32 s39, 0x20000
  s_add_u32 m0, s66, 0
  s_add_u32 s21, s65, 0
  buffer_load_dwordx4 v16, s[24:27], s21 offen offset:0 lds
  s_mov_b32 s28, s6
  s_and_b32 s29, s7, 0xffff
  s_mov_b32 s30, 0x258000
  buffer_load_dwordx4 v17, s[24:27], s21 offen offset:1024 lds
  s_mov_b32 s31, 0x20000
  s_lshl_b32 s12, s3, 10
  s_add_u32 s12, s12, 65536
  buffer_load_dwordx4 v18, s[24:27], s21 offen offset:2048 lds
  s_mov_b32 s44, s8
  s_and_b32 s45, s9, 0xffff
  s_mov_b32 s46, 0x6400
  buffer_load_dwordx4 v19, s[24:27], s21 offen offset:3072 lds
  s_mov_b32 s47, 0x20000
  s_mov_b32 s48, s22
  s_and_b32 s49, s23, 0xffff
  s_mov_b32 s50, 0x280000
  s_mov_b32 s51, 0x20000
  s_mov_b32 s4, 0
  s_add_u32 m0, s67, 0
  s_nop 0
  buffer_load_dwordx4 v24, s[28:31], s4 offen offset:0 lds
  v_and_b32 v1, 31, v0
  v_lshrrev_b32 v2, 5, v0
  v_bfe_u32 v3, v0, 1, 3
  v_lshlrev_b32 v4, 7, v1
  v_add_u32 v4, s66, v4
  v_add_u32 v5, 0, v2
  v_xor_b32 v5, v5, v3
  v_lshl_add_u32 v20, v5, 4, v4
  v_add_u32 v5, 2, v2
  v_xor_b32 v5, v5, v3
  buffer_load_dwordx4 v25, s[28:31], s4 offen offset:1024 lds
  v_lshl_add_u32 v21, v5, 4, v4
  v_add_u32 v5, 4, v2
  v_xor_b32 v5, v5, v3
  v_lshl_add_u32 v22, v5, 4, v4
  v_add_u32 v5, 6, v2
  v_xor_b32 v5, v5, v3
  v_lshl_add_u32 v23, v5, 4, v4
  v_lshrrev_b32 v3, 4, v1
  v_mul_u32_u24 v3, 96256, v3
  v_lshl_add_u32 v3, v2, 8, v3
  buffer_load_dwordx4 v26, s[28:31], s4 offen offset:2048 lds
  s_add_u32 m0, s12, 0
  v_and_b32 v4, 15, v0
  v_lshl_add_u32 v44, v4, 4, v3
  s_lshl_b32 s68, s60, 3
  s_lshl_b32 s69, s3, 1
  s_add_u32 s68, s68, s69
  s_mul_i32 s6, s68, 96256
  s_add_u32 s6, s6, 3276800
  s_lshl_b32 s68, s2, 8
  s_add_u32 s68, s68, 4096
  v_mov_b32 v3, s68
  buffer_load_dwordx4 v29, s[28:31], s4 offen lds
  s_mov_b32 s4, 122880
  s_add_u32 m0, s67, 16384
  v_mov_b32 v4, 0x40000000
  v_cmp_eq_u32 vcc, 0, v8
  s_nop 1
  v_cndmask_b32 v9, v4, v3, vcc
  v_and_b32 v11, 127, v8
  v_lshlrev_b32 v11, 8, v11
  v_add_u32 v11, 36864, v11
  s_mul_i32 s8, s63, 74
  s_add_u32 s8, s8, s3
  s_mul_i32 s8, s8, 5120
  s_add_u32 s8, s8, 131072
  buffer_load_dwordx4 v24, s[28:31], s4 offen offset:0 lds
  s_add_u32 s20, s8, 266240
  s_cmp_lt_u32 s3, 2
  s_cselect_b32 s20, s20, 0x40000000
  s_mul_i32 s23, s3, 20480
  s_add_u32 s23, s23, 276480
  s_add_u32 s23, s23, s8
  v_and_b32 v1, 3, v0
  v_bfe_u32 v2, v0, 2, 1
  v_bfe_u32 v3, v0, 3, 2
  v_lshrrev_b32 v4, 1, v3
  buffer_load_dwordx4 v25, s[28:31], s4 offen offset:1024 lds
  v_lshl_add_u32 v4, v4, 1, v2
  v_and_b32 v5, 1, v3
  v_lshl_add_u32 v5, v5, 2, v1
  v_lshl_add_u32 v4, v4, 3, v5
  v_lshlrev_b32 v47, 4, v4
  v_mul_u32_u24 v4, 40, v2
  v_lshl_add_u32 v4, v3, 2, v4
  v_add_u32 v4, v4, v1
  v_lshlrev_b32 v40, 4, v4
  v_add_u32 v42, 9600, v40
  buffer_load_dwordx4 v26, s[28:31], s4 offen offset:2048 lds
  s_add_u32 m0, s12, 16384
  v_cmp_lt_u32 vcc, 1, v3
  s_nop 1
  v_cndmask_b32 v41, v40, v42, vcc
  v_lshrrev_b32 v1, 5, v0
  v_bfe_u32 v2, v0, 2, 2
  v_and_b32 v3, 1, v0
  v_bfe_u32 v4, v0, 1, 1
  v_bfe_u32 v5, v0, 4, 1
  v_lshl_add_u32 v4, v5, 1, v4
  v_lshl_add_u32 v6, v1, 3, v2
  v_mul_u32_u24 v7, 320, v6
  buffer_load_dwordx4 v29, s[28:31], s4 offen lds
  v_mul_u32_u24 v34, 160, v3
  v_add_u32 v34, v34, v7
  v_lshl_add_u32 v34, v1, 9, v34
  v_lshl_add_u32 v34, v4, 3, v34
  v_add_u32 v34, 53248, v34
  v_add_u32 v35, 65536, v34
  v_lshrrev_b32 v7, 1, v4
  v_lshlrev_b32 v7, 2, v7
  v_lshl_add_u32 v7, v3, 1, v7
  v_and_b32 v5, 1, v4
  v_add_u32 v7, v7, v5
  v_lshlrev_b32 v7, 3, v7
  v_lshl_add_u32 v7, v6, 7, v7
  v_bfe_u32 v5, v0, 3, 1
  v_lshl_add_u32 v36, v5, 6, v7
  v_add_u32 v36, 65536, v36
  v_xor_b32 v37, 64, v36
  v_add_u32 v38, 65536, v36
  v_add_u32 v39, 65536, v37
  v_mov_b32 v55, 0
  buffer_load_dword v55, v55, s[36:39], 0 offen sc1
  s_lshl_b32 s0, s63, 2
  s_add_u32 s0, s0, s3
  s_mul_i32 s0, s0, 800
  s_and_b32 s1, s3, 1
  s_mul_i32 s1, s1, 10
  v_add_u32 v1, s1, v0
  v_subrev_u32 v2, 50, v1
  v_min_u32 v1, v1, v2
  v_lshlrev_b32 v1, 4, v1
  v_mov_b32 v2, 0x40000000
  v_cmp_gt_u32 vcc, 50, v0
  s_nop 1
  v_cndmask_b32 v1, v2, v1, vcc
  v_cndmask_b32 v3, v2, v12, vcc
  buffer_load_dwordx4 a[28:31], v1, s[44:47], s0 offen
  s_lshl_b32 s0, s61, 2
  s_add_u32 s0, s0, s3
  s_mul_i32 s0, s0, 800
  buffer_load_dwordx4 a[32:35], v3, s[44:47], s0 offen
  s_add_u32 m0, s66, 4096
  s_add_u32 s21, s65, 128
  buffer_load_dwordx4 v16, s[24:27], s21 offen offset:0 lds
  buffer_load_dwordx4 v17, s[24:27], s21 offen offset:1024 lds
  buffer_load_dwordx4 v18, s[24:27], s21 offen offset:2048 lds
  buffer_load_dwordx4 v19, s[24:27], s21 offen offset:3072 lds
  s_mov_b32 s4, 245760
  s_add_u32 m0, s67, 32768
  s_nop 0
  buffer_load_dwordx4 v24, s[28:31], s4 offen offset:0 lds
  buffer_load_dwordx4 v25, s[28:31], s4 offen offset:1024 lds
  buffer_load_dwordx4 v26, s[28:31], s4 offen offset:2048 lds
  s_add_u32 m0, s12, 32768
  s_nop 0
  buffer_load_dwordx4 v29, s[28:31], s4 offen lds
  s_mov_b32 s4, 368640
  s_add_u32 m0, s67, 49152
  s_nop 0
  buffer_load_dwordx4 v24, s[28:31], s4 offen offset:0 lds
  buffer_load_dwordx4 v25, s[28:31], s4 offen offset:1024 lds
  buffer_load_dwordx4 v26, s[28:31], s4 offen offset:2048 lds
  s_add_u32 m0, s12, 49152
  s_nop 0
  buffer_load_dwordx4 v29, s[28:31], s4 offen lds
  s_waitcnt vmcnt(19) lgkmcnt(0)
  s_barrier
  ds_read_b128 a[224:227], v20 offset:0
  ds_read_b64_tr_b16 a[160:161], v34 offset:0
  ds_read_b64_tr_b16 a[162:163], v34 offset:1280
  ds_read_b64_tr_b16 a[164:165], v34 offset:32
  ds_read_b64_tr_b16 a[166:167], v34 offset:1312
  ds_read_b64_tr_b16 a[168:169], v34 offset:64
  ds_read_b64_tr_b16 a[170:171], v34 offset:1344
  ds_read_b64_tr_b16 a[172:173], v34 offset:96
  ds_read_b64_tr_b16 a[174:175], v34 offset:1376
  ds_read_b64_tr_b16 a[176:177], v34 offset:128
  ds_read_b64_tr_b16 a[178:179], v34 offset:1408
  ds_read_b64_tr_b16 a[180:181], v36 offset:0
  ds_read_b64_tr_b16 a[182:183], v36 offset:512
  ds_read_b64_tr_b16 a[184:185], v37 offset:0
  ds_read_b64_tr_b16 a[186:187], v37 offset:512
  ds_read_b128 a[228:231], v21 offset:0
  s_waitcnt lgkmcnt(11)
  v_mfma_f32_32x32x16_bf16 v[176:191], a[160:163], a[224:227], 0
  ds_read_b64_tr_b16 a[188:189], v34 offset:6144
  ds_read_b64_tr_b16 a[190:191], v34 offset:7424
  ds_read_b64_tr_b16 a[192:193], v34 offset:6176
  v_mfma_f32_32x32x16_bf16 v[192:207], a[164:167], a[224:227], 0
  ds_read_b64_tr_b16 a[194:195], v34 offset:7456
  ds_read_b64_tr_b16 a[196:197], v34 offset:6208
  ds_read_b64_tr_b16 a[198:199], v34 offset:7488
  s_mov_b32 s4, 491520
  s_add_u32 m0, s67, 65536
  s_nop 0
  buffer_load_dwordx4 v24, s[28:31], s4 offen offset:0 lds
  s_waitcnt lgkmcnt(13)
  v_mfma_f32_32x32x16_bf16 v[208:223], a[168:171], a[224:227], 0
  ds_read_b64_tr_b16 a[200:201], v34 offset:6240
  ds_read_b64_tr_b16 a[202:203], v34 offset:7520
  v_mfma_f32_32x32x16_bf16 v[224:239], a[172:175], a[224:227], 0
  ds_read_b64_tr_b16 a[204:205], v34 offset:6272
  ds_read_b64_tr_b16 a[206:207], v34 offset:7552
  buffer_load_dwordx4 v25, s[28:31], s4 offen offset:1024 lds
  s_waitcnt lgkmcnt(13)
  v_mfma_f32_32x32x16_bf16 v[240:255], a[176:179], a[224:227], 0
  ds_read_b64_tr_b16 a[208:209], v36 offset:2048
  ds_read_b64_tr_b16 a[210:211], v36 offset:2560
  v_mfma_f32_32x32x16_bf16 v[64:79], a[180:183], a[224:227], 0
  ds_read_b64_tr_b16 a[212:213], v37 offset:2048
  ds_read_b64_tr_b16 a[214:215], v37 offset:2560
  buffer_load_dwordx4 v26, s[28:31], s4 offen offset:2048 lds
  s_add_u32 m0, s12, 65536
  s_waitcnt lgkmcnt(15)
  v_mfma_f32_32x32x16_bf16 v[80:95], a[184:187], a[224:227], 0
  ds_read_b128 a[232:235], v22 offset:0
  ds_read_b128 a[236:239], v23 offset:0
  s_waitcnt lgkmcnt(12)
  v_mfma_f32_32x32x16_bf16 v[176:191], a[188:191], a[228:231], v[176:191]
  buffer_load_dwordx4 v29, s[28:31], s4 offen lds
  s_add_u32 m0, s66, 8192
  s_add_u32 s21, s65, 256
  v_mfma_f32_32x32x16_bf16 v[192:207], a[192:195], a[228:231], v[192:207]
  s_waitcnt lgkmcnt(8)
  v_mfma_f32_32x32x16_bf16 v[208:223], a[196:199], a[228:231], v[208:223]
  s_waitcnt vmcnt(19) lgkmcnt(0)
  s_barrier
  ds_read_b64_tr_b16 a[160:161], v34 offset:16384
  ds_read_b64_tr_b16 a[162:163], v34 offset:17664
  ds_read_b64_tr_b16 a[164:165], v34 offset:16416
  buffer_load_dwordx4 v16, s[24:27], s21 offen offset:0 lds
  v_mfma_f32_32x32x16_bf16 v[224:239], a[200:203], a[228:231], v[224:239]
  ds_read_b64_tr_b16 a[166:167], v34 offset:17696
  ds_read_b64_tr_b16 a[168:169], v34 offset:16448
  ds_read_b64_tr_b16 a[170:171], v34 offset:17728
  v_mfma_f32_32x32x16_bf16 v[240:255], a[204:207], a[228:231], v[240:255]
  ds_read_b64_tr_b16 a[172:173], v34 offset:16480
  ds_read_b64_tr_b16 a[174:175], v34 offset:17760
  ds_read_b64_tr_b16 a[176:177], v34 offset:16512
  buffer_load_dwordx4 v17, s[24:27], s21 offen offset:1024 lds
  v_mfma_f32_32x32x16_bf16 v[64:79], a[208:211], a[228:231], v[64:79]
  ds_read_b64_tr_b16 a[178:179], v34 offset:17792
  ds_read_b64_tr_b16 a[180:181], v36 offset:16384
  ds_read_b64_tr_b16 a[182:183], v36 offset:16896
  v_mfma_f32_32x32x16_bf16 v[80:95], a[212:215], a[228:231], v[80:95]
  ds_read_b64_tr_b16 a[184:185], v37 offset:16384
  ds_read_b64_tr_b16 a[186:187], v37 offset:16896
  buffer_load_dwordx4 v18, s[24:27], s21 offen offset:2048 lds
  s_waitcnt lgkmcnt(10)
  v_mfma_f32_32x32x16_bf16 v[176:191], a[160:163], a[232:235], v[176:191]
  ds_read_b64_tr_b16 a[188:189], v34 offset:22528
  ds_read_b64_tr_b16 a[190:191], v34 offset:23808
  v_mfma_f32_32x32x16_bf16 v[192:207], a[164:167], a[232:235], v[192:207]
  ds_read_b64_tr_b16 a[192:193], v34 offset:22560
  ds_read_b64_tr_b16 a[194:195], v34 offset:23840
  buffer_load_dwordx4 v19, s[24:27], s21 offen offset:3072 lds
  s_mov_b32 s4, 614400
  s_add_u32 m0, s67, 81920
  s_waitcnt lgkmcnt(10)
  v_mfma_f32_32x32x16_bf16 v[208:223], a[168:171], a[232:235], v[208:223]
  ds_read_b64_tr_b16 a[196:197], v34 offset:22592
  ds_read_b64_tr_b16 a[198:199], v34 offset:23872
  v_mfma_f32_32x32x16_bf16 v[224:239], a[172:175], a[232:235], v[224:239]
  ds_read_b64_tr_b16 a[200:201], v34 offset:22624
  ds_read_b64_tr_b16 a[202:203], v34 offset:23904
  buffer_load_dwordx4 v24, s[28:31], s4 offen offset:0 lds
  s_waitcnt lgkmcnt(10)
  v_mfma_f32_32x32x16_bf16 v[240:255], a[176:179], a[232:235], v[240:255]
  ds_read_b64_tr_b16 a[204:205], v34 offset:22656
  ds_read_b64_tr_b16 a[206:207], v34 offset:23936
  v_mfma_f32_32x32x16_bf16 v[64:79], a[180:183], a[232:235], v[64:79]
  ds_read_b64_tr_b16 a[208:209], v36 offset:18432
  ds_read_b64_tr_b16 a[210:211], v36 offset:18944
  buffer_load_dwordx4 v25, s[28:31], s4 offen offset:1024 lds
  s_waitcnt lgkmcnt(12)
  v_mfma_f32_32x32x16_bf16 v[80:95], a[184:187], a[232:235], v[80:95]
  ds_read_b64_tr_b16 a[212:213], v37 offset:18432
  ds_read_b64_tr_b16 a[214:215], v37 offset:18944
  s_waitcnt lgkmcnt(10)
  v_mfma_f32_32x32x16_bf16 v[176:191], a[188:191], a[236:239], v[176:191]
  buffer_load_dwordx4 v26, s[28:31], s4 offen offset:2048 lds
  s_add_u32 m0, s12, 81920
  v_mfma_f32_32x32x16_bf16 v[192:207], a[192:195], a[236:239], v[192:207]
  s_waitcnt lgkmcnt(6)
  v_mfma_f32_32x32x16_bf16 v[208:223], a[196:199], a[236:239], v[208:223]
  s_waitcnt vmcnt(15) lgkmcnt(0)
  s_barrier
  v_readfirstlane_b32 s64, v55
  ds_read_b128 a[240:243], v20 offset:4096
  ds_read_b64_tr_b16 a[160:161], v34 offset:32768
  ds_read_b64_tr_b16 a[162:163], v34 offset:34048
  ds_read_b64_tr_b16 a[164:165], v34 offset:32800
  buffer_load_dwordx4 v29, s[28:31], s4 offen lds
  s_mov_b32 s4, 737280
  s_add_u32 m0, s67, 0
  v_mfma_f32_32x32x16_bf16 v[224:239], a[200:203], a[236:239], v[224:239]
  ds_read_b64_tr_b16 a[166:167], v34 offset:34080
  ds_read_b64_tr_b16 a[168:169], v34 offset:32832
  ds_read_b64_tr_b16 a[170:171], v34 offset:34112
  v_mfma_f32_32x32x16_bf16 v[240:255], a[204:207], a[236:239], v[240:255]
  ds_read_b64_tr_b16 a[172:173], v34 offset:32864
  ds_read_b64_tr_b16 a[174:175], v34 offset:34144
  ds_read_b64_tr_b16 a[176:177], v34 offset:32896
  buffer_load_dwordx4 v24, s[28:31], s4 offen offset:0 lds
  v_mfma_f32_32x32x16_bf16 v[64:79], a[208:211], a[236:239], v[64:79]
  ds_read_b64_tr_b16 a[178:179], v34 offset:34176
  ds_read_b64_tr_b16 a[180:181], v36 offset:32768
  ds_read_b64_tr_b16 a[182:183], v36 offset:33280
  v_mfma_f32_32x32x16_bf16 v[80:95], a[212:215], a[236:239], v[80:95]
  ds_read_b64_tr_b16 a[184:185], v37 offset:32768
  ds_read_b64_tr_b16 a[186:187], v37 offset:33280
  ds_read_b128 a[244:247], v21 offset:4096
  buffer_load_dwordx4 v25, s[28:31], s4 offen offset:1024 lds
  s_waitcnt lgkmcnt(11)
  v_mfma_f32_32x32x16_bf16 v[176:191], a[160:163], a[240:243], v[176:191]
  ds_read_b64_tr_b16 a[188:189], v34 offset:38912
  ds_read_b64_tr_b16 a[190:191], v34 offset:40192
  ds_read_b64_tr_b16 a[192:193], v34 offset:38944
  v_mfma_f32_32x32x16_bf16 v[192:207], a[164:167], a[240:243], v[192:207]
  ds_read_b64_tr_b16 a[194:195], v34 offset:40224
  ds_read_b64_tr_b16 a[196:197], v34 offset:38976
  ds_read_b64_tr_b16 a[198:199], v34 offset:40256
  buffer_load_dwordx4 v26, s[28:31], s4 offen offset:2048 lds
  s_add_u32 m0, s12, 0
  s_waitcnt lgkmcnt(13)
  v_mfma_f32_32x32x16_bf16 v[208:223], a[168:171], a[240:243], v[208:223]
  ds_read_b64_tr_b16 a[200:201], v34 offset:39008
  ds_read_b64_tr_b16 a[202:203], v34 offset:40288
  s_mul_i32 s0, s3, 960
  s_add_u32 s0, s0, 151552
  v_mfma_f32_32x32x16_bf16 v[224:239], a[172:175], a[240:243], v[224:239]
  ds_read_b64_tr_b16 a[204:205], v34 offset:39040
  ds_read_b64_tr_b16 a[206:207], v34 offset:40320
  buffer_load_dwordx4 v29, s[28:31], s4 offen lds
  s_add_u32 m0, s66, 0
  s_add_u32 s21, s65, 384
  v_add_u32 v1, s0, v12
  s_mul_i32 s0, s3, 480
  s_waitcnt lgkmcnt(13)
  v_mfma_f32_32x32x16_bf16 v[240:255], a[176:179], a[240:243], v[240:255]
  ds_read_b64_tr_b16 a[208:209], v36 offset:34816
  ds_read_b64_tr_b16 a[210:211], v36 offset:35328
  s_add_u32 s0, s0, 155392
  v_lshl_add_u32 v2, v0, 3, s0
  v_mfma_f32_32x32x16_bf16 v[64:79], a[180:183], a[240:243], v[64:79]
  ds_read_b64_tr_b16 a[212:213], v37 offset:34816
  ds_read_b64_tr_b16 a[214:215], v37 offset:35328
  buffer_load_dwordx4 v16, s[24:27], s21 offen offset:0 lds
  v_mov_b32 v4, 0
  v_mov_b32 v5, 0
  s_waitcnt lgkmcnt(15)
  v_mfma_f32_32x32x16_bf16 v[80:95], a[184:187], a[240:243], v[80:95]
  ds_read_b128 a[248:251], v22 offset:4096
  ds_read_b128 a[252:255], v23 offset:4096
  s_bfm_b64 exec, 60, 0
  ds_write_b128 v1, a[28:31]
  ds_write_b128 v1, a[32:35] offset:5760
  ds_write_b64 v2, v[4:5]
  s_mov_b64 exec, -1
  s_waitcnt lgkmcnt(15)
  v_mfma_f32_32x32x16_bf16 v[176:191], a[188:191], a[244:247], v[176:191]
  buffer_load_dwordx4 v17, s[24:27], s21 offen offset:1024 lds
  v_mfma_f32_32x32x16_bf16 v[192:207], a[192:195], a[244:247], v[192:207]
  s_waitcnt lgkmcnt(11)
  v_mfma_f32_32x32x16_bf16 v[208:223], a[196:199], a[244:247], v[208:223]
  s_waitcnt vmcnt(18) lgkmcnt(0)
  s_barrier
  ds_read_b64_tr_b16 a[160:161], v34 offset:49152
  ds_read_b64_tr_b16 a[162:163], v34 offset:50432
  ds_read_b64_tr_b16 a[164:165], v34 offset:49184
  buffer_load_dwordx4 v18, s[24:27], s21 offen offset:2048 lds
  v_mfma_f32_32x32x16_bf16 v[224:239], a[200:203], a[244:247], v[224:239]
  ds_read_b64_tr_b16 a[166:167], v34 offset:50464
  ds_read_b64_tr_b16 a[168:169], v34 offset:49216
  ds_read_b64_tr_b16 a[170:171], v34 offset:50496
  v_mfma_f32_32x32x16_bf16 v[240:255], a[204:207], a[244:247], v[240:255]
  ds_read_b64_tr_b16 a[172:173], v34 offset:49248
  ds_read_b64_tr_b16 a[174:175], v34 offset:50528
  ds_read_b64_tr_b16 a[176:177], v34 offset:49280
  buffer_load_dwordx4 v19, s[24:27], s21 offen offset:3072 lds
  s_mov_b32 s4, 860160
  s_add_u32 m0, s67, 16384
  v_mfma_f32_32x32x16_bf16 v[64:79], a[208:211], a[244:247], v[64:79]
  ds_read_b64_tr_b16 a[178:179], v34 offset:50560
  ds_read_b64_tr_b16 a[180:181], v36 offset:49152
  ds_read_b64_tr_b16 a[182:183], v36 offset:49664
  v_mfma_f32_32x32x16_bf16 v[80:95], a[212:215], a[244:247], v[80:95]
  ds_read_b64_tr_b16 a[184:185], v37 offset:49152
  ds_read_b64_tr_b16 a[186:187], v37 offset:49664
  buffer_load_dwordx4 v24, s[28:31], s4 offen offset:0 lds
  s_waitcnt lgkmcnt(10)
  v_mfma_f32_32x32x16_bf16 v[176:191], a[160:163], a[248:251], v[176:191]
  ds_read_b64_tr_b16 a[188:189], v34 offset:55296
  ds_read_b64_tr_b16 a[190:191], v34 offset:56576
  v_mfma_f32_32x32x16_bf16 v[192:207], a[164:167], a[248:251], v[192:207]
  ds_read_b64_tr_b16 a[192:193], v34 offset:55328
  ds_read_b64_tr_b16 a[194:195], v34 offset:56608
  buffer_load_dwordx4 v25, s[28:31], s4 offen offset:1024 lds
  s_waitcnt lgkmcnt(10)
  v_mfma_f32_32x32x16_bf16 v[208:223], a[168:171], a[248:251], v[208:223]
  ds_read_b64_tr_b16 a[196:197], v34 offset:55360
  ds_read_b64_tr_b16 a[198:199], v34 offset:56640
  v_mfma_f32_32x32x16_bf16 v[224:239], a[172:175], a[248:251], v[224:239]
  ds_read_b64_tr_b16 a[200:201], v34 offset:55392
  ds_read_b64_tr_b16 a[202:203], v34 offset:56672
  buffer_load_dwordx4 v26, s[28:31], s4 offen offset:2048 lds
  s_add_u32 m0, s12, 16384
  s_waitcnt lgkmcnt(10)
  v_mfma_f32_32x32x16_bf16 v[240:255], a[176:179], a[248:251], v[240:255]
  ds_read_b64_tr_b16 a[204:205], v34 offset:55424
  ds_read_b64_tr_b16 a[206:207], v34 offset:56704
  v_mfma_f32_32x32x16_bf16 v[64:79], a[180:183], a[248:251], v[64:79]
  ds_read_b64_tr_b16 a[208:209], v36 offset:51200
  ds_read_b64_tr_b16 a[210:211], v36 offset:51712
  buffer_load_dwordx4 v29, s[28:31], s4 offen lds
  s_mov_b32 s4, 983040
  s_add_u32 m0, s67, 32768
  s_waitcnt lgkmcnt(12)
  v_mfma_f32_32x32x16_bf16 v[80:95], a[184:187], a[248:251], v[80:95]
  ds_read_b64_tr_b16 a[212:213], v37 offset:51200
  ds_read_b64_tr_b16 a[214:215], v37 offset:51712
  s_waitcnt lgkmcnt(10)
  v_mfma_f32_32x32x16_bf16 v[176:191], a[188:191], a[252:255], v[176:191]
  buffer_load_dwordx4 v24, s[28:31], s4 offen offset:0 lds
  v_mfma_f32_32x32x16_bf16 v[192:207], a[192:195], a[252:255], v[192:207]
  s_waitcnt lgkmcnt(6)
  v_mfma_f32_32x32x16_bf16 v[208:223], a[196:199], a[252:255], v[208:223]
  s_waitcnt vmcnt(17) lgkmcnt(0)
  s_barrier
  ds_read_b128 a[224:227], v20 offset:8192
  ds_read_b64_tr_b16 a[160:161], v35 offset:0
  ds_read_b64_tr_b16 a[162:163], v35 offset:1280
  ds_read_b64_tr_b16 a[164:165], v35 offset:32
  buffer_load_dwordx4 v25, s[28:31], s4 offen offset:1024 lds
  v_mfma_f32_32x32x16_bf16 v[224:239], a[200:203], a[252:255], v[224:239]
  ds_read_b64_tr_b16 a[166:167], v35 offset:1312
  ds_read_b64_tr_b16 a[168:169], v35 offset:64
  ds_read_b64_tr_b16 a[170:171], v35 offset:1344
  v_mfma_f32_32x32x16_bf16 v[240:255], a[204:207], a[252:255], v[240:255]
  ds_read_b64_tr_b16 a[172:173], v35 offset:96
  ds_read_b64_tr_b16 a[174:175], v35 offset:1376
  ds_read_b64_tr_b16 a[176:177], v35 offset:128
  buffer_load_dwordx4 v26, s[28:31], s4 offen offset:2048 lds
  s_add_u32 m0, s12, 32768
  v_mfma_f32_32x32x16_bf16 v[64:79], a[208:211], a[252:255], v[64:79]
  ds_read_b64_tr_b16 a[178:179], v35 offset:1408
  ds_read_b64_tr_b16 a[180:181], v38 offset:0
  ds_read_b64_tr_b16 a[182:183], v38 offset:512
  v_mfma_f32_32x32x16_bf16 v[80:95], a[212:215], a[252:255], v[80:95]
  ds_read_b64_tr_b16 a[184:185], v39 offset:0
  ds_read_b64_tr_b16 a[186:187], v39 offset:512
  ds_read_b128 a[228:231], v21 offset:8192
  buffer_load_dwordx4 v29, s[28:31], s4 offen lds
  s_add_u32 m0, s66, 4096
  s_add_u32 s21, s65, 512
  s_waitcnt lgkmcnt(11)
  v_mfma_f32_32x32x16_bf16 v[176:191], a[160:163], a[224:227], v[176:191]
  ds_read_b64_tr_b16 a[188:189], v35 offset:6144
  ds_read_b64_tr_b16 a[190:191], v35 offset:7424
  ds_read_b64_tr_b16 a[192:193], v35 offset:6176
  v_mfma_f32_32x32x16_bf16 v[192:207], a[164:167], a[224:227], v[192:207]
  ds_read_b64_tr_b16 a[194:195], v35 offset:7456
  ds_read_b64_tr_b16 a[196:197], v35 offset:6208
  ds_read_b64_tr_b16 a[198:199], v35 offset:7488
  buffer_load_dwordx4 v16, s[24:27], s21 offen offset:0 lds
  s_waitcnt lgkmcnt(13)
  v_mfma_f32_32x32x16_bf16 v[208:223], a[168:171], a[224:227], v[208:223]
  ds_read_b64_tr_b16 a[200:201], v35 offset:6240
  ds_read_b64_tr_b16 a[202:203], v35 offset:7520
  v_mfma_f32_32x32x16_bf16 v[224:239], a[172:175], a[224:227], v[224:239]
  ds_read_b64_tr_b16 a[204:205], v35 offset:6272
  ds_read_b64_tr_b16 a[206:207], v35 offset:7552
  buffer_load_dwordx4 v17, s[24:27], s21 offen offset:1024 lds
  s_waitcnt lgkmcnt(13)
  v_mfma_f32_32x32x16_bf16 v[240:255], a[176:179], a[224:227], v[240:255]
  ds_read_b64_tr_b16 a[208:209], v38 offset:2048
  ds_read_b64_tr_b16 a[210:211], v38 offset:2560
  v_mfma_f32_32x32x16_bf16 v[64:79], a[180:183], a[224:227], v[64:79]
  ds_read_b64_tr_b16 a[212:213], v39 offset:2048
  ds_read_b64_tr_b16 a[214:215], v39 offset:2560
  buffer_load_dwordx4 v18, s[24:27], s21 offen offset:2048 lds
  s_waitcnt lgkmcnt(15)
  v_mfma_f32_32x32x16_bf16 v[80:95], a[184:187], a[224:227], v[80:95]
  ds_read_b128 a[232:235], v22 offset:8192
  ds_read_b128 a[236:239], v23 offset:8192
  s_waitcnt lgkmcnt(12)
  v_mfma_f32_32x32x16_bf16 v[176:191], a[188:191], a[228:231], v[176:191]
  buffer_load_dwordx4 v19, s[24:27], s21 offen offset:3072 lds
  s_mov_b32 s4, 1105920
  s_add_u32 m0, s67, 49152
  v_mfma_f32_32x32x16_bf16 v[192:207], a[192:195], a[228:231], v[192:207]
  s_waitcnt lgkmcnt(8)
  v_mfma_f32_32x32x16_bf16 v[208:223], a[196:199], a[228:231], v[208:223]
  s_waitcnt vmcnt(20) lgkmcnt(0)
  s_barrier
  ds_read_b64_tr_b16 a[160:161], v35 offset:16384
  ds_read_b64_tr_b16 a[162:163], v35 offset:17664
  ds_read_b64_tr_b16 a[164:165], v35 offset:16416
  buffer_load_dwordx4 v24, s[28:31], s4 offen offset:0 lds
  v_mfma_f32_32x32x16_bf16 v[224:239], a[200:203], a[228:231], v[224:239]
  ds_read_b64_tr_b16 a[166:167], v35 offset:17696
  ds_read_b64_tr_b16 a[168:169], v35 offset:16448
  ds_read_b64_tr_b16 a[170:171], v35 offset:17728
  v_mfma_f32_32x32x16_bf16 v[240:255], a[204:207], a[228:231], v[240:255]
  ds_read_b64_tr_b16 a[172:173], v35 offset:16480
  ds_read_b64_tr_b16 a[174:175], v35 offset:17760
  ds_read_b64_tr_b16 a[176:177], v35 offset:16512
  buffer_load_dwordx4 v25, s[28:31], s4 offen offset:1024 lds
  v_mfma_f32_32x32x16_bf16 v[64:79], a[208:211], a[228:231], v[64:79]
  ds_read_b64_tr_b16 a[178:179], v35 offset:17792
  ds_read_b64_tr_b16 a[180:181], v38 offset:16384
  ds_read_b64_tr_b16 a[182:183], v38 offset:16896
  v_mfma_f32_32x32x16_bf16 v[80:95], a[212:215], a[228:231], v[80:95]
  ds_read_b64_tr_b16 a[184:185], v39 offset:16384
  ds_read_b64_tr_b16 a[186:187], v39 offset:16896
  buffer_load_dwordx4 v26, s[28:31], s4 offen offset:2048 lds
  s_add_u32 m0, s12, 49152
  s_waitcnt lgkmcnt(10)
  v_mfma_f32_32x32x16_bf16 v[176:191], a[160:163], a[232:235], v[176:191]
  ds_read_b64_tr_b16 a[188:189], v35 offset:22528
  ds_read_b64_tr_b16 a[190:191], v35 offset:23808
  v_mfma_f32_32x32x16_bf16 v[192:207], a[164:167], a[232:235], v[192:207]
  ds_read_b64_tr_b16 a[192:193], v35 offset:22560
  ds_read_b64_tr_b16 a[194:195], v35 offset:23840
  buffer_load_dwordx4 v29, s[28:31], s4 offen lds
  s_mov_b32 s4, 1228800
  s_add_u32 m0, s67, 65536
  s_waitcnt lgkmcnt(10)
  v_mfma_f32_32x32x16_bf16 v[208:223], a[168:171], a[232:235], v[208:223]
  ds_read_b64_tr_b16 a[196:197], v35 offset:22592
  ds_read_b64_tr_b16 a[198:199], v35 offset:23872
  v_mfma_f32_32x32x16_bf16 v[224:239], a[172:175], a[232:235], v[224:239]
  ds_read_b64_tr_b16 a[200:201], v35 offset:22624
  ds_read_b64_tr_b16 a[202:203], v35 offset:23904
  buffer_load_dwordx4 v24, s[28:31], s4 offen offset:0 lds
  s_waitcnt lgkmcnt(10)
  v_mfma_f32_32x32x16_bf16 v[240:255], a[176:179], a[232:235], v[240:255]
  ds_read_b64_tr_b16 a[204:205], v35 offset:22656
  ds_read_b64_tr_b16 a[206:207], v35 offset:23936
  v_mfma_f32_32x32x16_bf16 v[64:79], a[180:183], a[232:235], v[64:79]
  ds_read_b64_tr_b16 a[208:209], v38 offset:18432
  ds_read_b64_tr_b16 a[210:211], v38 offset:18944
  buffer_load_dwordx4 v25, s[28:31], s4 offen offset:1024 lds
  s_waitcnt lgkmcnt(12)
  v_mfma_f32_32x32x16_bf16 v[80:95], a[184:187], a[232:235], v[80:95]
  ds_read_b64_tr_b16 a[212:213], v39 offset:18432
  ds_read_b64_tr_b16 a[214:215], v39 offset:18944
  s_waitcnt lgkmcnt(10)
  v_mfma_f32_32x32x16_bf16 v[176:191], a[188:191], a[236:239], v[176:191]
  buffer_load_dwordx4 v26, s[28:31], s4 offen offset:2048 lds
  s_add_u32 m0, s12, 65536
  v_mfma_f32_32x32x16_bf16 v[192:207], a[192:195], a[236:239], v[192:207]
  s_waitcnt lgkmcnt(6)
  v_mfma_f32_32x32x16_bf16 v[208:223], a[196:199], a[236:239], v[208:223]
  s_waitcnt vmcnt(19) lgkmcnt(0)
  s_barrier
  ds_read_b128 a[240:243], v20 offset:0
  ds_read_b64_tr_b16 a[160:161], v34 offset:0
  ds_read_b64_tr_b16 a[162:163], v34 offset:1280
  ds_read_b64_tr_b16 a[164:165], v34 offset:32
  buffer_load_dwordx4 v29, s[28:31], s4 offen lds
  s_add_u32 m0, s66, 8192
  s_add_u32 s21, s65, 640
  v_mfma_f32_32x32x16_bf16 v[224:239], a[200:203], a[236:239], v[224:239]
  ds_read_b64_tr_b16 a[166:167], v34 offset:1312
  ds_read_b64_tr_b16 a[168:169], v34 offset:64
  ds_read_b64_tr_b16 a[170:171], v34 offset:1344
  v_mfma_f32_32x32x16_bf16 v[240:255], a[204:207], a[236:239], v[240:255]
  ds_read_b64_tr_b16 a[172:173], v34 offset:96
  ds_read_b64_tr_b16 a[174:175], v34 offset:1376
  ds_read_b64_tr_b16 a[176:177], v34 offset:128
  buffer_load_dwordx4 v16, s[24:27], s21 offen offset:0 lds
  v_mfma_f32_32x32x16_bf16 v[64:79], a[208:211], a[236:239], v[64:79]
  ds_read_b64_tr_b16 a[178:179], v34 offset:1408
  ds_read_b64_tr_b16 a[180:181], v36 offset:0
  ds_read_b64_tr_b16 a[182:183], v36 offset:512
  v_mfma_f32_32x32x16_bf16 v[80:95], a[212:215], a[236:239], v[80:95]
  ds_read_b64_tr_b16 a[184:185], v37 offset:0
  ds_read_b64_tr_b16 a[186:187], v37 offset:512
  ds_read_b128 a[244:247], v21 offset:0
  buffer_load_dwordx4 v17, s[24:27], s21 offen offset:1024 lds
  s_waitcnt lgkmcnt(11)
  v_mfma_f32_32x32x16_bf16 v[176:191], a[160:163], a[240:243], v[176:191]
  ds_read_b64_tr_b16 a[188:189], v34 offset:6144
  ds_read_b64_tr_b16 a[190:191], v34 offset:7424
  ds_read_b64_tr_b16 a[192:193], v34 offset:6176
  v_mfma_f32_32x32x16_bf16 v[192:207], a[164:167], a[240:243], v[192:207]
  ds_read_b64_tr_b16 a[194:195], v34 offset:7456
  ds_read_b64_tr_b16 a[196:197], v34 offset:6208
  ds_read_b64_tr_b16 a[198:199], v34 offset:7488
  buffer_load_dwordx4 v18, s[24:27], s21 offen offset:2048 lds
  s_waitcnt lgkmcnt(13)
  v_mfma_f32_32x32x16_bf16 v[208:223], a[168:171], a[240:243], v[208:223]
  ds_read_b64_tr_b16 a[200:201], v34 offset:6240
  ds_read_b64_tr_b16 a[202:203], v34 offset:7520
  v_mfma_f32_32x32x16_bf16 v[224:239], a[172:175], a[240:243], v[224:239]
  ds_read_b64_tr_b16 a[204:205], v34 offset:6272
  ds_read_b64_tr_b16 a[206:207], v34 offset:7552
  buffer_load_dwordx4 v19, s[24:27], s21 offen offset:3072 lds
  s_mov_b32 s4, 1351680
  s_add_u32 m0, s67, 81920
  s_waitcnt lgkmcnt(13)
  v_mfma_f32_32x32x16_bf16 v[240:255], a[176:179], a[240:243], v[240:255]
  ds_read_b64_tr_b16 a[208:209], v36 offset:2048
  ds_read_b64_tr_b16 a[210:211], v36 offset:2560
  v_mfma_f32_32x32x16_bf16 v[64:79], a[180:183], a[240:243], v[64:79]
  ds_read_b64_tr_b16 a[212:213], v37 offset:2048
  ds_read_b64_tr_b16 a[214:215], v37 offset:2560
  buffer_load_dwordx4 v24, s[28:31], s4 offen offset:0 lds
  s_waitcnt lgkmcnt(15)
  v_mfma_f32_32x32x16_bf16 v[80:95], a[184:187], a[240:243], v[80:95]
  ds_read_b128 a[248:251], v22 offset:0
  ds_read_b128 a[252:255], v23 offset:0
  s_waitcnt lgkmcnt(12)
  v_mfma_f32_32x32x16_bf16 v[176:191], a[188:191], a[244:247], v[176:191]
  buffer_load_dwordx4 v25, s[28:31], s4 offen offset:1024 lds
  v_mfma_f32_32x32x16_bf16 v[192:207], a[192:195], a[244:247], v[192:207]
  s_waitcnt lgkmcnt(8)
  v_mfma_f32_32x32x16_bf16 v[208:223], a[196:199], a[244:247], v[208:223]
  s_waitcnt vmcnt(22) lgkmcnt(0)
  s_barrier
  ds_read_b64_tr_b16 a[160:161], v34 offset:16384
  ds_read_b64_tr_b16 a[162:163], v34 offset:17664
  ds_read_b64_tr_b16 a[164:165], v34 offset:16416
  buffer_load_dwordx4 v26, s[28:31], s4 offen offset:2048 lds
  s_add_u32 m0, s12, 81920
  v_mfma_f32_32x32x16_bf16 v[224:239], a[200:203], a[244:247], v[224:239]
  ds_read_b64_tr_b16 a[166:167], v34 offset:17696
  ds_read_b64_tr_b16 a[168:169], v34 offset:16448
  ds_read_b64_tr_b16 a[170:171], v34 offset:17728
  v_mfma_f32_32x32x16_bf16 v[240:255], a[204:207], a[244:247], v[240:255]
  ds_read_b64_tr_b16 a[172:173], v34 offset:16480
  ds_read_b64_tr_b16 a[174:175], v34 offset:17760
  ds_read_b64_tr_b16 a[176:177], v34 offset:16512
  buffer_load_dwordx4 v29, s[28:31], s4 offen lds
  s_mov_b32 s4, 1474560
  s_add_u32 m0, s67, 0
  v_mfma_f32_32x32x16_bf16 v[64:79], a[208:211], a[244:247], v[64:79]
  ds_read_b64_tr_b16 a[178:179], v34 offset:17792
  ds_read_b64_tr_b16 a[180:181], v36 offset:16384
  ds_read_b64_tr_b16 a[182:183], v36 offset:16896
  v_mfma_f32_32x32x16_bf16 v[80:95], a[212:215], a[244:247], v[80:95]
  ds_read_b64_tr_b16 a[184:185], v37 offset:16384
  ds_read_b64_tr_b16 a[186:187], v37 offset:16896
  buffer_load_dwordx4 v24, s[28:31], s4 offen offset:0 lds
  s_waitcnt lgkmcnt(10)
  v_mfma_f32_32x32x16_bf16 v[176:191], a[160:163], a[248:251], v[176:191]
  ds_read_b64_tr_b16 a[188:189], v34 offset:22528
  ds_read_b64_tr_b16 a[190:191], v34 offset:23808
  v_mfma_f32_32x32x16_bf16 v[192:207], a[164:167], a[248:251], v[192:207]
  ds_read_b64_tr_b16 a[192:193], v34 offset:22560
  ds_read_b64_tr_b16 a[194:195], v34 offset:23840
  buffer_load_dwordx4 v25, s[28:31], s4 offen offset:1024 lds
  s_waitcnt lgkmcnt(10)
  v_mfma_f32_32x32x16_bf16 v[208:223], a[168:171], a[248:251], v[208:223]
  ds_read_b64_tr_b16 a[196:197], v34 offset:22592
  ds_read_b64_tr_b16 a[198:199], v34 offset:23872
  v_mfma_f32_32x32x16_bf16 v[224:239], a[172:175], a[248:251], v[224:239]
  ds_read_b64_tr_b16 a[200:201], v34 offset:22624
  ds_read_b64_tr_b16 a[202:203], v34 offset:23904
  buffer_load_dwordx4 v26, s[28:31], s4 offen offset:2048 lds
  s_add_u32 m0, s12, 0
  s_waitcnt lgkmcnt(10)
  v_mfma_f32_32x32x16_bf16 v[240:255], a[176:179], a[248:251], v[240:255]
  ds_read_b64_tr_b16 a[204:205], v34 offset:22656
  ds_read_b64_tr_b16 a[206:207], v34 offset:23936
  v_mfma_f32_32x32x16_bf16 v[64:79], a[180:183], a[248:251], v[64:79]
  ds_read_b64_tr_b16 a[208:209], v36 offset:18432
  ds_read_b64_tr_b16 a[210:211], v36 offset:18944
  buffer_load_dwordx4 v29, s[28:31], s4 offen lds
  s_add_u32 m0, s66, 0
  s_add_u32 s21, s65, 768
  s_waitcnt lgkmcnt(12)
  v_mfma_f32_32x32x16_bf16 v[80:95], a[184:187], a[248:251], v[80:95]
  ds_read_b64_tr_b16 a[212:213], v37 offset:18432
  ds_read_b64_tr_b16 a[214:215], v37 offset:18944
  s_waitcnt lgkmcnt(10)
  v_mfma_f32_32x32x16_bf16 v[176:191], a[188:191], a[252:255], v[176:191]
  buffer_load_dwordx4 v16, s[24:27], s21 offen offset:0 lds
  v_mfma_f32_32x32x16_bf16 v[192:207], a[192:195], a[252:255], v[192:207]
  s_waitcnt lgkmcnt(6)
  v_mfma_f32_32x32x16_bf16 v[208:223], a[196:199], a[252:255], v[208:223]
  s_waitcnt vmcnt(21) lgkmcnt(0)
  s_barrier
  ds_read_b128 a[224:227], v20 offset:4096
  ds_read_b64_tr_b16 a[160:161], v34 offset:32768
  ds_read_b64_tr_b16 a[162:163], v34 offset:34048
  ds_read_b64_tr_b16 a[164:165], v34 offset:32800
  buffer_load_dwordx4 v17, s[24:27], s21 offen offset:1024 lds
  v_mfma_f32_32x32x16_bf16 v[224:239], a[200:203], a[252:255], v[224:239]
  ds_read_b64_tr_b16 a[166:167], v34 offset:34080
  ds_read_b64_tr_b16 a[168:169], v34 offset:32832
  ds_read_b64_tr_b16 a[170:171], v34 offset:34112
  v_mfma_f32_32x32x16_bf16 v[240:255], a[204:207], a[252:255], v[240:255]
  ds_read_b64_tr_b16 a[172:173], v34 offset:32864
  ds_read_b64_tr_b16 a[174:175], v34 offset:34144
  ds_read_b64_tr_b16 a[176:177], v34 offset:32896
  buffer_load_dwordx4 v18, s[24:27], s21 offen offset:2048 lds
  v_mfma_f32_32x32x16_bf16 v[64:79], a[208:211], a[252:255], v[64:79]
  ds_read_b64_tr_b16 a[178:179], v34 offset:34176
  ds_read_b64_tr_b16 a[180:181], v36 offset:32768
  ds_read_b64_tr_b16 a[182:183], v36 offset:33280
  v_mfma_f32_32x32x16_bf16 v[80:95], a[212:215], a[252:255], v[80:95]
  ds_read_b64_tr_b16 a[184:185], v37 offset:32768
  ds_read_b64_tr_b16 a[186:187], v37 offset:33280
  ds_read_b128 a[228:231], v21 offset:4096
  buffer_load_dwordx4 v19, s[24:27], s21 offen offset:3072 lds
  s_mov_b32 s4, 1597440
  s_add_u32 m0, s67, 16384
  s_waitcnt lgkmcnt(11)
  v_mfma_f32_32x32x16_bf16 v[176:191], a[160:163], a[224:227], v[176:191]
  ds_read_b64_tr_b16 a[188:189], v34 offset:38912
  ds_read_b64_tr_b16 a[190:191], v34 offset:40192
  ds_read_b64_tr_b16 a[192:193], v34 offset:38944
  v_mfma_f32_32x32x16_bf16 v[192:207], a[164:167], a[224:227], v[192:207]
  ds_read_b64_tr_b16 a[194:195], v34 offset:40224
  ds_read_b64_tr_b16 a[196:197], v34 offset:38976
  ds_read_b64_tr_b16 a[198:199], v34 offset:40256
  buffer_load_dwordx4 v24, s[28:31], s4 offen offset:0 lds
  s_waitcnt lgkmcnt(13)
  v_mfma_f32_32x32x16_bf16 v[208:223], a[168:171], a[224:227], v[208:223]
  ds_read_b64_tr_b16 a[200:201], v34 offset:39008
  ds_read_b64_tr_b16 a[202:203], v34 offset:40288
  v_mfma_f32_32x32x16_bf16 v[224:239], a[172:175], a[224:227], v[224:239]
  ds_read_b64_tr_b16 a[204:205], v34 offset:39040
  ds_read_b64_tr_b16 a[206:207], v34 offset:40320
  buffer_load_dwordx4 v25, s[28:31], s4 offen offset:1024 lds
  s_waitcnt lgkmcnt(13)
  v_mfma_f32_32x32x16_bf16 v[240:255], a[176:179], a[224:227], v[240:255]
  ds_read_b64_tr_b16 a[208:209], v36 offset:34816
  ds_read_b64_tr_b16 a[210:211], v36 offset:35328
  v_mfma_f32_32x32x16_bf16 v[64:79], a[180:183], a[224:227], v[64:79]
  ds_read_b64_tr_b16 a[212:213], v37 offset:34816
  ds_read_b64_tr_b16 a[214:215], v37 offset:35328
  buffer_load_dwordx4 v26, s[28:31], s4 offen offset:2048 lds
  s_add_u32 m0, s12, 16384
  s_waitcnt lgkmcnt(15)
  v_mfma_f32_32x32x16_bf16 v[80:95], a[184:187], a[224:227], v[80:95]
  ds_read_b128 a[232:235], v22 offset:4096
  ds_read_b128 a[236:239], v23 offset:4096
  s_waitcnt lgkmcnt(12)
  v_mfma_f32_32x32x16_bf16 v[176:191], a[188:191], a[228:231], v[176:191]
  buffer_load_dwordx4 v29, s[28:31], s4 offen lds
  v_mfma_f32_32x32x16_bf16 v[192:207], a[192:195], a[228:231], v[192:207]
  s_waitcnt lgkmcnt(8)
  v_mfma_f32_32x32x16_bf16 v[208:223], a[196:199], a[228:231], v[208:223]
  s_waitcnt vmcnt(24) lgkmcnt(0)
  s_barrier
  ds_read_b64_tr_b16 a[160:161], v34 offset:49152
  ds_read_b64_tr_b16 a[162:163], v34 offset:50432
  ds_read_b64_tr_b16 a[164:165], v34 offset:49184
  s_mov_b32 s4, 1720320
  s_add_u32 m0, s67, 32768
  s_nop 0
  buffer_load_dwordx4 v24, s[28:31], s4 offen offset:0 lds
  v_mfma_f32_32x32x16_bf16 v[224:239], a[200:203], a[228:231], v[224:239]
  ds_read_b64_tr_b16 a[166:167], v34 offset:50464
  ds_read_b64_tr_b16 a[168:169], v34 offset:49216
  ds_read_b64_tr_b16 a[170:171], v34 offset:50496
  v_mfma_f32_32x32x16_bf16 v[240:255], a[204:207], a[228:231], v[240:255]
  ds_read_b64_tr_b16 a[172:173], v34 offset:49248
  ds_read_b64_tr_b16 a[174:175], v34 offset:50528
  ds_read_b64_tr_b16 a[176:177], v34 offset:49280
  buffer_load_dwordx4 v25, s[28:31], s4 offen offset:1024 lds
  v_mfma_f32_32x32x16_bf16 v[64:79], a[208:211], a[228:231], v[64:79]
  ds_read_b64_tr_b16 a[178:179], v34 offset:50560
  ds_read_b64_tr_b16 a[180:181], v36 offset:49152
  ds_read_b64_tr_b16 a[182:183], v36 offset:49664
  v_mfma_f32_32x32x16_bf16 v[80:95], a[212:215], a[228:231], v[80:95]
  ds_read_b64_tr_b16 a[184:185], v37 offset:49152
  ds_read_b64_tr_b16 a[186:187], v37 offset:49664
  buffer_load_dwordx4 v26, s[28:31], s4 offen offset:2048 lds
  s_add_u32 m0, s12, 32768
  s_waitcnt lgkmcnt(10)
  v_mfma_f32_32x32x16_bf16 v[176:191], a[160:163], a[232:235], v[176:191]
  ds_read_b64_tr_b16 a[188:189], v34 offset:55296
  ds_read_b64_tr_b16 a[190:191], v34 offset:56576
  v_mfma_f32_32x32x16_bf16 v[192:207], a[164:167], a[232:235], v[192:207]
  ds_read_b64_tr_b16 a[192:193], v34 offset:55328
  ds_read_b64_tr_b16 a[194:195], v34 offset:56608
  buffer_load_dwordx4 v29, s[28:31], s4 offen lds
  s_add_u32 m0, s66, 4096
  s_add_u32 s21, s65, 896
  s_waitcnt lgkmcnt(10)
  v_mfma_f32_32x32x16_bf16 v[208:223], a[168:171], a[232:235], v[208:223]
  ds_read_b64_tr_b16 a[196:197], v34 offset:55360
  ds_read_b64_tr_b16 a[198:199], v34 offset:56640
  v_mfma_f32_32x32x16_bf16 v[224:239], a[172:175], a[232:235], v[224:239]
  ds_read_b64_tr_b16 a[200:201], v34 offset:55392
  ds_read_b64_tr_b16 a[202:203], v34 offset:56672
  buffer_load_dwordx4 v16, s[24:27], s21 offen offset:0 lds
  s_waitcnt lgkmcnt(10)
  v_mfma_f32_32x32x16_bf16 v[240:255], a[176:179], a[232:235], v[240:255]
  ds_read_b64_tr_b16 a[204:205], v34 offset:55424
  ds_read_b64_tr_b16 a[206:207], v34 offset:56704
  v_mfma_f32_32x32x16_bf16 v[64:79], a[180:183], a[232:235], v[64:79]
  ds_read_b64_tr_b16 a[208:209], v36 offset:51200
  ds_read_b64_tr_b16 a[210:211], v36 offset:51712
  buffer_load_dwordx4 v17, s[24:27], s21 offen offset:1024 lds
  s_waitcnt lgkmcnt(12)
  v_mfma_f32_32x32x16_bf16 v[80:95], a[184:187], a[232:235], v[80:95]
  ds_read_b64_tr_b16 a[212:213], v37 offset:51200
  ds_read_b64_tr_b16 a[214:215], v37 offset:51712
  s_waitcnt lgkmcnt(10)
  v_mfma_f32_32x32x16_bf16 v[176:191], a[188:191], a[236:239], v[176:191]
  buffer_load_dwordx4 v18, s[24:27], s21 offen offset:2048 lds
  v_mfma_f32_32x32x16_bf16 v[192:207], a[192:195], a[236:239], v[192:207]
  s_waitcnt lgkmcnt(6)
  v_mfma_f32_32x32x16_bf16 v[208:223], a[196:199], a[236:239], v[208:223]
  s_waitcnt vmcnt(23) lgkmcnt(0)
  s_barrier
  ds_read_b128 a[240:243], v20 offset:8192
  ds_read_b64_tr_b16 a[160:161], v35 offset:0
  ds_read_b64_tr_b16 a[162:163], v35 offset:1280
  ds_read_b64_tr_b16 a[164:165], v35 offset:32
  buffer_load_dwordx4 v19, s[24:27], s21 offen offset:3072 lds
  s_mov_b32 s4, 1843200
  s_add_u32 m0, s67, 49152
  v_mfma_f32_32x32x16_bf16 v[224:239], a[200:203], a[236:239], v[224:239]
  ds_read_b64_tr_b16 a[166:167], v35 offset:1312
  ds_read_b64_tr_b16 a[168:169], v35 offset:64
  ds_read_b64_tr_b16 a[170:171], v35 offset:1344
  v_mfma_f32_32x32x16_bf16 v[240:255], a[204:207], a[236:239], v[240:255]
  ds_read_b64_tr_b16 a[172:173], v35 offset:96
  ds_read_b64_tr_b16 a[174:175], v35 offset:1376
  ds_read_b64_tr_b16 a[176:177], v35 offset:128
  buffer_load_dwordx4 v24, s[28:31], s4 offen offset:0 lds
  v_mfma_f32_32x32x16_bf16 v[64:79], a[208:211], a[236:239], v[64:79]
  ds_read_b64_tr_b16 a[178:179], v35 offset:1408
  ds_read_b64_tr_b16 a[180:181], v38 offset:0
  ds_read_b64_tr_b16 a[182:183], v38 offset:512
  v_mfma_f32_32x32x16_bf16 v[80:95], a[212:215], a[236:239], v[80:95]
  ds_read_b64_tr_b16 a[184:185], v39 offset:0
  ds_read_b64_tr_b16 a[186:187], v39 offset:512
  ds_read_b128 a[244:247], v21 offset:8192
  buffer_load_dwordx4 v25, s[28:31], s4 offen offset:1024 lds
  s_waitcnt lgkmcnt(11)
  v_mfma_f32_32x32x16_bf16 v[176:191], a[160:163], a[240:243], v[176:191]
  ds_read_b64_tr_b16 a[188:189], v35 offset:6144
  ds_read_b64_tr_b16 a[190:191], v35 offset:7424
  ds_read_b64_tr_b16 a[192:193], v35 offset:6176
  v_mfma_f32_32x32x16_bf16 v[192:207], a[164:167], a[240:243], v[192:207]
  ds_read_b64_tr_b16 a[194:195], v35 offset:7456
  ds_read_b64_tr_b16 a[196:197], v35 offset:6208
  ds_read_b64_tr_b16 a[198:199], v35 offset:7488
  buffer_load_dwordx4 v26, s[28:31], s4 offen offset:2048 lds
  s_add_u32 m0, s12, 49152
  s_waitcnt lgkmcnt(13)
  v_mfma_f32_32x32x16_bf16 v[208:223], a[168:171], a[240:243], v[208:223]
  ds_read_b64_tr_b16 a[200:201], v35 offset:6240
  ds_read_b64_tr_b16 a[202:203], v35 offset:7520
  v_mfma_f32_32x32x16_bf16 v[224:239], a[172:175], a[240:243], v[224:239]
  ds_read_b64_tr_b16 a[204:205], v35 offset:6272
  ds_read_b64_tr_b16 a[206:207], v35 offset:7552
  buffer_load_dwordx4 v29, s[28:31], s4 offen lds
  s_waitcnt lgkmcnt(13)
  v_mfma_f32_32x32x16_bf16 v[240:255], a[176:179], a[240:243], v[240:255]
  ds_read_b64_tr_b16 a[208:209], v38 offset:2048
  ds_read_b64_tr_b16 a[210:211], v38 offset:2560
  v_mfma_f32_32x32x16_bf16 v[64:79], a[180:183], a[240:243], v[64:79]
  ds_read_b64_tr_b16 a[212:213], v39 offset:2048
  ds_read_b64_tr_b16 a[214:215], v39 offset:2560
  s_waitcnt lgkmcnt(15)
  v_mfma_f32_32x32x16_bf16 v[80:95], a[184:187], a[240:243], v[80:95]
  ds_read_b128 a[248:251], v22 offset:8192
  ds_read_b128 a[252:255], v23 offset:8192
  s_waitcnt lgkmcnt(12)
  v_mfma_f32_32x32x16_bf16 v[176:191], a[188:191], a[244:247], v[176:191]
  v_mfma_f32_32x32x16_bf16 v[192:207], a[192:195], a[244:247], v[192:207]
  s_waitcnt lgkmcnt(8)
  v_mfma_f32_32x32x16_bf16 v[208:223], a[196:199], a[244:247], v[208:223]
  s_waitcnt vmcnt(24) lgkmcnt(0)
  s_barrier
  ds_read_b64_tr_b16 a[160:161], v35 offset:16384
  ds_read_b64_tr_b16 a[162:163], v35 offset:17664
  ds_read_b64_tr_b16 a[164:165], v35 offset:16416
  s_mov_b32 s4, 1966080
  s_add_u32 m0, s67, 65536
  s_nop 0
  buffer_load_dwordx4 v24, s[28:31], s4 offen offset:0 lds
  v_mfma_f32_32x32x16_bf16 v[224:239], a[200:203], a[244:247], v[224:239]
  ds_read_b64_tr_b16 a[166:167], v35 offset:17696
  ds_read_b64_tr_b16 a[168:169], v35 offset:16448
  ds_read_b64_tr_b16 a[170:171], v35 offset:17728
  buffer_load_dwordx4 v25, s[28:31], s4 offen offset:1024 lds
  v_mfma_f32_32x32x16_bf16 v[240:255], a[204:207], a[244:247], v[240:255]
  ds_read_b64_tr_b16 a[172:173], v35 offset:16480
  ds_read_b64_tr_b16 a[174:175], v35 offset:17760
  ds_read_b64_tr_b16 a[176:177], v35 offset:16512
  v_mfma_f32_32x32x16_bf16 v[64:79], a[208:211], a[244:247], v[64:79]
  ds_read_b64_tr_b16 a[178:179], v35 offset:17792
  ds_read_b64_tr_b16 a[180:181], v38 offset:16384
  ds_read_b64_tr_b16 a[182:183], v38 offset:16896
  buffer_load_dwordx4 v26, s[28:31], s4 offen offset:2048 lds
  s_add_u32 m0, s12, 65536
  v_mfma_f32_32x32x16_bf16 v[80:95], a[212:215], a[244:247], v[80:95]
  ds_read_b64_tr_b16 a[184:185], v39 offset:16384
  ds_read_b64_tr_b16 a[186:187], v39 offset:16896
  s_waitcnt lgkmcnt(10)
  v_mfma_f32_32x32x16_bf16 v[176:191], a[160:163], a[248:251], v[176:191]
  ds_read_b64_tr_b16 a[188:189], v35 offset:22528
  ds_read_b64_tr_b16 a[190:191], v35 offset:23808
  buffer_load_dwordx4 v29, s[28:31], s4 offen lds
  s_add_u32 m0, s66, 8192
  s_add_u32 s21, s65, 1024
  v_mfma_f32_32x32x16_bf16 v[192:207], a[164:167], a[248:251], v[192:207]
  ds_read_b64_tr_b16 a[192:193], v35 offset:22560
  ds_read_b64_tr_b16 a[194:195], v35 offset:23840
  s_waitcnt lgkmcnt(10)
  v_mfma_f32_32x32x16_bf16 v[208:223], a[168:171], a[248:251], v[208:223]
  ds_read_b64_tr_b16 a[196:197], v35 offset:22592
  ds_read_b64_tr_b16 a[198:199], v35 offset:23872
  buffer_load_dwordx4 v16, s[24:27], s21 offen offset:0 lds
  v_mfma_f32_32x32x16_bf16 v[224:239], a[172:175], a[248:251], v[224:239]
  ds_read_b64_tr_b16 a[200:201], v35 offset:22624
  ds_read_b64_tr_b16 a[202:203], v35 offset:23904
  s_waitcnt lgkmcnt(10)
  v_mfma_f32_32x32x16_bf16 v[240:255], a[176:179], a[248:251], v[240:255]
  ds_read_b64_tr_b16 a[204:205], v35 offset:22656
  ds_read_b64_tr_b16 a[206:207], v35 offset:23936
  buffer_load_dwordx4 v17, s[24:27], s21 offen offset:1024 lds
  v_mfma_f32_32x32x16_bf16 v[64:79], a[180:183], a[248:251], v[64:79]
  ds_read_b64_tr_b16 a[208:209], v38 offset:18432
  ds_read_b64_tr_b16 a[210:211], v38 offset:18944
  s_waitcnt lgkmcnt(12)
  v_mfma_f32_32x32x16_bf16 v[80:95], a[184:187], a[248:251], v[80:95]
  ds_read_b64_tr_b16 a[212:213], v39 offset:18432
  ds_read_b64_tr_b16 a[214:215], v39 offset:18944
  buffer_load_dwordx4 v18, s[24:27], s21 offen offset:2048 lds
  s_waitcnt lgkmcnt(10)
  v_mfma_f32_32x32x16_bf16 v[176:191], a[188:191], a[252:255], v[176:191]
  v_mfma_f32_32x32x16_bf16 v[192:207], a[192:195], a[252:255], v[192:207]
  buffer_load_dwordx4 v19, s[24:27], s21 offen offset:3072 lds
  s_waitcnt lgkmcnt(6)
  v_mfma_f32_32x32x16_bf16 v[208:223], a[196:199], a[252:255], v[208:223]
  s_waitcnt vmcnt(24) lgkmcnt(0)
  s_barrier
  ds_read_b128 a[224:227], v20 offset:0
  ds_read_b64_tr_b16 a[160:161], v34 offset:0
  ds_read_b64_tr_b16 a[162:163], v34 offset:1280
  ds_read_b64_tr_b16 a[164:165], v34 offset:32
  v_mfma_f32_32x32x16_bf16 v[224:239], a[200:203], a[252:255], v[224:239]
  ds_read_b64_tr_b16 a[166:167], v34 offset:1312
  ds_read_b64_tr_b16 a[168:169], v34 offset:64
  ds_read_b64_tr_b16 a[170:171], v34 offset:1344
  s_mov_b32 s4, 2088960
  s_add_u32 m0, s67, 81920
  s_nop 0
  buffer_load_dwordx4 v24, s[28:31], s4 offen offset:0 lds
  v_mfma_f32_32x32x16_bf16 v[240:255], a[204:207], a[252:255], v[240:255]
  ds_read_b64_tr_b16 a[172:173], v34 offset:96
  ds_read_b64_tr_b16 a[174:175], v34 offset:1376
  ds_read_b64_tr_b16 a[176:177], v34 offset:128
  v_mfma_f32_32x32x16_bf16 v[64:79], a[208:211], a[252:255], v[64:79]
  ds_read_b64_tr_b16 a[178:179], v34 offset:1408
  ds_read_b64_tr_b16 a[180:181], v36 offset:0
  ds_read_b64_tr_b16 a[182:183], v36 offset:512
  buffer_load_dwordx4 v25, s[28:31], s4 offen offset:1024 lds
  v_mfma_f32_32x32x16_bf16 v[80:95], a[212:215], a[252:255], v[80:95]
  ds_read_b64_tr_b16 a[184:185], v37 offset:0
  ds_read_b64_tr_b16 a[186:187], v37 offset:512
  ds_read_b128 a[228:231], v21 offset:0
  s_waitcnt lgkmcnt(11)
  v_mfma_f32_32x32x16_bf16 v[176:191], a[160:163], a[224:227], v[176:191]
  ds_read_b64_tr_b16 a[188:189], v34 offset:6144
  ds_read_b64_tr_b16 a[190:191], v34 offset:7424
  ds_read_b64_tr_b16 a[192:193], v34 offset:6176
  buffer_load_dwordx4 v26, s[28:31], s4 offen offset:2048 lds
  s_add_u32 m0, s12, 81920
  v_mfma_f32_32x32x16_bf16 v[192:207], a[164:167], a[224:227], v[192:207]
  ds_read_b64_tr_b16 a[194:195], v34 offset:7456
  ds_read_b64_tr_b16 a[196:197], v34 offset:6208
  ds_read_b64_tr_b16 a[198:199], v34 offset:7488
  s_waitcnt lgkmcnt(13)
  v_mfma_f32_32x32x16_bf16 v[208:223], a[168:171], a[224:227], v[208:223]
  ds_read_b64_tr_b16 a[200:201], v34 offset:6240
  ds_read_b64_tr_b16 a[202:203], v34 offset:7520
  buffer_load_dwordx4 v29, s[28:31], s4 offen lds
  v_mfma_f32_32x32x16_bf16 v[224:239], a[172:175], a[224:227], v[224:239]
  ds_read_b64_tr_b16 a[204:205], v34 offset:6272
  ds_read_b64_tr_b16 a[206:207], v34 offset:7552
  s_waitcnt lgkmcnt(13)
  v_mfma_f32_32x32x16_bf16 v[240:255], a[176:179], a[224:227], v[240:255]
  ds_read_b64_tr_b16 a[208:209], v36 offset:2048
  ds_read_b64_tr_b16 a[210:211], v36 offset:2560
  v_mfma_f32_32x32x16_bf16 v[64:79], a[180:183], a[224:227], v[64:79]
  ds_read_b64_tr_b16 a[212:213], v37 offset:2048
  ds_read_b64_tr_b16 a[214:215], v37 offset:2560
  s_waitcnt lgkmcnt(15)
  v_mfma_f32_32x32x16_bf16 v[80:95], a[184:187], a[224:227], v[80:95]
  ds_read_b128 a[232:235], v22 offset:0
  ds_read_b128 a[236:239], v23 offset:0
  s_waitcnt lgkmcnt(12)
  v_mfma_f32_32x32x16_bf16 v[176:191], a[188:191], a[228:231], v[176:191]
  v_mfma_f32_32x32x16_bf16 v[192:207], a[192:195], a[228:231], v[192:207]
  s_waitcnt lgkmcnt(8)
  v_mfma_f32_32x32x16_bf16 v[208:223], a[196:199], a[228:231], v[208:223]
  s_waitcnt vmcnt(24) lgkmcnt(0)
  s_barrier
  ds_read_b64_tr_b16 a[160:161], v34 offset:16384
  ds_read_b64_tr_b16 a[162:163], v34 offset:17664
  ds_read_b64_tr_b16 a[164:165], v34 offset:16416
  s_mov_b32 s4, 2211840
  s_add_u32 m0, s67, 0
  s_nop 0
  buffer_load_dwordx4 v24, s[28:31], s4 offen offset:0 lds
  v_mfma_f32_32x32x16_bf16 v[224:239], a[200:203], a[228:231], v[224:239]
  ds_read_b64_tr_b16 a[166:167], v34 offset:17696
  ds_read_b64_tr_b16 a[168:169], v34 offset:16448
  ds_read_b64_tr_b16 a[170:171], v34 offset:17728
  buffer_load_dwordx4 v25, s[28:31], s4 offen offset:1024 lds
  v_mfma_f32_32x32x16_bf16 v[240:255], a[204:207], a[228:231], v[240:255]
  ds_read_b64_tr_b16 a[172:173], v34 offset:16480
  ds_read_b64_tr_b16 a[174:175], v34 offset:17760
  ds_read_b64_tr_b16 a[176:177], v34 offset:16512
  v_mfma_f32_32x32x16_bf16 v[64:79], a[208:211], a[228:231], v[64:79]
  ds_read_b64_tr_b16 a[178:179], v34 offset:17792
  ds_read_b64_tr_b16 a[180:181], v36 offset:16384
  ds_read_b64_tr_b16 a[182:183], v36 offset:16896
  buffer_load_dwordx4 v26, s[28:31], s4 offen offset:2048 lds
  s_add_u32 m0, s12, 0
  v_mfma_f32_32x32x16_bf16 v[80:95], a[212:215], a[228:231], v[80:95]
  ds_read_b64_tr_b16 a[184:185], v37 offset:16384
  ds_read_b64_tr_b16 a[186:187], v37 offset:16896
  s_waitcnt lgkmcnt(10)
  v_mfma_f32_32x32x16_bf16 v[176:191], a[160:163], a[232:235], v[176:191]
  ds_read_b64_tr_b16 a[188:189], v34 offset:22528
  ds_read_b64_tr_b16 a[190:191], v34 offset:23808
  buffer_load_dwordx4 v29, s[28:31], s4 offen lds
  s_add_u32 m0, s66, 0
  s_add_u32 s21, s65, 1152
  v_mfma_f32_32x32x16_bf16 v[192:207], a[164:167], a[232:235], v[192:207]
  ds_read_b64_tr_b16 a[192:193], v34 offset:22560
  ds_read_b64_tr_b16 a[194:195], v34 offset:23840
  s_waitcnt lgkmcnt(10)
  v_mfma_f32_32x32x16_bf16 v[208:223], a[168:171], a[232:235], v[208:223]
  ds_read_b64_tr_b16 a[196:197], v34 offset:22592
  ds_read_b64_tr_b16 a[198:199], v34 offset:23872
  buffer_load_dwordx4 v16, s[24:27], s21 offen offset:0 lds
  v_mfma_f32_32x32x16_bf16 v[224:239], a[172:175], a[232:235], v[224:239]
  ds_read_b64_tr_b16 a[200:201], v34 offset:22624
  ds_read_b64_tr_b16 a[202:203], v34 offset:23904
  s_waitcnt lgkmcnt(10)
  v_mfma_f32_32x32x16_bf16 v[240:255], a[176:179], a[232:235], v[240:255]
  ds_read_b64_tr_b16 a[204:205], v34 offset:22656
  ds_read_b64_tr_b16 a[206:207], v34 offset:23936
  buffer_load_dwordx4 v17, s[24:27], s21 offen offset:1024 lds
  v_mfma_f32_32x32x16_bf16 v[64:79], a[180:183], a[232:235], v[64:79]
  ds_read_b64_tr_b16 a[208:209], v36 offset:18432
  ds_read_b64_tr_b16 a[210:211], v36 offset:18944
  s_waitcnt lgkmcnt(12)
  v_mfma_f32_32x32x16_bf16 v[80:95], a[184:187], a[232:235], v[80:95]
  ds_read_b64_tr_b16 a[212:213], v37 offset:18432
  ds_read_b64_tr_b16 a[214:215], v37 offset:18944
  buffer_load_dwordx4 v18, s[24:27], s21 offen offset:2048 lds
  s_waitcnt lgkmcnt(10)
  v_mfma_f32_32x32x16_bf16 v[176:191], a[188:191], a[236:239], v[176:191]
  v_mfma_f32_32x32x16_bf16 v[192:207], a[192:195], a[236:239], v[192:207]
  buffer_load_dwordx4 v19, s[24:27], s21 offen offset:3072 lds
  s_waitcnt lgkmcnt(6)
  v_mfma_f32_32x32x16_bf16 v[208:223], a[196:199], a[236:239], v[208:223]
  s_waitcnt vmcnt(24) lgkmcnt(0)
  s_barrier
  ds_read_b128 a[240:243], v20 offset:4096
  ds_read_b64_tr_b16 a[160:161], v34 offset:32768
  ds_read_b64_tr_b16 a[162:163], v34 offset:34048
  ds_read_b64_tr_b16 a[164:165], v34 offset:32800
  v_mfma_f32_32x32x16_bf16 v[224:239], a[200:203], a[236:239], v[224:239]
  ds_read_b64_tr_b16 a[166:167], v34 offset:34080
  ds_read_b64_tr_b16 a[168:169], v34 offset:32832
  ds_read_b64_tr_b16 a[170:171], v34 offset:34112
  s_mov_b32 s4, 2334720
  s_add_u32 m0, s67, 16384
  s_nop 0
  buffer_load_dwordx4 v24, s[28:31], s4 offen offset:0 lds
  v_mfma_f32_32x32x16_bf16 v[240:255], a[204:207], a[236:239], v[240:255]
  ds_read_b64_tr_b16 a[172:173], v34 offset:32864
  ds_read_b64_tr_b16 a[174:175], v34 offset:34144
  ds_read_b64_tr_b16 a[176:177], v34 offset:32896
  v_mfma_f32_32x32x16_bf16 v[64:79], a[208:211], a[236:239], v[64:79]
  ds_read_b64_tr_b16 a[178:179], v34 offset:34176
  ds_read_b64_tr_b16 a[180:181], v36 offset:32768
  ds_read_b64_tr_b16 a[182:183], v36 offset:33280
  buffer_load_dwordx4 v25, s[28:31], s4 offen offset:1024 lds
  v_mfma_f32_32x32x16_bf16 v[80:95], a[212:215], a[236:239], v[80:95]
  ds_read_b64_tr_b16 a[184:185], v37 offset:32768
  ds_read_b64_tr_b16 a[186:187], v37 offset:33280
  ds_read_b128 a[244:247], v21 offset:4096
  s_waitcnt lgkmcnt(11)
  v_mfma_f32_32x32x16_bf16 v[176:191], a[160:163], a[240:243], v[176:191]
  ds_read_b64_tr_b16 a[188:189], v34 offset:38912
  ds_read_b64_tr_b16 a[190:191], v34 offset:40192
  ds_read_b64_tr_b16 a[192:193], v34 offset:38944
  buffer_load_dwordx4 v26, s[28:31], s4 offen offset:2048 lds
  s_add_u32 m0, s12, 16384
  v_mfma_f32_32x32x16_bf16 v[192:207], a[164:167], a[240:243], v[192:207]
  ds_read_b64_tr_b16 a[194:195], v34 offset:40224
  ds_read_b64_tr_b16 a[196:197], v34 offset:38976
  ds_read_b64_tr_b16 a[198:199], v34 offset:40256
  s_waitcnt lgkmcnt(13)
  v_mfma_f32_32x32x16_bf16 v[208:223], a[168:171], a[240:243], v[208:223]
  ds_read_b64_tr_b16 a[200:201], v34 offset:39008
  ds_read_b64_tr_b16 a[202:203], v34 offset:40288
  buffer_load_dwordx4 v29, s[28:31], s4 offen lds
  v_mfma_f32_32x32x16_bf16 v[224:239], a[172:175], a[240:243], v[224:239]
  ds_read_b64_tr_b16 a[204:205], v34 offset:39040
  ds_read_b64_tr_b16 a[206:207], v34 offset:40320
  s_waitcnt lgkmcnt(13)
  v_mfma_f32_32x32x16_bf16 v[240:255], a[176:179], a[240:243], v[240:255]
  ds_read_b64_tr_b16 a[208:209], v36 offset:34816
  ds_read_b64_tr_b16 a[210:211], v36 offset:35328
  v_lshrrev_b32 v1, 5, v0
  v_mfma_f32_32x32x16_bf16 v[64:79], a[180:183], a[240:243], v[64:79]
  ds_read_b64_tr_b16 a[212:213], v37 offset:34816
  ds_read_b64_tr_b16 a[214:215], v37 offset:35328
  v_bfe_u32 v2, v0, 2, 2
  v_and_b32 v3, 1, v0
  s_waitcnt lgkmcnt(15)
  v_mfma_f32_32x32x16_bf16 v[80:95], a[184:187], a[240:243], v[80:95]
  ds_read_b128 a[248:251], v22 offset:4096
  ds_read_b128 a[252:255], v23 offset:4096
  v_bfe_u32 v4, v0, 1, 1
  s_waitcnt lgkmcnt(12)
  v_mfma_f32_32x32x16_bf16 v[176:191], a[188:191], a[244:247], v[176:191]
  v_bfe_u32 v5, v0, 4, 1
  v_lshl_add_u32 v4, v5, 1, v4
  v_mfma_f32_32x32x16_bf16 v[192:207], a[192:195], a[244:247], v[192:207]
  v_lshl_add_u32 v6, v1, 3, v2
  s_waitcnt lgkmcnt(8)
  v_mfma_f32_32x32x16_bf16 v[208:223], a[196:199], a[244:247], v[208:223]
  v_mul_u32_u24 v7, 1920, v3
  v_add_u32 v7, 157312, v7
  s_waitcnt vmcnt(24) lgkmcnt(0)
  s_barrier
  ds_read_b64_tr_b16 a[160:161], v34 offset:49152
  ds_read_b64_tr_b16 a[162:163], v34 offset:50432
  ds_read_b64_tr_b16 a[164:165], v34 offset:49184
  v_mfma_f32_32x32x16_bf16 v[224:239], a[200:203], a[244:247], v[224:239]
  ds_read_b64_tr_b16 a[166:167], v34 offset:50464
  ds_read_b64_tr_b16 a[168:169], v34 offset:49216
  ds_read_b64_tr_b16 a[170:171], v34 offset:50496
  v_mov_b32 v5, 155392
  v_mfma_f32_32x32x16_bf16 v[240:255], a[204:207], a[244:247], v[240:255]
  ds_read_b64_tr_b16 a[172:173], v34 offset:49248
  ds_read_b64_tr_b16 a[174:175], v34 offset:50528
  ds_read_b64_tr_b16 a[176:177], v34 offset:49280
  v_cmp_eq_u32 vcc, v1, v3
  s_nop 1
  v_cndmask_b32 v7, v5, v7, vcc
  v_mfma_f32_32x32x16_bf16 v[64:79], a[208:211], a[244:247], v[64:79]
  ds_read_b64_tr_b16 a[178:179], v34 offset:50560
  ds_read_b64_tr_b16 a[180:181], v36 offset:49152
  ds_read_b64_tr_b16 a[182:183], v36 offset:49664
  v_mul_u32_u24 v5, 40, v2
  v_mfma_f32_32x32x16_bf16 v[80:95], a[212:215], a[244:247], v[80:95]
  ds_read_b64_tr_b16 a[184:185], v37 offset:49152
  ds_read_b64_tr_b16 a[186:187], v37 offset:49664
  v_add_u32 v7, v7, v5
  v_lshl_add_u32 v6, v4, 3, v7
  s_waitcnt lgkmcnt(10)
  v_mfma_f32_32x32x16_bf16 v[176:191], a[160:163], a[248:251], v[176:191]
  ds_read_b64_tr_b16 a[188:189], v34 offset:55296
  ds_read_b64_tr_b16 a[190:191], v34 offset:56576
  v_add_u32 v7, 32, v7
  v_mfma_f32_32x32x16_bf16 v[192:207], a[164:167], a[248:251], v[192:207]
  ds_read_b64_tr_b16 a[192:193], v34 offset:55328
  ds_read_b64_tr_b16 a[194:195], v34 offset:56608
  s_lshl_b32 s13, s61, 11
  s_add_u32 s13, s13, s6
  s_waitcnt lgkmcnt(10)
  v_mfma_f32_32x32x16_bf16 v[208:223], a[168:171], a[248:251], v[208:223]
  ds_read_b64_tr_b16 a[196:197], v34 offset:55360
  ds_read_b64_tr_b16 a[198:199], v34 offset:56640
  s_add_u32 s13, s13, 75776
  v_mfma_f32_32x32x16_bf16 v[224:239], a[172:175], a[248:251], v[224:239]
  ds_read_b64_tr_b16 a[200:201], v34 offset:55392
  ds_read_b64_tr_b16 a[202:203], v34 offset:56672
  ds_read_b64_tr_b16 a[0:1], v6 offset:0
  ds_read_b64_tr_b16 a[2:3], v6 offset:160
  s_waitcnt lgkmcnt(12)
  v_mfma_f32_32x32x16_bf16 v[240:255], a[176:179], a[248:251], v[240:255]
  ds_read_b64_tr_b16 a[204:205], v34 offset:55424
  ds_read_b64_tr_b16 a[206:207], v34 offset:56704
  ds_read_b64_tr_b16 a[4:5], v7 offset:0
  v_mfma_f32_32x32x16_bf16 v[64:79], a[180:183], a[248:251], v[64:79]
  ds_read_b64_tr_b16 a[208:209], v36 offset:51200
  ds_read_b64_tr_b16 a[210:211], v36 offset:51712
  ds_read_b64_tr_b16 a[6:7], v7 offset:160
  ds_read_b64_tr_b16 a[8:9], v6 offset:320
  s_waitcnt lgkmcnt(15)
  v_mfma_f32_32x32x16_bf16 v[80:95], a[184:187], a[248:251], v[80:95]
  ds_read_b64_tr_b16 a[212:213], v37 offset:51200
  ds_read_b64_tr_b16 a[214:215], v37 offset:51712
  ds_read_b64_tr_b16 a[10:11], v6 offset:480
  s_waitcnt lgkmcnt(15)
  v_mfma_f32_32x32x16_bf16 v[176:191], a[188:191], a[252:255], v[176:191]
  ds_read_b64_tr_b16 a[12:13], v7 offset:320
  ds_read_b64_tr_b16 a[14:15], v7 offset:480
  v_mfma_f32_32x32x16_bf16 v[192:207], a[192:195], a[252:255], v[192:207]
  ds_read_b64_tr_b16 a[16:17], v6 offset:640
  s_waitcnt lgkmcnt(15)
  v_mfma_f32_32x32x16_bf16 v[208:223], a[196:199], a[252:255], v[208:223]
  ds_read_b64_tr_b16 a[18:19], v6 offset:800
  ds_read_b64_tr_b16 a[20:21], v7 offset:640
  s_waitcnt vmcnt(16) lgkmcnt(0)
  s_barrier
  buffer_load_dword v10, v11, s[36:39], 0 offen sc1
  ds_read_b128 a[224:227], v20 offset:8192
  ds_read_b64_tr_b16 a[160:161], v35 offset:0
  ds_read_b64_tr_b16 a[162:163], v35 offset:1280
  ds_read_b64_tr_b16 a[164:165], v35 offset:32
  v_mfma_f32_32x32x16_bf16 v[224:239], a[200:203], a[252:255], v[224:239]
  ds_read_b64_tr_b16 a[166:167], v35 offset:1312
  ds_read_b64_tr_b16 a[168:169], v35 offset:64
  ds_read_b64_tr_b16 a[170:171], v35 offset:1344
  ds_read_b64_tr_b16 a[22:23], v7 offset:800
  v_mfma_f32_32x32x16_bf16 v[240:255], a[204:207], a[252:255], v[240:255]
  ds_read_b64_tr_b16 a[172:173], v35 offset:96
  ds_read_b64_tr_b16 a[174:175], v35 offset:1376
  ds_read_b64_tr_b16 a[176:177], v35 offset:128
  ds_read_b64_tr_b16 a[24:25], v6 offset:960
  ds_read_b64_tr_b16 a[26:27], v6 offset:1120
  v_mfma_f32_32x32x16_bf16 v[64:79], a[208:211], a[252:255], v[64:79]
  ds_read_b64_tr_b16 a[178:179], v35 offset:1408
  ds_read_b64_tr_b16 a[180:181], v38 offset:0
  ds_read_b64_tr_b16 a[182:183], v38 offset:512
  ds_read_b64_tr_b16 a[28:29], v7 offset:960
  v_mfma_f32_32x32x16_bf16 v[80:95], a[212:215], a[252:255], v[80:95]
  ds_read_b64_tr_b16 a[184:185], v39 offset:0
  ds_read_b64_tr_b16 a[186:187], v39 offset:512
  ds_read_b128 a[228:231], v21 offset:8192
  ds_read_b64_tr_b16 a[30:31], v7 offset:1120
  ds_read_b64_tr_b16 a[32:33], v6 offset:1280
  s_waitcnt lgkmcnt(15)
  v_mfma_f32_32x32x16_bf16 v[176:191], a[160:163], a[224:227], v[176:191]
  ds_read_b64_tr_b16 a[188:189], v35 offset:6144
  ds_read_b64_tr_b16 a[190:191], v35 offset:7424
  ds_read_b64_tr_b16 a[192:193], v35 offset:6176
  ds_read_b64_tr_b16 a[34:35], v6 offset:1440
  v_mfma_f32_32x32x16_bf16 v[192:207], a[164:167], a[224:227], v[192:207]
  ds_read_b64_tr_b16 a[194:195], v35 offset:7456
  ds_read_b64_tr_b16 a[196:197], v35 offset:6208
  ds_read_b64_tr_b16 a[198:199], v35 offset:7488
  ds_read_b64_tr_b16 a[36:37], v7 offset:1280
  ds_read_b64_tr_b16 a[38:39], v7 offset:1440
  s_waitcnt lgkmcnt(15)
  v_mfma_f32_32x32x16_bf16 v[208:223], a[168:171], a[224:227], v[208:223]
  ds_read_b64_tr_b16 a[200:201], v35 offset:6240
  ds_read_b64_tr_b16 a[202:203], v35 offset:7520
  ds_read_b64_tr_b16 a[40:41], v6 offset:1600
  v_mfma_f32_32x32x16_bf16 v[224:239], a[172:175], a[224:227], v[224:239]
  ds_read_b64_tr_b16 a[204:205], v35 offset:6272
  ds_read_b64_tr_b16 a[206:207], v35 offset:7552
  ds_read_b64_tr_b16 a[42:43], v6 offset:1760
  ds_read_b64_tr_b16 a[44:45], v7 offset:1600
  v_mfma_f32_32x32x16_bf16 v[240:255], a[176:179], a[224:227], v[240:255]
  ds_read_b64_tr_b16 a[208:209], v38 offset:2048
  ds_read_b64_tr_b16 a[210:211], v38 offset:2560
  ds_read_b64_tr_b16 a[46:47], v7 offset:1760
  v_mfma_f32_32x32x16_bf16 v[64:79], a[180:183], a[224:227], v[64:79]
  ds_read_b64_tr_b16 a[212:213], v39 offset:2048
  ds_read_b64_tr_b16 a[214:215], v39 offset:2560
  s_waitcnt lgkmcnt(15)
  v_mfma_f32_32x32x16_bf16 v[80:95], a[184:187], a[224:227], v[80:95]
  ds_read_b128 a[232:235], v22 offset:8192
  ds_read_b128 a[236:239], v23 offset:8192
  v_mfma_f32_32x32x16_bf16 v[176:191], a[188:191], a[228:231], v[176:191]
  v_mfma_f32_32x32x16_bf16 v[192:207], a[192:195], a[228:231], v[192:207]
  s_waitcnt lgkmcnt(12)
  v_mfma_f32_32x32x16_bf16 v[208:223], a[196:199], a[228:231], v[208:223]
  s_waitcnt vmcnt(13) lgkmcnt(0)
  s_barrier
  ds_read_b64_tr_b16 a[160:161], v35 offset:16384
  ds_read_b64_tr_b16 a[162:163], v35 offset:17664
  ds_read_b64_tr_b16 a[164:165], v35 offset:16416
  v_mfma_f32_32x32x16_bf16 v[224:239], a[200:203], a[228:231], v[224:239]
  ds_read_b64_tr_b16 a[166:167], v35 offset:17696
  ds_read_b64_tr_b16 a[168:169], v35 offset:16448
  ds_read_b64_tr_b16 a[170:171], v35 offset:17728
  v_mfma_f32_32x32x16_bf16 v[240:255], a[204:207], a[228:231], v[240:255]
  ds_read_b64_tr_b16 a[172:173], v35 offset:16480
  ds_read_b64_tr_b16 a[174:175], v35 offset:17760
  ds_read_b64_tr_b16 a[176:177], v35 offset:16512
  v_mfma_f32_32x32x16_bf16 v[64:79], a[208:211], a[228:231], v[64:79]
  ds_read_b64_tr_b16 a[178:179], v35 offset:17792
  ds_read_b64_tr_b16 a[180:181], v38 offset:16384
  ds_read_b64_tr_b16 a[182:183], v38 offset:16896
  v_mfma_f32_32x32x16_bf16 v[80:95], a[212:215], a[228:231], v[80:95]
  ds_read_b64_tr_b16 a[184:185], v39 offset:16384
  ds_read_b64_tr_b16 a[186:187], v39 offset:16896
  s_waitcnt lgkmcnt(10)
  v_mfma_f32_32x32x16_bf16 v[176:191], a[160:163], a[232:235], v[176:191]
  ds_read_b64_tr_b16 a[188:189], v35 offset:22528
  ds_read_b64_tr_b16 a[190:191], v35 offset:23808
  v_mfma_f32_32x32x16_bf16 v[192:207], a[164:167], a[232:235], v[192:207]
  ds_read_b64_tr_b16 a[192:193], v35 offset:22560
  ds_read_b64_tr_b16 a[194:195], v35 offset:23840
  s_waitcnt lgkmcnt(10)
  v_mfma_f32_32x32x16_bf16 v[208:223], a[168:171], a[232:235], v[208:223]
  ds_read_b64_tr_b16 a[196:197], v35 offset:22592
  ds_read_b64_tr_b16 a[198:199], v35 offset:23872
  v_mfma_f32_32x32x16_bf16 v[224:239], a[172:175], a[232:235], v[224:239]
  ds_read_b64_tr_b16 a[200:201], v35 offset:22624
  ds_read_b64_tr_b16 a[202:203], v35 offset:23904
  s_waitcnt lgkmcnt(10)
  v_mfma_f32_32x32x16_bf16 v[240:255], a[176:179], a[232:235], v[240:255]
  ds_read_b64_tr_b16 a[204:205], v35 offset:22656
  ds_read_b64_tr_b16 a[206:207], v35 offset:23936
  v_mfma_f32_32x32x16_bf16 v[64:79], a[180:183], a[232:235], v[64:79]
  ds_read_b64_tr_b16 a[208:209], v38 offset:18432
  ds_read_b64_tr_b16 a[210:211], v38 offset:18944
  s_waitcnt lgkmcnt(12)
  v_mfma_f32_32x32x16_bf16 v[80:95], a[184:187], a[232:235], v[80:95]
  ds_read_b64_tr_b16 a[212:213], v39 offset:18432
  ds_read_b64_tr_b16 a[214:215], v39 offset:18944
  s_waitcnt lgkmcnt(10)
  v_mfma_f32_32x32x16_bf16 v[176:191], a[188:191], a[236:239], v[176:191]
  v_mfma_f32_32x32x16_bf16 v[192:207], a[192:195], a[236:239], v[192:207]
  s_waitcnt lgkmcnt(6)
  v_mfma_f32_32x32x16_bf16 v[208:223], a[196:199], a[236:239], v[208:223]
  s_add_u32 s18, s64, 1
  s_waitcnt vmcnt(0)
  v_subrev_u32 v14, s18, v10
  v_cmp_gt_u32_e64 s[100:101], 8, v14
  s_nop 0
  s_cmp_eq_u64 s[100:101], -1
  s_cbranch_scc0 f_spin1
f_back1:
  s_waitcnt lgkmcnt(0)
  s_barrier
  ds_read_b128 a[240:243], v20 offset:0
  ds_read_b64_tr_b16 a[160:161], v34 offset:0
  ds_read_b64_tr_b16 a[162:163], v34 offset:1280
  ds_read_b64_tr_b16 a[164:165], v34 offset:32
  s_lshl_b32 s18, s60, 2
  s_add_u32 s18, s18, s3
  s_lshl_b32 s18, s18, 8
  s_add_u32 s18, s18, 15859712
  v_and_b32 v14, 31, v0
  v_lshlrev_b32 v14, 3, v14
  buffer_load_dwordx2 v[52:53], v14, s[36:39], s18 offen sc1
  s_mul_i32 s18, s61, 1280
  s_add_u32 s18, s18, 15935488
  v_mfma_f32_32x32x16_bf16 v[224:239], a[200:203], a[236:239], v[224:239]
  ds_read_b64_tr_b16 a[166:167], v34 offset:1312
  ds_read_b64_tr_b16 a[168:169], v34 offset:64
  ds_read_b64_tr_b16 a[170:171], v34 offset:1344
  buffer_load_dwordx4 v[120:123], v40, s[36:39], s18 offen offset:0 sc1
  v_mfma_f32_32x32x16_bf16 v[240:255], a[204:207], a[236:239], v[240:255]
  ds_read_b64_tr_b16 a[172:173], v34 offset:96
  ds_read_b64_tr_b16 a[174:175], v34 offset:1376
  ds_read_b64_tr_b16 a[176:177], v34 offset:128
  v_mfma_f32_32x32x16_bf16 v[64:79], a[208:211], a[236:239], v[64:79]
  ds_read_b64_tr_b16 a[178:179], v34 offset:1408
  ds_read_b64_tr_b16 a[180:181], v36 offset:0
  ds_read_b64_tr_b16 a[182:183], v36 offset:512
  buffer_load_dwordx4 v[124:127], v40, s[36:39], s18 offen offset:256 sc1
  v_mfma_f32_32x32x16_bf16 v[80:95], a[212:215], a[236:239], v[80:95]
  ds_read_b64_tr_b16 a[184:185], v37 offset:0
  ds_read_b64_tr_b16 a[186:187], v37 offset:512
  ds_read_b128 a[244:247], v21 offset:0
  s_waitcnt lgkmcnt(11)
  v_mfma_f32_32x32x16_bf16 v[176:191], a[160:163], a[240:243], v[176:191]
  ds_read_b64_tr_b16 a[188:189], v34 offset:6144
  ds_read_b64_tr_b16 a[190:191], v34 offset:7424
  ds_read_b64_tr_b16 a[192:193], v34 offset:6176
  buffer_load_dwordx4 v[128:131], v41, s[36:39], s18 offen offset:512 sc1
  v_mfma_f32_32x32x16_bf16 v[192:207], a[164:167], a[240:243], v[192:207]
  ds_read_b64_tr_b16 a[194:195], v34 offset:7456
  ds_read_b64_tr_b16 a[196:197], v34 offset:6208
  ds_read_b64_tr_b16 a[198:199], v34 offset:7488
  buffer_load_dwordx4 v[132:135], v42, s[36:39], s18 offen offset:768 sc1
  s_waitcnt lgkmcnt(13)
  v_mfma_f32_32x32x16_bf16 v[208:223], a[168:171], a[240:243], v[208:223]
  ds_read_b64_tr_b16 a[200:201], v34 offset:6240
  ds_read_b64_tr_b16 a[202:203], v34 offset:7520
  buffer_load_dwordx4 v[136:139], v42, s[36:39], s18 offen offset:1024 sc1
  s_lshl_b32 s18, s61, 10
  s_add_u32 s18, s18, 15925248
  v_mfma_f32_32x32x16_bf16 v[224:239], a[172:175], a[240:243], v[224:239]
  ds_read_b64_tr_b16 a[204:205], v34 offset:6272
  ds_read_b64_tr_b16 a[206:207], v34 offset:7552
  buffer_load_dwordx4 v[56:59], v47, s[36:39], s18 offen offset:0 sc1
  s_waitcnt lgkmcnt(13)
  v_mfma_f32_32x32x16_bf16 v[240:255], a[176:179], a[240:243], v[240:255]
  ds_read_b64_tr_b16 a[208:209], v36 offset:2048
  ds_read_b64_tr_b16 a[210:211], v36 offset:2560
  buffer_load_dwordx4 v[60:63], v47, s[36:39], s18 offen offset:512 sc1
  s_add_u32 s22, s8, 102400
  v_mfma_f32_32x32x16_bf16 v[64:79], a[180:183], a[240:243], v[64:79]
  ds_read_b64_tr_b16 a[212:213], v37 offset:2048
  ds_read_b64_tr_b16 a[214:215], v37 offset:2560
  buffer_load_dwordx4 a[60:63], v12, s[36:39], s22 offen offset:0 sc1
  s_waitcnt lgkmcnt(15)
  v_mfma_f32_32x32x16_bf16 v[80:95], a[184:187], a[240:243], v[80:95]
  ds_read_b128 a[248:251], v22 offset:0
  ds_read_b128 a[252:255], v23 offset:0
  buffer_load_dwordx4 a[64:67], v12, s[36:39], s22 offen offset:1024 sc1
  s_waitcnt lgkmcnt(12)
  v_mfma_f32_32x32x16_bf16 v[176:191], a[188:191], a[244:247], v[176:191]
  buffer_load_dwordx4 a[68:71], v12, s[36:39], s22 offen offset:2048 sc1
  v_mfma_f32_32x32x16_bf16 v[192:207], a[192:195], a[244:247], v[192:207]
  buffer_load_dwordx4 a[72:75], v12, s[36:39], s22 offen offset:3072 sc1
  s_waitcnt lgkmcnt(8)
  v_mfma_f32_32x32x16_bf16 v[208:223], a[196:199], a[244:247], v[208:223]
  s_waitcnt lgkmcnt(0)
  s_barrier
  ds_read_b64_tr_b16 a[160:161], v34 offset:16384
  ds_read_b64_tr_b16 a[162:163], v34 offset:17664
  ds_read_b64_tr_b16 a[164:165], v34 offset:16416
  buffer_load_dwordx4 a[76:79], v13, s[36:39], s22 offen offset:0 sc1
  v_mfma_f32_32x32x16_bf16 v[224:239], a[200:203], a[244:247], v[224:239]
  ds_read_b64_tr_b16 a[166:167], v34 offset:17696
  ds_read_b64_tr_b16 a[168:169], v34 offset:16448
  ds_read_b64_tr_b16 a[170:171], v34 offset:17728
  v_mfma_f32_32x32x16_bf16 v[240:255], a[204:207], a[244:247], v[240:255]
  ds_read_b64_tr_b16 a[172:173], v34 offset:16480
  ds_read_b64_tr_b16 a[174:175], v34 offset:17760
  ds_read_b64_tr_b16 a[176:177], v34 offset:16512
  v_mfma_f32_32x32x16_bf16 v[64:79], a[208:211], a[244:247], v[64:79]
  ds_read_b64_tr_b16 a[178:179], v34 offset:17792
  ds_read_b64_tr_b16 a[180:181], v36 offset:16384
  ds_read_b64_tr_b16 a[182:183], v36 offset:16896
  v_mfma_f32_32x32x16_bf16 v[80:95], a[212:215], a[244:247], v[80:95]
  ds_read_b64_tr_b16 a[184:185], v37 offset:16384
  ds_read_b64_tr_b16 a[186:187], v37 offset:16896
  s_waitcnt lgkmcnt(10)
  v_mfma_f32_32x32x16_bf16 v[176:191], a[160:163], a[248:251], v[176:191]
  ds_read_b64_tr_b16 a[188:189], v34 offset:22528
  ds_read_b64_tr_b16 a[190:191], v34 offset:23808
  v_mfma_f32_32x32x16_bf16 v[192:207], a[164:167], a[248:251], v[192:207]
  ds_read_b64_tr_b16 a[192:193], v34 offset:22560
  ds_read_b64_tr_b16 a[194:195], v34 offset:23840
  s_waitcnt lgkmcnt(10)
  v_mfma_f32_32x32x16_bf16 v[208:223], a[168:171], a[248:251], v[208:223]
  ds_read_b64_tr_b16 a[196:197], v34 offset:22592
  ds_read_b64_tr_b16 a[198:199], v34 offset:23872
  v_mfma_f32_32x32x16_bf16 v[224:239], a[172:175], a[248:251], v[224:239]
  ds_read_b64_tr_b16 a[200:201], v34 offset:22624
  ds_read_b64_tr_b16 a[202:203], v34 offset:23904
  s_waitcnt lgkmcnt(10)
  v_mfma_f32_32x32x16_bf16 v[240:255], a[176:179], a[248:251], v[240:255]
  ds_read_b64_tr_b16 a[204:205], v34 offset:22656
  ds_read_b64_tr_b16 a[206:207], v34 offset:23936
  v_mfma_f32_32x32x16_bf16 v[64:79], a[180:183], a[248:251], v[64:79]
  ds_read_b64_tr_b16 a[208:209], v36 offset:18432
  ds_read_b64_tr_b16 a[210:211], v36 offset:18944
  s_waitcnt lgkmcnt(12)
  v_mfma_f32_32x32x16_bf16 v[80:95], a[184:187], a[248:251], v[80:95]
  ds_read_b64_tr_b16 a[212:213], v37 offset:18432
  ds_read_b64_tr_b16 a[214:215], v37 offset:18944
  s_waitcnt lgkmcnt(10)
  v_mfma_f32_32x32x16_bf16 v[176:191], a[188:191], a[252:255], v[176:191]
  v_mfma_f32_32x32x16_bf16 v[192:207], a[192:195], a[252:255], v[192:207]
  s_waitcnt lgkmcnt(6)
  v_mfma_f32_32x32x16_bf16 v[208:223], a[196:199], a[252:255], v[208:223]
  v_mfma_f32_32x32x16_bf16 v[224:239], a[200:203], a[252:255], v[224:239]
  s_waitcnt lgkmcnt(2)
  v_mfma_f32_32x32x16_bf16 v[240:255], a[204:207], a[252:255], v[240:255]
  v_mfma_f32_32x32x16_bf16 v[64:79], a[208:211], a[252:255], v[64:79]
  s_waitcnt lgkmcnt(0)
  v_mfma_f32_32x32x16_bf16 v[80:95], a[212:215], a[252:255], v[80:95]
  s_waitcnt vmcnt(12)
  v_rsq_f32 v46, v53
  v_sub_f32 v1, 0, v52
  v_mul_f32 v2, v53, v46
  v_mul_f32 v45, 0x3fb8aa3b, v46
  v_cvt_pk_bf16_f32 v49, v1, v2
  v_lshlrev_b32 v3, 16, v49
  v_and_b32 v4, 0xffff0000, v49
  v_sub_f32 v3, v1, v3
  v_sub_f32 v4, v2, v4
  s_add_u32 s22, s8, 122880
  buffer_load_dwordx4 a[80:83], v12, s[36:39], s22 offen offset:0 sc1
  v_cvt_pk_bf16_f32 v48, v1, v3
  v_cvt_pk_bf16_f32 v50, v4, 0
  v_mov_b32 v51, 0
  v_cmp_gt_u32 vcc, 32, v0
  s_nop 1
  v_cndmask_b32 v48, 0, v48, vcc
  v_cndmask_b32 v49, 0, v49, vcc
  v_cndmask_b32 v50, 0, v50, vcc
  s_waitcnt vmcnt(12)
  v_add_f32 v1, v120, v122
  v_lshrrev_b32 v122, 16, v121
  buffer_load_dwordx4 a[84:87], v12, s[36:39], s22 offen offset:1024 sc1
  v_cvt_pk_bf16_f32 v120, v1, v1
  v_and_b32 v123, 0xffff0000, v120
  v_sub_f32 v1, v1, v123
  v_mov_b32 v123, 0
  v_cvt_pk_bf16_f32 v121, v1, v121
  s_waitcnt vmcnt(12)
  v_add_f32 v2, v124, v126
  v_lshrrev_b32 v126, 16, v125
  v_cvt_pk_bf16_f32 v124, v2, v2
  v_and_b32 v127, 0xffff0000, v124
  buffer_load_dwordx4 a[88:91], v12, s[36:39], s22 offen offset:2048 sc1
  v_sub_f32 v2, v2, v127
  v_mov_b32 v127, 0
  v_cvt_pk_bf16_f32 v125, v2, v125
  s_waitcnt vmcnt(12)
  v_add_f32 v1, v128, v130
  v_lshrrev_b32 v130, 16, v129
  v_cvt_pk_bf16_f32 v128, v1, v1
  v_and_b32 v131, 0xffff0000, v128
  v_sub_f32 v1, v1, v131
  v_mov_b32 v131, 0
  buffer_load_dwordx4 a[92:95], v12, s[36:39], s22 offen offset:3072 sc1
  v_cvt_pk_bf16_f32 v129, v1, v129
  s_waitcnt vmcnt(12)
  v_add_f32 v2, v132, v134
  v_lshrrev_b32 v134, 16, v133
  v_cvt_pk_bf16_f32 v132, v2, v2
  v_and_b32 v135, 0xffff0000, v132
  v_sub_f32 v2, v2, v135
  v_mov_b32 v135, 0
  v_cvt_pk_bf16_f32 v133, v2, v133
  s_waitcnt vmcnt(11)
  v_add_f32 v1, v136, v138
  buffer_load_dwordx4 a[96:99], v13, s[36:39], s22 offen offset:0 sc1
  s_add_u32 s22, s8, 143360
  v_lshrrev_b32 v138, 16, v137
  v_cvt_pk_bf16_f32 v136, v1, v1
  v_and_b32 v139, 0xffff0000, v136
  v_sub_f32 v1, v1, v139
  v_mov_b32 v139, 0
  v_cvt_pk_bf16_f32 v137, v1, v137
  s_waitcnt vmcnt(11)
  v_add_f32 v1, v56, v58
  v_lshrrev_b32 v58, 16, v57
  v_cvt_pk_bf16_f32 v56, v1, v1
  buffer_load_dwordx4 a[100:103], v12, s[36:39], s22 offen offset:0 sc1
  v_and_b32 v59, 0xffff0000, v56
  v_sub_f32 v1, v1, v59
  v_mov_b32 v59, 0
  v_cvt_pk_bf16_f32 v57, v1, v57
  s_waitcnt vmcnt(11)
  v_add_f32 v2, v60, v62
  v_lshrrev_b32 v62, 16, v61
  v_cvt_pk_bf16_f32 v60, v2, v2
  v_and_b32 v63, 0xffff0000, v60
  v_sub_f32 v2, v2, v63
  buffer_load_dwordx4 a[104:107], v12, s[36:39], s22 offen offset:1024 sc1
  v_mov_b32 v63, 0
  v_cvt_pk_bf16_f32 v61, v2, v61
  v_mfma_f32_32x32x16_bf16 v[176:191], v[120:123], v[48:51], v[176:191]
  v_mfma_f32_32x32x16_bf16 v[192:207], v[124:127], v[48:51], v[192:207]
  v_mfma_f32_32x32x16_bf16 v[208:223], v[128:131], v[48:51], v[208:223]
  v_mfma_f32_32x32x16_bf16 v[224:239], v[132:135], v[48:51], v[224:239]
  v_mfma_f32_32x32x16_bf16 v[240:255], v[136:139], v[48:51], v[240:255]
  v_mfma_f32_32x32x16_bf16 v[64:79], v[56:59], v[48:51], v[64:79]
  v_mfma_f32_32x32x16_bf16 v[80:95], v[60:63], v[48:51], v[80:95]
  buffer_load_dwordx4 a[108:111], v12, s[36:39], s22 offen offset:2048 sc1
  s_nop 4
  v_cvt_pk_bf16_f32 v96, v176, v177
  v_cvt_pk_bf16_f32 v97, v178, v179
  v_cvt_pk_bf16_f32 v98, v180, v181
  v_cvt_pk_bf16_f32 v99, v182, v183
  v_cvt_pk_bf16_f32 v100, v184, v185
  v_cvt_pk_bf16_f32 v101, v186, v187
  v_cvt_pk_bf16_f32 v102, v188, v189
  v_cvt_pk_bf16_f32 v103, v190, v191
  v_cvt_pk_bf16_f32 v104, v192, v193
  buffer_load_dwordx4 a[112:115], v12, s[36:39], s22 offen offset:3072 sc1
  v_cvt_pk_bf16_f32 v105, v194, v195
  v_cvt_pk_bf16_f32 v106, v196, v197
  v_cvt_pk_bf16_f32 v107, v198, v199
  v_cvt_pk_bf16_f32 v108, v200, v201
  v_cvt_pk_bf16_f32 v109, v202, v203
  v_cvt_pk_bf16_f32 v110, v204, v205
  v_cvt_pk_bf16_f32 v111, v206, v207
  v_cvt_pk_bf16_f32 v112, v208, v209
  v_cvt_pk_bf16_f32 v113, v210, v211
  buffer_load_dwordx4 a[116:119], v13, s[36:39], s22 offen offset:0 sc1
  v_cvt_pk_bf16_f32 v114, v212, v213
  v_cvt_pk_bf16_f32 v115, v214, v215
  v_mov_b32 v116, 0
  v_mov_b32 v117, 0
  v_mfma_f32_32x32x16_bf16 v[120:135], a[0:3], v[96:99], 0
  v_cvt_pk_bf16_f32 v64, v64, v65
  v_cvt_pk_bf16_f32 v65, v66, v67
  v_cvt_pk_bf16_f32 v66, v68, v69
  v_cvt_pk_bf16_f32 v67, v70, v71
  buffer_load_dwordx4 a[200:203], v12, s[36:39], s8 offen offset:0 sc1
  buffer_store_dwordx4 v[64:67], v44, s[36:39], s13 offen offset:0 sc1
  v_mfma_f32_32x32x16_bf16 v[136:151], a[4:7], v[96:99], 0
  v_cvt_pk_bf16_f32 v72, v72, v73
  v_cvt_pk_bf16_f32 v73, v74, v75
  v_cvt_pk_bf16_f32 v74, v76, v77
  v_cvt_pk_bf16_f32 v75, v78, v79
  buffer_store_dwordx4 v[72:75], v44, s[36:39], s13 offen offset:512 sc1
  v_mfma_f32_32x32x16_bf16 v[120:135], a[8:11], v[100:103], v[120:135]
  v_cvt_pk_bf16_f32 v80, v80, v81
  buffer_load_dwordx4 a[204:207], v12, s[36:39], s8 offen offset:1024 sc1
  v_cvt_pk_bf16_f32 v81, v82, v83
  v_cvt_pk_bf16_f32 v82, v84, v85
  v_cvt_pk_bf16_f32 v83, v86, v87
  buffer_store_dwordx4 v[80:83], v44, s[36:39], s13 offen offset:1024 sc1
  v_mfma_f32_32x32x16_bf16 v[136:151], a[12:15], v[100:103], v[136:151]
  v_cvt_pk_bf16_f32 v88, v88, v89
  v_cvt_pk_bf16_f32 v89, v90, v91
  v_cvt_pk_bf16_f32 v90, v92, v93
  v_cvt_pk_bf16_f32 v91, v94, v95
  buffer_load_dwordx4 a[208:211], v12, s[36:39], s8 offen offset:2048 sc1
  buffer_store_dwordx4 v[88:91], v44, s[36:39], s13 offen offset:1536 sc1
  v_mfma_f32_32x32x16_bf16 v[120:135], a[16:19], v[104:107], v[120:135]
  v_and_b32 v1, 31, v0
  s_lshl_b32 s0, s3, 5
  v_add_u32 v1, s0, v1
  v_lshrrev_b32 v2, 5, v0
  v_mul_u32_u24 v3, 48, v1
  v_mfma_f32_32x32x16_bf16 v[136:151], a[20:23], v[104:107], v[136:151]
  v_mul_u32_u24 v5, 12288, v2
  buffer_load_dwordx4 a[212:215], v12, s[36:39], s8 offen offset:3072 sc1
  v_add_u32 v3, v3, v5
  v_add_u32 v35, 126976, v3
  v_mul_u32_u24 v3, 80, v1
  v_mul_u32_u24 v4, 20480, v2
  v_mfma_f32_32x32x16_bf16 v[152:167], a[24:27], v[106:109], 0
  v_add_u32 v3, v3, v4
  v_add_u32 v34, 86016, v3
  v_mul_f32 v216, v216, v46
  v_mul_f32 v217, v217, v46
  buffer_load_dwordx4 a[216:219], v13, s[36:39], s8 offen offset:0 sc1
  s_add_u32 s22, s8, 20480
  v_cvt_pk_bf16_f32 v184, v216, v217
  v_mfma_f32_32x32x16_bf16 v[168:183], a[28:31], v[106:109], 0
  v_mul_f32 v218, v218, v46
  v_mul_f32 v219, v219, v46
  v_cvt_pk_bf16_f32 v185, v218, v219
  v_mul_f32 v220, v220, v46
  v_mul_f32 v221, v221, v46
  v_mfma_f32_32x32x16_bf16 v[152:167], a[32:35], v[110:113], v[152:167]
  v_cvt_pk_bf16_f32 v186, v220, v221
  buffer_load_dwordx4 a[220:223], v12, s[36:39], s22 offen offset:0 sc1
  v_mul_f32 v222, v222, v46
  v_mul_f32 v223, v223, v46
  v_cvt_pk_bf16_f32 v187, v222, v223
  v_mul_f32 v224, v224, v46
  v_mfma_f32_32x32x16_bf16 v[168:183], a[36:39], v[110:113], v[168:183]
  v_mul_f32 v225, v225, v46
  v_cvt_pk_bf16_f32 v188, v224, v225
  v_mul_f32 v226, v226, v46
  v_mul_f32 v227, v227, v46
  buffer_load_dwordx4 a[224:227], v12, s[36:39], s22 offen offset:1024 sc1
  v_cvt_pk_bf16_f32 v189, v226, v227
  v_mfma_f32_32x32x16_bf16 v[152:167], a[40:43], v[114:117], v[152:167]
  v_mul_f32 v228, v228, v46
  v_mul_f32 v229, v229, v46
  v_cvt_pk_bf16_f32 v190, v228, v229
  v_mul_f32 v230, v230, v46
  v_mul_f32 v231, v231, v46
  v_mfma_f32_32x32x16_bf16 v[168:183], a[44:47], v[114:117], v[168:183]
  v_cvt_pk_bf16_f32 v191, v230, v231
  buffer_load_dwordx4 a[228:231], v12, s[36:39], s22 offen offset:2048 sc1
  v_mul_f32 v232, v232, v46
  v_mul_f32 v233, v233, v46
  v_cvt_pk_bf16_f32 v192, v232, v233
  v_mul_f32 v234, v234, v46
  v_mul_f32 v235, v235, v46
  v_cvt_pk_bf16_f32 v193, v234, v235
  v_mov_b32 v194, 0x3f80
  v_mov_b32 v195, 0
  ds_write_b128 v35, v[184:187] offset:0
  buffer_load_dwordx4 a[232:235], v12, s[36:39], s22 offen offset:3072 sc1
  ds_write_b128 v35, v[188:191] offset:16
  ds_write_b128 v35, v[192:195] offset:32
  v_mul_f32 v236, v236, v46
  v_mul_f32 v237, v237, v46
  v_cvt_pk_bf16_f32 v196, v236, v237
  v_mul_f32 v238, v238, v46
  v_mul_f32 v239, v239, v46
  v_cvt_pk_bf16_f32 v197, v238, v239
  v_mul_f32 v240, v240, v46
  buffer_load_dwordx4 a[236:239], v13, s[36:39], s22 offen offset:0 sc1
  v_mul_f32 v241, v241, v46
  v_cvt_pk_bf16_f32 v198, v240, v241
  v_mul_f32 v242, v242, v46
  v_mul_f32 v243, v243, v46
  v_cvt_pk_bf16_f32 v199, v242, v243
  v_mul_f32 v244, v244, v46
  v_mul_f32 v245, v245, v46
  v_cvt_pk_bf16_f32 v200, v244, v245
  v_mul_f32 v246, v246, v46
  v_mul_f32 v247, v247, v46
  v_cvt_pk_bf16_f32 v201, v246, v247
  v_mul_f32 v248, v248, v46
  v_mul_f32 v249, v249, v46
  v_cvt_pk_bf16_f32 v202, v248, v249
  v_mul_f32 v250, v250, v46
  v_mul_f32 v251, v251, v46
  v_cvt_pk_bf16_f32 v203, v250, v251
  v_mul_f32 v252, v252, v46
  v_mul_f32 v253, v253, v46
  v_cvt_pk_bf16_f32 v204, v252, v253
  v_mul_f32 v254, v254, v46
  v_mul_f32 v255, v255, v46
  v_cvt_pk_bf16_f32 v205, v254, v255
  v_mov_b32 v206, 0x3f80
  v_mov_b32 v207, 0
  ds_write_b128 v35, v[196:199] offset:6144
  ds_write_b128 v35, v[200:203] offset:6160
  ds_write_b128 v35, v[204:207] offset:6176
  v_max3_f32 v2, v120, v121, v122
  v_min3_f32 v3, v120, v121, v122
  v_max3_f32 v2, v2, v123, v124
  v_min3_f32 v3, v3, v123, v124
  v_max3_f32 v2, v2, v125, v126
  v_min3_f32 v3, v3, v125, v126
  v_max3_f32 v2, v2, v127, v128
  v_min3_f32 v3, v3, v127, v128
  v_max3_f32 v2, v2, v129, v130
  s_add_u32 s22, s8, 40960
  buffer_load_dwordx4 a[0:3], v12, s[36:39], s22 offen offset:0 sc1
  v_min3_f32 v3, v3, v129, v130
  v_max3_f32 v2, v2, v131, v132
  v_min3_f32 v3, v3, v131, v132
  v_max3_f32 v2, v2, v133, v134
  v_min3_f32 v3, v3, v133, v134
  v_max3_f32 v2, v2, v135, v136
  v_min3_f32 v3, v3, v135, v136
  v_max3_f32 v2, v2, v137, v138
  v_min3_f32 v3, v3, v137, v138
  buffer_load_dwordx4 a[4:7], v12, s[36:39], s22 offen offset:1024 sc1
  v_max_f32 v2, v2, v139
  v_min_f32 v3, v3, v139
  v_mul_f32 v2, v2, v45
  v_mul_f32 v3, v3, v45
  v_pk_fma_f32 v[216:217], v[120:121], v[44:45], v[2:3] op_sel:[0,1,0] op_sel_hi:[1,1,0] neg_lo:[0,0,1] neg_hi:[0,0,1]
  v_pk_fma_f32 v[236:237], v[120:121], v[44:45], v[2:3] op_sel:[0,1,1] op_sel_hi:[1,1,1] neg_lo:[1,0,0] neg_hi:[1,0,0]
  v_exp_f32 v216, v216
  v_exp_f32 v217, v217
  v_exp_f32 v236, v236
  buffer_load_dwordx4 a[8:11], v12, s[36:39], s22 offen offset:2048 sc1
  v_exp_f32 v237, v237
  v_pk_fma_f32 v[218:219], v[122:123], v[44:45], v[2:3] op_sel:[0,1,0] op_sel_hi:[1,1,0] neg_lo:[0,0,1] neg_hi:[0,0,1]
  v_pk_fma_f32 v[238:239], v[122:123], v[44:45], v[2:3] op_sel:[0,1,1] op_sel_hi:[1,1,1] neg_lo:[1,0,0] neg_hi:[1,0,0]
  v_exp_f32 v218, v218
  v_exp_f32 v219, v219
  v_exp_f32 v238, v238
  v_exp_f32 v239, v239
  v_pk_fma_f32 v[220:221], v[124:125], v[44:45], v[2:3] op_sel:[0,1,0] op_sel_hi:[1,1,0] neg_lo:[0,0,1] neg_hi:[0,0,1]
  v_pk_fma_f32 v[240:241], v[124:125], v[44:45], v[2:3] op_sel:[0,1,1] op_sel_hi:[1,1,1] neg_lo:[1,0,0] neg_hi:[1,0,0]
  buffer_load_dwordx4 a[12:15], v12, s[36:39], s22 offen offset:3072 sc1
  v_exp_f32 v220, v220
  v_exp_f32 v221, v221
  v_exp_f32 v240, v240
  v_exp_f32 v241, v241
  v_pk_fma_f32 v[222:223], v[126:127], v[44:45], v[2:3] op_sel:[0,1,0] op_sel_hi:[1,1,0] neg_lo:[0,0,1] neg_hi:[0,0,1]
  v_pk_fma_f32 v[242:243], v[126:127], v[44:45], v[2:3] op_sel:[0,1,1] op_sel_hi:[1,1,1] neg_lo:[1,0,0] neg_hi:[1,0,0]
  v_exp_f32 v222, v222
  v_exp_f32 v223, v223
  v_exp_f32 v242, v242
  buffer_load_dwordx4 a[16:19], v13, s[36:39], s22 offen offset:0 sc1
  s_add_u32 s22, s8, 61440
  v_exp_f32 v243, v243
  v_pk_fma_f32 v[224:225], v[128:129], v[44:45], v[2:3] op_sel:[0,1,0] op_sel_hi:[1,1,0] neg_lo:[0,0,1] neg_hi:[0,0,1]
  v_pk_fma_f32 v[244:245], v[128:129], v[44:45], v[2:3] op_sel:[0,1,1] op_sel_hi:[1,1,1] neg_lo:[1,0,0] neg_hi:[1,0,0]
  v_exp_f32 v224, v224
  v_exp_f32 v225, v225
  v_exp_f32 v244, v244
  v_exp_f32 v245, v245
  v_pk_fma_f32 v[226:227], v[130:131], v[44:45], v[2:3] op_sel:[0,1,0] op_sel_hi:[1,1,0] neg_lo:[0,0,1] neg_hi:[0,0,1]
  v_pk_fma_f32 v[246:247], v[130:131], v[44:45], v[2:3] op_sel:[0,1,1] op_sel_hi:[1,1,1] neg_lo:[1,0,0] neg_hi:[1,0,0]
  buffer_load_dwordx4 a[20:23], v12, s[36:39], s22 offen offset:0 sc1
  v_exp_f32 v226, v226
  v_exp_f32 v227, v227
  v_exp_f32 v246, v246
  v_exp_f32 v247, v247
  v_pk_fma_f32 v[228:229], v[132:133], v[44:45], v[2:3] op_sel:[0,1,0] op_sel_hi:[1,1,0] neg_lo:[0,0,1] neg_hi:[0,0,1]
  v_pk_fma_f32 v[248:249], v[132:133], v[44:45], v[2:3] op_sel:[0,1,1] op_sel_hi:[1,1,1] neg_lo:[1,0,0] neg_hi:[1,0,0]
  v_exp_f32 v228, v228
  v_exp_f32 v229, v229
  v_exp_f32 v248, v248
  buffer_load_dwordx4 a[24:27], v12, s[36:39], s22 offen offset:1024 sc1
  v_exp_f32 v249, v249
  v_pk_fma_f32 v[230:231], v[134:135], v[44:45], v[2:3] op_sel:[0,1,0] op_sel_hi:[1,1,0] neg_lo:[0,0,1] neg_hi:[0,0,1]
  v_pk_fma_f32 v[250:251], v[134:135], v[44:45], v[2:3] op_sel:[0,1,1] op_sel_hi:[1,1,1] neg_lo:[1,0,0] neg_hi:[1,0,0]
  v_exp_f32 v230, v230
  v_exp_f32 v231, v231
  v_exp_f32 v250, v250
  v_exp_f32 v251, v251
  v_pk_fma_f32 v[232:233], v[136:137], v[44:45], v[2:3] op_sel:[0,1,0] op_sel_hi:[1,1,0] neg_lo:[0,0,1] neg_hi:[0,0,1]
  v_pk_fma_f32 v[252:253], v[136:137], v[44:45], v[2:3] op_sel:[0,1,1] op_sel_hi:[1,1,1] neg_lo:[1,0,0] neg_hi:[1,0,0]
  buffer_load_dwordx4 a[28:31], v12, s[36:39], s22 offen offset:2048 sc1
  v_exp_f32 v232, v232
  v_exp_f32 v233, v233
  v_exp_f32 v252, v252
  v_exp_f32 v253, v253
  v_pk_fma_f32 v[234:235], v[138:139], v[44:45], v[2:3] op_sel:[0,1,0] op_sel_hi:[1,1,0] neg_lo:[0,0,1] neg_hi:[0,0,1]
  v_pk_fma_f32 v[254:255], v[138:139], v[44:45], v[2:3] op_sel:[0,1,1] op_sel_hi:[1,1,1] neg_lo:[1,0,0] neg_hi:[1,0,0]
  v_exp_f32 v234, v234
  v_exp_f32 v235, v235
  v_exp_f32 v254, v254
  buffer_load_dwordx4 a[32:35], v12, s[36:39], s22 offen offset:3072 sc1
  v_exp_f32 v255, v255
  v_pk_add_f32 v[4:5], v[216:217], v[218:219]
  v_pk_add_f32 v[6:7], v[236:237], v[238:239]
  v_pk_add_f32 v[4:5], v[4:5], v[220:221]
  v_pk_add_f32 v[6:7], v[6:7], v[240:241]
  v_pk_add_f32 v[4:5], v[4:5], v[222:223]
  v_pk_add_f32 v[6:7], v[6:7], v[242:243]
  v_pk_add_f32 v[4:5], v[4:5], v[224:225]
  v_pk_add_f32 v[6:7], v[6:7], v[244:245]
  buffer_load_dwordx4 a[36:39], v13, s[36:39], s22 offen offset:0 sc1
  s_add_u32 s22, s8, 81920
  v_pk_add_f32 v[4:5], v[4:5], v[226:227]
  v_pk_add_f32 v[6:7], v[6:7], v[246:247]
  v_pk_add_f32 v[4:5], v[4:5], v[228:229]
  v_pk_add_f32 v[6:7], v[6:7], v[248:249]
  v_pk_add_f32 v[4:5], v[4:5], v[230:231]
  v_pk_add_f32 v[6:7], v[6:7], v[250:251]
  v_pk_add_f32 v[4:5], v[4:5], v[232:233]
  v_pk_add_f32 v[6:7], v[6:7], v[252:253]
  v_pk_add_f32 v[4:5], v[4:5], v[234:235]
  buffer_load_dwordx4 a[40:43], v12, s[36:39], s22 offen offset:0 sc1
  v_pk_add_f32 v[6:7], v[6:7], v[254:255]
  v_add_f32 v2, v4, v5
  v_add_f32 v3, v6, v7
  v_rcp_f32 v2, v2
  v_rcp_f32 v3, v3
  s_nop 0
  v_pk_mul_f32 v[216:217], v[216:217], v[2:3] op_sel:[0,0] op_sel_hi:[1,0]
  v_pk_mul_f32 v[218:219], v[218:219], v[2:3] op_sel:[0,0] op_sel_hi:[1,0]
  v_cvt_pk_bf16_f32 v184, v216, v217
  buffer_load_dwordx4 a[44:47], v12, s[36:39], s22 offen offset:1024 sc1
  v_pk_mul_f32 v[220:221], v[220:221], v[2:3] op_sel:[0,0] op_sel_hi:[1,0]
  v_cvt_pk_bf16_f32 v185, v218, v219
  v_pk_mul_f32 v[222:223], v[222:223], v[2:3] op_sel:[0,0] op_sel_hi:[1,0]
  v_cvt_pk_bf16_f32 v186, v220, v221
  v_pk_mul_f32 v[224:225], v[224:225], v[2:3] op_sel:[0,0] op_sel_hi:[1,0]
  v_cvt_pk_bf16_f32 v187, v222, v223
  v_pk_mul_f32 v[226:227], v[226:227], v[2:3] op_sel:[0,0] op_sel_hi:[1,0]
  v_cvt_pk_bf16_f32 v188, v224, v225
  v_pk_mul_f32 v[228:229], v[228:229], v[2:3] op_sel:[0,0] op_sel_hi:[1,0]
  buffer_load_dwordx4 a[48:51], v12, s[36:39], s22 offen offset:2048 sc1
  v_cvt_pk_bf16_f32 v189, v226, v227
  v_pk_mul_f32 v[230:231], v[230:231], v[2:3] op_sel:[0,0] op_sel_hi:[1,0]
  v_cvt_pk_bf16_f32 v190, v228, v229
  v_pk_mul_f32 v[232:233], v[232:233], v[2:3] op_sel:[0,0] op_sel_hi:[1,0]
  v_cvt_pk_bf16_f32 v191, v230, v231
  v_pk_mul_f32 v[234:235], v[234:235], v[2:3] op_sel:[0,0] op_sel_hi:[1,0]
  v_cvt_pk_bf16_f32 v192, v232, v233
  v_pk_mul_f32 v[236:237], v[236:237], v[2:3] op_sel:[0,1] op_sel_hi:[1,1]
  v_cvt_pk_bf16_f32 v193, v234, v235
  buffer_load_dwordx4 a[52:55], v12, s[36:39], s22 offen offset:3072 sc1
  v_pk_mul_f32 v[238:239], v[238:239], v[2:3] op_sel:[0,1] op_sel_hi:[1,1]
  v_cvt_pk_bf16_f32 v194, v236, v237
  v_pk_mul_f32 v[240:241], v[240:241], v[2:3] op_sel:[0,1] op_sel_hi:[1,1]
  v_cvt_pk_bf16_f32 v195, v238, v239
  v_pk_mul_f32 v[242:243], v[242:243], v[2:3] op_sel:[0,1] op_sel_hi:[1,1]
  v_cvt_pk_bf16_f32 v196, v240, v241
  v_pk_mul_f32 v[244:245], v[244:245], v[2:3] op_sel:[0,1] op_sel_hi:[1,1]
  v_cvt_pk_bf16_f32 v197, v242, v243
  v_pk_mul_f32 v[246:247], v[246:247], v[2:3] op_sel:[0,1] op_sel_hi:[1,1]
  buffer_load_dwordx4 a[56:59], v13, s[36:39], s22 offen offset:0 sc1
  s_add_u32 s22, s8, 163840
  v_cvt_pk_bf16_f32 v198, v244, v245
  v_pk_mul_f32 v[248:249], v[248:249], v[2:3] op_sel:[0,1] op_sel_hi:[1,1]
  v_cvt_pk_bf16_f32 v199, v246, v247
  v_pk_mul_f32 v[250:251], v[250:251], v[2:3] op_sel:[0,1] op_sel_hi:[1,1]
  v_cvt_pk_bf16_f32 v200, v248, v249
  v_pk_mul_f32 v[252:253], v[252:253], v[2:3] op_sel:[0,1] op_sel_hi:[1,1]
  v_cvt_pk_bf16_f32 v201, v250, v251
  v_pk_mul_f32 v[254:255], v[254:255], v[2:3] op_sel:[0,1] op_sel_hi:[1,1]
  v_cvt_pk_bf16_f32 v202, v252, v253
  buffer_load_dwordx4 a[120:123], v12, s[36:39], s22 offen offset:0 sc1
  v_cvt_pk_bf16_f32 v203, v254, v255
  ds_write_b128 v34, v[184:187] offset:0
  ds_write_b128 v34, v[188:191] offset:16
  ds_write_b128 v34, v[192:195] offset:32
  ds_write_b128 v34, v[196:199] offset:48
  ds_write_b128 v34, v[200:203] offset:64
  s_waitcnt vmcnt(23)
  s_barrier
  s_add_u32 s18, s64, 2
  buffer_load_dwordx4 a[124:127], v12, s[36:39], s22 offen offset:1024 sc1
  v_mov_b32 v14, s18
  buffer_store_dword v14, v9, s[36:39], 0 offen sc1
  v_max3_f32 v2, v152, v153, v154
  v_min3_f32 v3, v152, v153, v154
  v_max3_f32 v2, v2, v155, v156
  v_min3_f32 v3, v3, v155, v156
  v_max3_f32 v2, v2, v157, v158
  v_min3_f32 v3, v3, v157, v158
  v_max3_f32 v2, v2, v159, v160
  buffer_load_dwordx4 a[128:131], v12, s[36:39], s22 offen offset:2048 sc1
  v_min3_f32 v3, v3, v159, v160
  v_max3_f32 v2, v2, v161, v162
  v_min3_f32 v3, v3, v161, v162
  v_max3_f32 v2, v2, v163, v164
  v_min3_f32 v3, v3, v163, v164
  v_max3_f32 v2, v2, v165, v166
  v_min3_f32 v3, v3, v165, v166
  v_max3_f32 v2, v2, v167, v168
  v_min3_f32 v3, v3, v167, v168
  buffer_load_dwordx4 a[132:135], v12, s[36:39], s22 offen offset:3072 sc1
  v_max3_f32 v2, v2, v169, v170
  v_min3_f32 v3, v3, v169, v170
  v_max_f32 v2, v2, v171
  v_min_f32 v3, v3, v171
  v_mul_f32 v2, v2, v45
  v_mul_f32 v3, v3, v45
  v_pk_fma_f32 v[216:217], v[152:153], v[44:45], v[2:3] op_sel:[0,1,0] op_sel_hi:[1,1,0] neg_lo:[0,0,1] neg_hi:[0,0,1]
  v_pk_fma_f32 v[236:237], v[152:153], v[44:45], v[2:3] op_sel:[0,1,1] op_sel_hi:[1,1,1] neg_lo:[1,0,0] neg_hi:[1,0,0]
  v_exp_f32 v216, v216
  buffer_load_dwordx4 a[136:139], v13, s[36:39], s22 offen offset:0 sc1
  s_add_u32 s22, s8, 184320
  v_exp_f32 v217, v217
  v_exp_f32 v236, v236
  v_exp_f32 v237, v237
  v_pk_fma_f32 v[218:219], v[154:155], v[44:45], v[2:3] op_sel:[0,1,0] op_sel_hi:[1,1,0] neg_lo:[0,0,1] neg_hi:[0,0,1]
  v_pk_fma_f32 v[238:239], v[154:155], v[44:45], v[2:3] op_sel:[0,1,1] op_sel_hi:[1,1,1] neg_lo:[1,0,0] neg_hi:[1,0,0]
  v_exp_f32 v218, v218
  v_exp_f32 v219, v219
  v_exp_f32 v238, v238
  v_exp_f32 v239, v239
  buffer_load_dwordx4 a[140:143], v12, s[36:39], s22 offen offset:0 sc1
  v_pk_fma_f32 v[220:221], v[156:157], v[44:45], v[2:3] op_sel:[0,1,0] op_sel_hi:[1,1,0] neg_lo:[0,0,1] neg_hi:[0,0,1]
  v_pk_fma_f32 v[240:241], v[156:157], v[44:45], v[2:3] op_sel:[0,1,1] op_sel_hi:[1,1,1] neg_lo:[1,0,0] neg_hi:[1,0,0]
  v_exp_f32 v220, v220
  v_exp_f32 v221, v221
  v_exp_f32 v240, v240
  v_exp_f32 v241, v241
  v_pk_fma_f32 v[222:223], v[158:159], v[44:45], v[2:3] op_sel:[0,1,0] op_sel_hi:[1,1,0] neg_lo:[0,0,1] neg_hi:[0,0,1]
  v_pk_fma_f32 v[242:243], v[158:159], v[44:45], v[2:3] op_sel:[0,1,1] op_sel_hi:[1,1,1] neg_lo:[1,0,0] neg_hi:[1,0,0]
  v_exp_f32 v222, v222
  buffer_load_dwordx4 a[144:147], v12, s[36:39], s22 offen offset:1024 sc1
  v_exp_f32 v223, v223
  v_exp_f32 v242, v242
  v_exp_f32 v243, v243
  v_pk_fma_f32 v[224:225], v[160:161], v[44:45], v[2:3] op_sel:[0,1,0] op_sel_hi:[1,1,0] neg_lo:[0,0,1] neg_hi:[0,0,1]
  v_pk_fma_f32 v[244:245], v[160:161], v[44:45], v[2:3] op_sel:[0,1,1] op_sel_hi:[1,1,1] neg_lo:[1,0,0] neg_hi:[1,0,0]
  v_exp_f32 v224, v224
  v_exp_f32 v225, v225
  v_exp_f32 v244, v244
  v_exp_f32 v245, v245
  buffer_load_dwordx4 a[148:151], v12, s[36:39], s22 offen offset:2048 sc1
  v_pk_fma_f32 v[226:227], v[162:163], v[44:45], v[2:3] op_sel:[0,1,0] op_sel_hi:[1,1,0] neg_lo:[0,0,1] neg_hi:[0,0,1]
  v_pk_fma_f32 v[246:247], v[162:163], v[44:45], v[2:3] op_sel:[0,1,1] op_sel_hi:[1,1,1] neg_lo:[1,0,0] neg_hi:[1,0,0]
  v_exp_f32 v226, v226
  v_exp_f32 v227, v227
  v_exp_f32 v246, v246
  v_exp_f32 v247, v247
  v_pk_fma_f32 v[228:229], v[164:165], v[44:45], v[2:3] op_sel:[0,1,0] op_sel_hi:[1,1,0] neg_lo:[0,0,1] neg_hi:[0,0,1]
  v_pk_fma_f32 v[248:249], v[164:165], v[44:45], v[2:3] op_sel:[0,1,1] op_sel_hi:[1,1,1] neg_lo:[1,0,0] neg_hi:[1,0,0]
  v_exp_f32 v228, v228
  buffer_load_dwordx4 a[152:155], v12, s[36:39], s22 offen offset:3072 sc1
  v_exp_f32 v229, v229
  v_exp_f32 v248, v248
  v_exp_f32 v249, v249
  v_pk_fma_f32 v[230:231], v[166:167], v[44:45], v[2:3] op_sel:[0,1,0] op_sel_hi:[1,1,0] neg_lo:[0,0,1] neg_hi:[0,0,1]
  v_pk_fma_f32 v[250:251], v[166:167], v[44:45], v[2:3] op_sel:[0,1,1] op_sel_hi:[1,1,1] neg_lo:[1,0,0] neg_hi:[1,0,0]
  v_exp_f32 v230, v230
  v_exp_f32 v231, v231
  v_exp_f32 v250, v250
  v_exp_f32 v251, v251
  buffer_load_dwordx4 a[156:159], v13, s[36:39], s22 offen offset:0 sc1
  s_add_u32 s22, s8, 204800
  v_pk_fma_f32 v[232:233], v[168:169], v[44:45], v[2:3] op_sel:[0,1,0] op_sel_hi:[1,1,0] neg_lo:[0,0,1] neg_hi:[0,0,1]
  v_pk_fma_f32 v[252:253], v[168:169], v[44:45], v[2:3] op_sel:[0,1,1] op_sel_hi:[1,1,1] neg_lo:[1,0,0] neg_hi:[1,0,0]
  v_exp_f32 v232, v232
  v_exp_f32 v233, v233
  v_exp_f32 v252, v252
  v_exp_f32 v253, v253
  v_pk_fma_f32 v[234:235], v[170:171], v[44:45], v[2:3] op_sel:[0,1,0] op_sel_hi:[1,1,0] neg_lo:[0,0,1] neg_hi:[0,0,1]
  v_pk_fma_f32 v[254:255], v[170:171], v[44:45], v[2:3] op_sel:[0,1,1] op_sel_hi:[1,1,1] neg_lo:[1,0,0] neg_hi:[1,0,0]
  v_exp_f32 v234, v234
  buffer_load_dwordx4 a[160:163], v12, s[36:39], s22 offen offset:0 sc1
  v_exp_f32 v235, v235
  v_exp_f32 v254, v254
  v_exp_f32 v255, v255
  v_pk_add_f32 v[4:5], v[216:217], v[218:219]
  v_pk_add_f32 v[6:7], v[236:237], v[238:239]
  v_pk_add_f32 v[4:5], v[4:5], v[220:221]
  v_pk_add_f32 v[6:7], v[6:7], v[240:241]
  v_pk_add_f32 v[4:5], v[4:5], v[222:223]
  v_pk_add_f32 v[6:7], v[6:7], v[242:243]
  buffer_load_dwordx4 a[164:167], v12, s[36:39], s22 offen offset:1024 sc1
  v_pk_add_f32 v[4:5], v[4:5], v[224:225]
  v_pk_add_f32 v[6:7], v[6:7], v[244:245]
  v_pk_add_f32 v[4:5], v[4:5], v[226:227]
  v_pk_add_f32 v[6:7], v[6:7], v[246:247]
  v_pk_add_f32 v[4:5], v[4:5], v[228:229]
  v_pk_add_f32 v[6:7], v[6:7], v[248:249]
  v_pk_add_f32 v[4:5], v[4:5], v[230:231]
  v_pk_add_f32 v[6:7], v[6:7], v[250:251]
  v_pk_add_f32 v[4:5], v[4:5], v[232:233]
  buffer_load_dwordx4 a[168:171], v12, s[36:39], s22 offen offset:2048 sc1
  v_pk_add_f32 v[6:7], v[6:7], v[252:253]
  v_pk_add_f32 v[4:5], v[4:5], v[234:235]
  v_pk_add_f32 v[6:7], v[6:7], v[254:255]
  v_add_f32 v2, v4, v5
  v_add_f32 v3, v6, v7
  v_rcp_f32 v2, v2
  v_rcp_f32 v3, v3
  s_nop 0
  v_pk_mul_f32 v[216:217], v[216:217], v[2:3] op_sel:[0,0] op_sel_hi:[1,0]
  buffer_load_dwordx4 a[172:175], v12, s[36:39], s22 offen offset:3072 sc1
  v_pk_mul_f32 v[218:219], v[218:219], v[2:3] op_sel:[0,0] op_sel_hi:[1,0]
  v_cvt_pk_bf16_f32 v184, v216, v217
  v_pk_mul_f32 v[220:221], v[220:221], v[2:3] op_sel:[0,0] op_sel_hi:[1,0]
  v_cvt_pk_bf16_f32 v185, v218, v219
  v_pk_mul_f32 v[222:223], v[222:223], v[2:3] op_sel:[0,0] op_sel_hi:[1,0]
  v_cvt_pk_bf16_f32 v186, v220, v221
  v_pk_mul_f32 v[224:225], v[224:225], v[2:3] op_sel:[0,0] op_sel_hi:[1,0]
  v_cvt_pk_bf16_f32 v187, v222, v223
  v_pk_mul_f32 v[226:227], v[226:227], v[2:3] op_sel:[0,0] op_sel_hi:[1,0]
  buffer_load_dwordx4 a[176:179], v13, s[36:39], s22 offen offset:0 sc1
  s_add_u32 s22, s8, 225280
  v_cvt_pk_bf16_f32 v188, v224, v225
  v_pk_mul_f32 v[228:229], v[228:229], v[2:3] op_sel:[0,0] op_sel_hi:[1,0]
  v_cvt_pk_bf16_f32 v189, v226, v227
  v_pk_mul_f32 v[230:231], v[230:231], v[2:3] op_sel:[0,0] op_sel_hi:[1,0]
  v_cvt_pk_bf16_f32 v190, v228, v229
  v_pk_mul_f32 v[232:233], v[232:233], v[2:3] op_sel:[0,0] op_sel_hi:[1,0]
  v_cvt_pk_bf16_f32 v191, v230, v231
  v_pk_mul_f32 v[234:235], v[234:235], v[2:3] op_sel:[0,0] op_sel_hi:[1,0]
  v_cvt_pk_bf16_f32 v192, v232, v233
  buffer_load_dwordx4 a[180:183], v12, s[36:39], s22 offen offset:0 sc1
  v_pk_mul_f32 v[236:237], v[236:237], v[2:3] op_sel:[0,1] op_sel_hi:[1,1]
  v_cvt_pk_bf16_f32 v193, v234, v235
  v_pk_mul_f32 v[238:239], v[238:239], v[2:3] op_sel:[0,1] op_sel_hi:[1,1]
  v_cvt_pk_bf16_f32 v194, v236, v237
  v_pk_mul_f32 v[240:241], v[240:241], v[2:3] op_sel:[0,1] op_sel_hi:[1,1]
  v_cvt_pk_bf16_f32 v195, v238, v239
  v_pk_mul_f32 v[242:243], v[242:243], v[2:3] op_sel:[0,1] op_sel_hi:[1,1]
  v_cvt_pk_bf16_f32 v196, v240, v241
  v_pk_mul_f32 v[244:245], v[244:245], v[2:3] op_sel:[0,1] op_sel_hi:[1,1]
  buffer_load_dwordx4 a[184:187], v12, s[36:39], s22 offen offset:1024 sc1
  v_cvt_pk_bf16_f32 v197, v242, v243
  v_pk_mul_f32 v[246:247], v[246:247], v[2:3] op_sel:[0,1] op_sel_hi:[1,1]
  v_cvt_pk_bf16_f32 v198, v244, v245
  v_pk_mul_f32 v[248:249], v[248:249], v[2:3] op_sel:[0,1] op_sel_hi:[1,1]
  v_cvt_pk_bf16_f32 v199, v246, v247
  v_pk_mul_f32 v[250:251], v[250:251], v[2:3] op_sel:[0,1] op_sel_hi:[1,1]
  v_cvt_pk_bf16_f32 v200, v248, v249
  v_pk_mul_f32 v[252:253], v[252:253], v[2:3] op_sel:[0,1] op_sel_hi:[1,1]
  v_cvt_pk_bf16_f32 v201, v250, v251
  buffer_load_dwordx4 a[188:191], v12, s[36:39], s22 offen offset:2048 sc1
  v_pk_mul_f32 v[254:255], v[254:255], v[2:3] op_sel:[0,1] op_sel_hi:[1,1]
  v_cvt_pk_bf16_f32 v202, v252, v253
  v_cvt_pk_bf16_f32 v203, v254, v255
  ds_write_b128 v34, v[184:187] offset:10240
  ds_write_b128 v34, v[188:191] offset:10256
  ds_write_b128 v34, v[192:195] offset:10272
  ds_write_b128 v34, v[196:199] offset:10288
  ds_write_b128 v34, v[200:203] offset:10304
  s_lshr_b32 s0, s62, 4
  buffer_load_dwordx4 a[192:195], v12, s[36:39], s22 offen offset:3072 sc1
  s_lshl_b32 s0, s0, 2
  s_bfe_u32 s1, s62, 0x30001
  s_lshl_b32 s1, s1, 3
  s_add_u32 s0, s0, s1
  s_mul_i32 s1, s63, 5
  s_lshr_b32 s1, s1, 2
  v_and_b32 v1, 1, v0
  v_add_u32 v1, s1, v1
  v_lshrrev_b32 v11, 3, v1
  buffer_load_dwordx4 a[196:199], v13, s[36:39], s22 offen offset:0 sc1
  v_bfe_u32 v2, v1, 1, 2
  v_and_b32 v1, 1, v1
  v_lshl_add_u32 v1, v11, 1, v1
  s_mov_b32 s1, 0
  v_lshl_add_u32 v1, v1, 6, v2
  s_add_u32 s0, s0, s1
  s_lshl_b32 s0, s0, 8
  s_add_u32 s0, s0, 4096
  v_lshl_add_u32 v11, v1, 8, s0
  v_lshrrev_b32 v1, 5, v0
  v_bfe_u32 v2, v0, 2, 2
  v_lshlrev_b32 v2, 2, v2
  v_lshl_add_u32 v2, v1, 1, v2
  v_and_b32 v3, 3, v0
  v_bfe_u32 v4, v0, 4, 1
  v_lshl_add_u32 v3, v4, 2, v3
  s_mul_i32 s0, s3, 10240
  s_add_u32 s0, s0, 86016
  v_mul_u32_u24 v4, 80, v2
  v_add_u32 v4, s0, v4
  v_lshl_add_u32 v5, v3, 3, v4
  v_and_b32 v6, 1, v3
  v_lshl_add_u32 v6, v6, 3, v4
  v_add_u32 v6, 64, v6
  s_mul_i32 s0, s3, 6144
  s_add_u32 s0, s0, 126976
  v_mul_u32_u24 v4, 48, v2
  v_add_u32 v4, s0, v4
  v_min_u32 v7, 5, v3
  v_lshl_add_u32 v7, v7, 3, v4
  buffer_load_dword v10, v11, s[36:39], 0 offen sc1
  s_waitcnt lgkmcnt(0)
  s_barrier
  ds_read_b64_tr_b16 v[120:121], v5 offset:0
  ds_read_b64_tr_b16 v[128:129], v7 offset:0
  ds_read_b64_tr_b16 v[124:125], v6 offset:0
  ds_read_b64_tr_b16 v[122:123], v5 offset:80
  ds_read_b64_tr_b16 v[130:131], v7 offset:48
  ds_read_b64_tr_b16 v[126:127], v6 offset:80
  ds_read_b64_tr_b16 v[132:133], v5 offset:1280
  ds_read_b64_tr_b16 v[140:141], v7 offset:768
  ds_read_b64_tr_b16 v[136:137], v6 offset:1280
  ds_read_b64_tr_b16 v[134:135], v5 offset:1360
  ds_read_b64_tr_b16 v[142:143], v7 offset:816
  ds_read_b64_tr_b16 v[138:139], v6 offset:1360
  ds_read_b64_tr_b16 v[144:145], v5 offset:2560
  ds_read_b64_tr_b16 v[152:153], v7 offset:1536
  ds_read_b64_tr_b16 v[148:149], v6 offset:2560
  ds_read_b64_tr_b16 v[146:147], v5 offset:2640
  ds_read_b64_tr_b16 v[154:155], v7 offset:1584
  ds_read_b64_tr_b16 v[150:151], v6 offset:2640
  ds_read_b64_tr_b16 v[156:157], v5 offset:3840
  ds_read_b64_tr_b16 v[164:165], v7 offset:2304
  ds_read_b64_tr_b16 v[160:161], v6 offset:3840
  ds_read_b64_tr_b16 v[158:159], v5 offset:3920
  ds_read_b64_tr_b16 v[166:167], v7 offset:2352
  ds_read_b64_tr_b16 v[162:163], v6 offset:3920
  s_waitcnt lgkmcnt(15)
  v_mfma_f32_32x32x16_bf16 v[184:199], v[120:123], v[128:131], 0
  v_mfma_f32_32x32x16_bf16 v[200:215], v[124:127], v[128:131], 0
  ds_read_b64_tr_b16 v[120:121], v5 offset:5120
  ds_read_b64_tr_b16 v[128:129], v7 offset:3072
  ds_read_b64_tr_b16 v[124:125], v6 offset:5120
  ds_read_b64_tr_b16 v[122:123], v5 offset:5200
  ds_read_b64_tr_b16 v[130:131], v7 offset:3120
  ds_read_b64_tr_b16 v[126:127], v6 offset:5200
  s_waitcnt lgkmcnt(15)
  v_mfma_f32_32x32x16_bf16 v[184:199], v[132:135], v[140:143], v[184:199]
  v_mfma_f32_32x32x16_bf16 v[200:215], v[136:139], v[140:143], v[200:215]
  ds_read_b64_tr_b16 v[132:133], v5 offset:6400
  ds_read_b64_tr_b16 v[140:141], v7 offset:3840
  ds_read_b64_tr_b16 v[136:137], v6 offset:6400
  ds_read_b64_tr_b16 v[134:135], v5 offset:6480
  ds_read_b64_tr_b16 v[142:143], v7 offset:3888
  ds_read_b64_tr_b16 v[138:139], v6 offset:6480
  s_waitcnt lgkmcnt(15)
  v_mfma_f32_32x32x16_bf16 v[184:199], v[144:147], v[152:155], v[184:199]
  v_mfma_f32_32x32x16_bf16 v[200:215], v[148:151], v[152:155], v[200:215]
  ds_read_b64_tr_b16 v[144:145], v5 offset:7680
  ds_read_b64_tr_b16 v[152:153], v7 offset:4608
  ds_read_b64_tr_b16 v[148:149], v6 offset:7680
  ds_read_b64_tr_b16 v[146:147], v5 offset:7760
  ds_read_b64_tr_b16 v[154:155], v7 offset:4656
  ds_read_b64_tr_b16 v[150:151], v6 offset:7760
  s_waitcnt lgkmcnt(15)
  v_mfma_f32_32x32x16_bf16 v[184:199], v[156:159], v[164:167], v[184:199]
  v_mfma_f32_32x32x16_bf16 v[200:215], v[160:163], v[164:167], v[200:215]
  ds_read_b64_tr_b16 v[156:157], v5 offset:8960
  ds_read_b64_tr_b16 v[164:165], v7 offset:5376
  ds_read_b64_tr_b16 v[160:161], v6 offset:8960
  ds_read_b64_tr_b16 v[158:159], v5 offset:9040
  ds_read_b64_tr_b16 v[166:167], v7 offset:5424
  ds_read_b64_tr_b16 v[162:163], v6 offset:9040
  s_waitcnt lgkmcnt(15)
  v_mfma_f32_32x32x16_bf16 v[184:199], v[120:123], v[128:131], v[184:199]
  s_add_u32 s0, s3, 0
  s_and_b32 s0, s0, 3
  s_mul_i32 s0, s0, 96256
  v_add_u32 v16, s0, v12
  s_add_u32 s0, s3, 1
  s_and_b32 s0, s0, 3
  v_mfma_f32_32x32x16_bf16 v[200:215], v[124:127], v[128:131], v[200:215]
  s_mul_i32 s0, s0, 96256
  v_add_u32 v17, s0, v12
  s_add_u32 s0, s3, 2
  s_and_b32 s0, s0, 3
  s_mul_i32 s0, s0, 96256
  v_add_u32 v18, s0, v12
  s_waitcnt lgkmcnt(13)
  v_mfma_f32_32x32x16_bf16 v[184:199], v[132:135], v[140:143], v[184:199]
  s_add_u32 s0, s3, 3
  s_and_b32 s0, s0, 3
  s_mul_i32 s0, s0, 96256
  v_add_u32 v19, s0, v12
  v_lshrrev_b32 v1, 4, v0
  v_and_b32 v2, 1, v1
  s_waitcnt lgkmcnt(12)
  v_mfma_f32_32x32x16_bf16 v[200:215], v[136:139], v[140:143], v[200:215]
  v_lshrrev_b32 v3, 1, v1
  v_mul_u32_u24 v3, 5, v3
  s_mul_i32 s0, s63, 10
  v_add_u32 v3, s0, v3
  v_and_b32 v4, 15, v0
  v_lshlrev_b32 v4, 4, v4
  s_waitcnt lgkmcnt(7)
  v_mfma_f32_32x32x16_bf16 v[184:199], v[144:147], v[152:155], v[184:199]
  v_lshl_add_u32 v4, v3, 8, v4
  v_mul_u32_u24 v5, 768, v2
  v_add_u32 v20, v4, v5
  v_lshl_add_u32 v21, v2, 3, v4
  v_and_b32 v4, 15, v0
  v_lshlrev_b32 v22, 3, v4
  s_waitcnt lgkmcnt(6)
  v_mfma_f32_32x32x16_bf16 v[200:215], v[148:151], v[152:155], v[200:215]
  s_mul_i32 s9, s62, 385024
  s_add_u32 s9, s9, 3276800
  s_lshl_b32 s0, s3, 10
  s_add_u32 s7, s9, s0
  s_mul_i32 s69, s3, 10240
  s_add_u32 s69, s69, 86016
  s_waitcnt lgkmcnt(1)
  v_mfma_f32_32x32x16_bf16 v[184:199], v[156:159], v[164:167], v[184:199]
  v_and_b32 v1, 31, v0
  v_lshrrev_b32 v2, 5, v0
  v_mul_u32_u24 v2, 384, v2
  v_lshl_add_u32 v2, v1, 2, v2
  v_add_u32 v3, 4096, v2
  v_cmp_gt_u32 vcc, 24, v1
  s_nop 1
  v_cndmask_b32 v2, v3, v2, vcc
  s_waitcnt lgkmcnt(0)
  v_mfma_f32_32x32x16_bf16 v[200:215], v[160:163], v[164:167], v[200:215]
  v_add_u32 v33, s69, v2
  v_lshlrev_b32 v32, 2, v0
  v_add_u32 v34, s69, v32
  s_lshl_b32 s68, s61, 2
  s_add_u32 s68, s68, s3
  s_mul_i32 s68, s68, 3840
  s_and_b32 s69, s60, 1
  s_mul_i32 s69, s69, 122880
  s_add_u32 s68, s68, s69
  s_add_u32 s68, s68, 15597568
  s_add_u32 s18, s64, 2
  s_waitcnt vmcnt(0)
  v_subrev_u32 v14, s18, v10
  v_cmp_gt_u32_e64 s[100:101], 8, v14
  s_nop 0
  s_cmp_eq_u64 s[100:101], -1
  s_cbranch_scc0 f_spin2
f_back2:
  s_mul_i32 s18, s3, 96256
  s_add_u32 s18, s18, s9
  s_add_u32 s18, s18, 75776
  buffer_load_dwordx4 v[84:87], v20, s[36:39], s18 offen sc1
  buffer_load_dwordx4 v[88:91], v20, s[36:39], s18 offen offset:256 sc1
  buffer_load_dwordx2 v[92:93], v21, s[36:39], s18 offen offset:512 sc1
  s_lshl_b32 s18, s62, 2
  s_add_u32 s18, s18, s3
  s_lshl_b32 s18, s18, 7
  s_add_u32 s18, s18, 15859712
  buffer_load_dwordx2 v[96:97], v22, s[36:39], s18 offen sc1
  ds_write_b32 v33, v184 offset:0
  ds_write_b32 v33, v185 offset:96
  ds_write_b32 v33, v186 offset:192
  ds_write_b32 v33, v187 offset:288
  ds_write_b32 v33, v188 offset:768
  ds_write_b32 v33, v189 offset:864
  ds_write_b32 v33, v190 offset:960
  ds_write_b32 v33, v191 offset:1056
  ds_write_b32 v33, v192 offset:1536
  ds_write_b32 v33, v193 offset:1632
  ds_write_b32 v33, v194 offset:1728
  ds_write_b32 v33, v195 offset:1824
  ds_write_b32 v33, v196 offset:2304
  ds_write_b32 v33, v197 offset:2400
  ds_write_b32 v33, v198 offset:2496
  ds_write_b32 v33, v199 offset:2592
  ds_write_b32 v33, v200 offset:3072
  ds_write_b32 v33, v201 offset:3168
  ds_write_b32 v33, v202 offset:3264
  ds_write_b32 v33, v203 offset:3360
  ds_read2st64_b32 v[120:121], v34 offset0:0 offset1:1
  ds_read2st64_b32 v[122:123], v34 offset0:2 offset1:3
  ds_read2st64_b32 v[124:125], v34 offset0:4 offset1:5
  ds_read2st64_b32 v[126:127], v34 offset0:6 offset1:7
  ds_read2st64_b32 v[128:129], v34 offset0:8 offset1:9
  ds_read2st64_b32 v[130:131], v34 offset0:10 offset1:11
  ds_read2st64_b32 v[132:133], v34 offset0:12 offset1:13
  ds_read_b32 v134, v34 offset:3584
  s_waitcnt lgkmcnt(7)
  buffer_atomic_add_f32 v120, v32, s[36:39], s68 offen offset:0 sc1
  buffer_atomic_add_f32 v121, v32, s[36:39], s68 offen offset:256 sc1
  s_waitcnt lgkmcnt(6)
  buffer_atomic_add_f32 v122, v32, s[36:39], s68 offen offset:512 sc1
  buffer_atomic_add_f32 v123, v32, s[36:39], s68 offen offset:768 sc1
  s_waitcnt lgkmcnt(5)
  buffer_atomic_add_f32 v124, v32, s[36:39], s68 offen offset:1024 sc1
  buffer_atomic_add_f32 v125, v32, s[36:39], s68 offen offset:1280 sc1
  s_waitcnt lgkmcnt(4)
  buffer_atomic_add_f32 v126, v32, s[36:39], s68 offen offset:1536 sc1
  buffer_atomic_add_f32 v127, v32, s[36:39], s68 offen offset:1792 sc1
  s_waitcnt lgkmcnt(3)
  buffer_atomic_add_f32 v128, v32, s[36:39], s68 offen offset:2048 sc1
  buffer_atomic_add_f32 v129, v32, s[36:39], s68 offen offset:2304 sc1
  s_waitcnt lgkmcnt(2)
  buffer_atomic_add_f32 v130, v32, s[36:39], s68 offen offset:2560 sc1
  buffer_atomic_add_f32 v131, v32, s[36:39], s68 offen offset:2816 sc1
  s_waitcnt lgkmcnt(1)
  buffer_atomic_add_f32 v132, v32, s[36:39], s68 offen offset:3072 sc1
  buffer_atomic_add_f32 v133, v32, s[36:39], s68 offen offset:3328 sc1
  s_waitcnt lgkmcnt(0)
  buffer_atomic_add_f32 v134, v32, s[36:39], s68 offen offset:3584 sc1
  v_lshrrev_b32 v1, 4, v0
  v_and_b32 v2, 3, v0
  v_bfe_u32 v3, v0, 2, 2
  v_mul_u32_u24 v4, 960, v1
  v_add_u32 v4, 151552, v4
  v_mul_u32_u24 v5, 1920, v1
  v_add_u32 v5, 20480, v5
  v_mov_b32 v6, 155392
  v_cmp_eq_u32 vcc, v1, v2
  s_nop 1
  v_cndmask_b32 v4, v6, v4, vcc
  v_cndmask_b32 v5, v6, v5, vcc
  v_mad_u32_u24 v24, v3, 40, v4
  v_mad_u32_u24 v25, v3, 48, v5
  v_mov_b32 v94, 0
  v_mov_b32 v95, 0
  ds_read_b64_tr_b16 a[240:241], v24 offset:0
  ds_read_b64_tr_b16 a[242:243], v24 offset:160
  ds_read_b64_tr_b16 a[244:245], v24 offset:8
  ds_read_b64_tr_b16 a[246:247], v24 offset:168
  ds_read_b64_tr_b16 a[248:249], v24 offset:16
  ds_read_b64_tr_b16 a[250:251], v24 offset:176
  ds_read_b64_tr_b16 a[252:253], v24 offset:24
  ds_read_b64_tr_b16 a[254:255], v24 offset:184
  ds_read_b64_tr_b16 v[100:101], v24 offset:32
  ds_read_b64_tr_b16 v[102:103], v24 offset:192
  ds_read_b64_tr_b16 v[104:105], v24 offset:320
  ds_read_b64_tr_b16 v[106:107], v24 offset:480
  ds_read_b64_tr_b16 v[108:109], v24 offset:328
  ds_read_b64_tr_b16 v[110:111], v24 offset:488
  s_lshr_b32 s0, s62, 4
  s_lshl_b32 s0, s0, 2
  s_bfe_u32 s1, s62, 0x30001
  s_lshl_b32 s1, s1, 3
  s_add_u32 s0, s0, s1
  s_mov_b32 s1, 128
  v_bfe_u32 v1, v0, 2, 1
  v_and_b32 v2, 3, v0
  v_lshl_add_u32 v1, v1, 6, v2
  s_add_u32 s0, s0, s1
  s_lshl_b32 s0, s0, 8
  s_add_u32 s0, s0, 4096
  v_lshl_add_u32 v11, v1, 8, s0
  s_waitcnt vmcnt(15)
  s_waitcnt lgkmcnt(12)
  v_mfma_f32_16x16x32_bf16 v[64:67], a[240:243], v[84:87], 0
  ds_read_b64_tr_b16 a[240:241], v24 offset:336
  ds_read_b64_tr_b16 a[242:243], v24 offset:496
  s_waitcnt lgkmcnt(12)
  v_mfma_f32_16x16x32_bf16 v[68:71], a[244:247], v[84:87], 0
  ds_read_b64_tr_b16 a[244:245], v24 offset:344
  ds_read_b64_tr_b16 a[246:247], v24 offset:504
  s_waitcnt lgkmcnt(12)
  v_mfma_f32_16x16x32_bf16 v[72:75], a[248:251], v[84:87], 0
  ds_read_b64_tr_b16 a[248:249], v24 offset:352
  ds_read_b64_tr_b16 a[250:251], v24 offset:512
  s_waitcnt lgkmcnt(12)
  v_mfma_f32_16x16x32_bf16 v[76:79], a[252:255], v[84:87], 0
  ds_read_b64_tr_b16 a[252:253], v24 offset:640
  ds_read_b64_tr_b16 a[254:255], v24 offset:800
  s_waitcnt lgkmcnt(12)
  v_mfma_f32_16x16x32_bf16 v[80:83], v[100:103], v[84:87], 0
  ds_read_b64_tr_b16 v[100:101], v24 offset:648
  ds_read_b64_tr_b16 v[102:103], v24 offset:808
  s_waitcnt lgkmcnt(12)
  v_mfma_f32_16x16x32_bf16 v[64:67], v[104:107], v[88:91], v[64:67]
  ds_read_b64_tr_b16 v[104:105], v24 offset:656
  ds_read_b64_tr_b16 v[106:107], v24 offset:816
  s_waitcnt lgkmcnt(12)
  v_mfma_f32_16x16x32_bf16 v[68:71], v[108:111], v[88:91], v[68:71]
  ds_read_b64_tr_b16 v[108:109], v24 offset:664
  ds_read_b64_tr_b16 v[110:111], v24 offset:824
  s_waitcnt lgkmcnt(12)
  v_mfma_f32_16x16x32_bf16 v[72:75], a[240:243], v[88:91], v[72:75]
  ds_read_b64_tr_b16 a[240:241], v24 offset:672
  ds_read_b64_tr_b16 a[242:243], v24 offset:832
  s_waitcnt lgkmcnt(12)
  v_mfma_f32_16x16x32_bf16 v[76:79], a[244:247], v[88:91], v[76:79]
  s_waitcnt lgkmcnt(10)
  v_mfma_f32_16x16x32_bf16 v[80:83], a[248:251], v[88:91], v[80:83]
  s_waitcnt lgkmcnt(8)
  v_mfma_f32_16x16x32_bf16 v[64:67], a[252:255], v[92:95], v[64:67]
  s_waitcnt lgkmcnt(6)
  v_mfma_f32_16x16x32_bf16 v[68:71], v[100:103], v[92:95], v[68:71]
  s_waitcnt lgkmcnt(4)
  v_mfma_f32_16x16x32_bf16 v[72:75], v[104:107], v[92:95], v[72:75]
  s_waitcnt lgkmcnt(2)
  v_mfma_f32_16x16x32_bf16 v[76:79], v[108:111], v[92:95], v[76:79]
  s_waitcnt lgkmcnt(0)
  v_mfma_f32_16x16x32_bf16 v[80:83], a[240:243], v[92:95], v[80:83]
  v_rsq_f32 v96, v97
  s_nop 0
  v_mul_f32 v96, 0x3fb8aa3b, v96
  v_max3_f32 v2, v64, v65, v66
  v_min3_f32 v3, v64, v65, v66
  v_max3_f32 v2, v2, v67, v68
  v_min3_f32 v3, v3, v67, v68
  v_max3_f32 v2, v2, v69, v70
  v_min3_f32 v3, v3, v69, v70
  v_max3_f32 v2, v2, v71, v72
  v_min3_f32 v3, v3, v71, v72
  v_max3_f32 v2, v2, v73, v74
  v_min3_f32 v3, v3, v73, v74
  v_max3_f32 v2, v2, v75, v76
  v_min3_f32 v3, v3, v75, v76
  v_max3_f32 v2, v2, v77, v78
  v_min3_f32 v3, v3, v77, v78
  v_max3_f32 v2, v2, v79, v80
  v_min3_f32 v3, v3, v79, v80
  v_max3_f32 v2, v2, v81, v82
  v_min3_f32 v3, v3, v81, v82
  v_max_f32 v2, v2, v83
  v_min_f32 v3, v3, v83
  v_mul_f32 v2, v2, v96
  v_mul_f32 v3, v3, v96
  v_pk_fma_f32 v[44:45], v[64:65], v[96:97], v[2:3] op_sel:[0,0,0] op_sel_hi:[1,0,0] neg_lo:[0,0,1] neg_hi:[0,0,1]
  v_pk_fma_f32 v[64:65], v[64:65], v[96:97], v[2:3] op_sel:[0,0,1] op_sel_hi:[1,0,1] neg_lo:[1,0,0] neg_hi:[1,0,0]
  v_exp_f32 v44, v44
  v_exp_f32 v45, v45
  v_exp_f32 v64, v64
  v_exp_f32 v65, v65
  v_pk_fma_f32 v[46:47], v[66:67], v[96:97], v[2:3] op_sel:[0,0,0] op_sel_hi:[1,0,0] neg_lo:[0,0,1] neg_hi:[0,0,1]
  v_pk_fma_f32 v[66:67], v[66:67], v[96:97], v[2:3] op_sel:[0,0,1] op_sel_hi:[1,0,1] neg_lo:[1,0,0] neg_hi:[1,0,0]
  v_exp_f32 v46, v46
  v_exp_f32 v47, v47
  v_exp_f32 v66, v66
  v_exp_f32 v67, v67
  v_pk_fma_f32 v[48:49], v[68:69], v[96:97], v[2:3] op_sel:[0,0,0] op_sel_hi:[1,0,0] neg_lo:[0,0,1] neg_hi:[0,0,1]
  v_pk_fma_f32 v[68:69], v[68:69], v[96:97], v[2:3] op_sel:[0,0,1] op_sel_hi:[1,0,1] neg_lo:[1,0,0] neg_hi:[1,0,0]
  v_exp_f32 v48, v48
  v_exp_f32 v49, v49
  v_exp_f32 v68, v68
  v_exp_f32 v69, v69
  v_pk_fma_f32 v[50:51], v[70:71], v[96:97], v[2:3] op_sel:[0,0,0] op_sel_hi:[1,0,0] neg_lo:[0,0,1] neg_hi:[0,0,1]
  v_pk_fma_f32 v[70:71], v[70:71], v[96:97], v[2:3] op_sel:[0,0,1] op_sel_hi:[1,0,1] neg_lo:[1,0,0] neg_hi:[1,0,0]
  v_exp_f32 v50, v50
  v_exp_f32 v51, v51
  v_exp_f32 v70, v70
  v_exp_f32 v71, v71
  v_pk_fma_f32 v[52:53], v[72:73], v[96:97], v[2:3] op_sel:[0,0,0] op_sel_hi:[1,0,0] neg_lo:[0,0,1] neg_hi:[0,0,1]
  v_pk_fma_f32 v[72:73], v[72:73], v[96:97], v[2:3] op_sel:[0,0,1] op_sel_hi:[1,0,1] neg_lo:[1,0,0] neg_hi:[1,0,0]
  v_exp_f32 v52, v52
  v_exp_f32 v53, v53
  v_exp_f32 v72, v72
  v_exp_f32 v73, v73
  v_pk_fma_f32 v[54:55], v[74:75], v[96:97], v[2:3] op_sel:[0,0,0] op_sel_hi:[1,0,0] neg_lo:[0,0,1] neg_hi:[0,0,1]
  v_pk_fma_f32 v[74:75], v[74:75], v[96:97], v[2:3] op_sel:[0,0,1] op_sel_hi:[1,0,1] neg_lo:[1,0,0] neg_hi:[1,0,0]
  v_exp_f32 v54, v54
  v_exp_f32 v55, v55
  v_exp_f32 v74, v74
  v_exp_f32 v75, v75
  v_pk_fma_f32 v[56:57], v[76:77], v[96:97], v[2:3] op_sel:[0,0,0] op_sel_hi:[1,0,0] neg_lo:[0,0,1] neg_hi:[0,0,1]
  v_pk_fma_f32 v[76:77], v[76:77], v[96:97], v[2:3] op_sel:[0,0,1] op_sel_hi:[1,0,1] neg_lo:[1,0,0] neg_hi:[1,0,0]
  v_exp_f32 v56, v56
  v_exp_f32 v57, v57
  v_exp_f32 v76, v76
  v_exp_f32 v77, v77
  v_pk_fma_f32 v[58:59], v[78:79], v[96:97], v[2:3] op_sel:[0,0,0] op_sel_hi:[1,0,0] neg_lo:[0,0,1] neg_hi:[0,0,1]
  v_pk_fma_f32 v[78:79], v[78:79], v[96:97], v[2:3] op_sel:[0,0,1] op_sel_hi:[1,0,1] neg_lo:[1,0,0] neg_hi:[1,0,0]
  v_exp_f32 v58, v58
  v_exp_f32 v59, v59
  v_exp_f32 v78, v78
  v_exp_f32 v79, v79
  v_pk_fma_f32 v[60:61], v[80:81], v[96:97], v[2:3] op_sel:[0,0,0] op_sel_hi:[1,0,0] neg_lo:[0,0,1] neg_hi:[0,0,1]
  v_pk_fma_f32 v[80:81], v[80:81], v[96:97], v[2:3] op_sel:[0,0,1] op_sel_hi:[1,0,1] neg_lo:[1,0,0] neg_hi:[1,0,0]
  v_exp_f32 v60, v60
  v_exp_f32 v61, v61
  v_exp_f32 v80, v80
  v_exp_f32 v81, v81
  v_pk_fma_f32 v[62:63], v[82:83], v[96:97], v[2:3] op_sel:[0,0,0] op_sel_hi:[1,0,0] neg_lo:[0,0,1] neg_hi:[0,0,1]
  v_pk_fma_f32 v[82:83], v[82:83], v[96:97], v[2:3] op_sel:[0,0,1] op_sel_hi:[1,0,1] neg_lo:[1,0,0] neg_hi:[1,0,0]
  v_exp_f32 v62, v62
  v_exp_f32 v63, v63
  v_exp_f32 v82, v82
  v_exp_f32 v83, v83
  v_pk_add_f32 v[4:5], v[44:45], v[46:47]
  v_pk_add_f32 v[6:7], v[64:65], v[66:67]
  v_pk_add_f32 v[4:5], v[4:5], v[48:49]
  v_pk_add_f32 v[6:7], v[6:7], v[68:69]
  v_pk_add_f32 v[4:5], v[4:5], v[50:51]
  v_pk_add_f32 v[6:7], v[6:7], v[70:71]
  v_pk_add_f32 v[4:5], v[4:5], v[52:53]
  v_pk_add_f32 v[6:7], v[6:7], v[72:73]
  v_pk_add_f32 v[4:5], v[4:5], v[54:55]
  v_pk_add_f32 v[6:7], v[6:7], v[74:75]
  v_pk_add_f32 v[4:5], v[4:5], v[56:57]
  v_pk_add_f32 v[6:7], v[6:7], v[76:77]
  v_pk_add_f32 v[4:5], v[4:5], v[58:59]
  v_pk_add_f32 v[6:7], v[6:7], v[78:79]
  v_pk_add_f32 v[4:5], v[4:5], v[60:61]
  v_pk_add_f32 v[6:7], v[6:7], v[80:81]
  v_pk_add_f32 v[4:5], v[4:5], v[62:63]
  v_pk_add_f32 v[6:7], v[6:7], v[82:83]
  v_add_f32 v2, v4, v5
  v_add_f32 v3, v6, v7
  v_rcp_f32 v2, v2
  v_rcp_f32 v3, v3
  s_nop 0
  v_pk_mul_f32 v[44:45], v[44:45], v[2:3] op_sel:[0,0] op_sel_hi:[1,0]
  v_pk_mul_f32 v[46:47], v[46:47], v[2:3] op_sel:[0,0] op_sel_hi:[1,0]
  v_cvt_pk_bf16_f32 v44, v44, v45
  v_pk_mul_f32 v[48:49], v[48:49], v[2:3] op_sel:[0,0] op_sel_hi:[1,0]
  v_cvt_pk_bf16_f32 v45, v46, v47
  buffer_load_dword v10, v11, s[36:39], 0 offen sc1
  v_pk_mul_f32 v[50:51], v[50:51], v[2:3] op_sel:[0,0] op_sel_hi:[1,0]
  v_cvt_pk_bf16_f32 v46, v48, v49
  v_pk_mul_f32 v[52:53], v[52:53], v[2:3] op_sel:[0,0] op_sel_hi:[1,0]
  v_cvt_pk_bf16_f32 v47, v50, v51
  v_pk_mul_f32 v[54:55], v[54:55], v[2:3] op_sel:[0,0] op_sel_hi:[1,0]
  v_cvt_pk_bf16_f32 v48, v52, v53
  v_pk_mul_f32 v[56:57], v[56:57], v[2:3] op_sel:[0,0] op_sel_hi:[1,0]
  v_cvt_pk_bf16_f32 v49, v54, v55
  v_pk_mul_f32 v[58:59], v[58:59], v[2:3] op_sel:[0,0] op_sel_hi:[1,0]
  v_cvt_pk_bf16_f32 v50, v56, v57
  v_pk_mul_f32 v[60:61], v[60:61], v[2:3] op_sel:[0,0] op_sel_hi:[1,0]
  v_cvt_pk_bf16_f32 v51, v58, v59
  v_pk_mul_f32 v[62:63], v[62:63], v[2:3] op_sel:[0,0] op_sel_hi:[1,0]
  v_cvt_pk_bf16_f32 v52, v60, v61
  v_pk_mul_f32 v[64:65], v[64:65], v[2:3] op_sel:[0,1] op_sel_hi:[1,1]
  v_cvt_pk_bf16_f32 v53, v62, v63
  v_pk_mul_f32 v[66:67], v[66:67], v[2:3] op_sel:[0,1] op_sel_hi:[1,1]
  v_cvt_pk_bf16_f32 v54, v64, v65
  v_pk_mul_f32 v[68:69], v[68:69], v[2:3] op_sel:[0,1] op_sel_hi:[1,1]
  v_cvt_pk_bf16_f32 v55, v66, v67
  v_pk_mul_f32 v[70:71], v[70:71], v[2:3] op_sel:[0,1] op_sel_hi:[1,1]
  v_cvt_pk_bf16_f32 v56, v68, v69
  v_pk_mul_f32 v[72:73], v[72:73], v[2:3] op_sel:[0,1] op_sel_hi:[1,1]
  v_cvt_pk_bf16_f32 v57, v70, v71
  v_pk_mul_f32 v[74:75], v[74:75], v[2:3] op_sel:[0,1] op_sel_hi:[1,1]
  v_cvt_pk_bf16_f32 v58, v72, v73
  v_pk_mul_f32 v[76:77], v[76:77], v[2:3] op_sel:[0,1] op_sel_hi:[1,1]
  v_cvt_pk_bf16_f32 v59, v74, v75
  v_pk_mul_f32 v[78:79], v[78:79], v[2:3] op_sel:[0,1] op_sel_hi:[1,1]
  v_cvt_pk_bf16_f32 v60, v76, v77
  v_pk_mul_f32 v[80:81], v[80:81], v[2:3] op_sel:[0,1] op_sel_hi:[1,1]
  v_cvt_pk_bf16_f32 v61, v78, v79
  v_pk_mul_f32 v[82:83], v[82:83], v[2:3] op_sel:[0,1] op_sel_hi:[1,1]
  v_cvt_pk_bf16_f32 v62, v80, v81
  v_cvt_pk_bf16_f32 v63, v82, v83
  s_waitcnt vmcnt(1)
  s_barrier
  s_add_u32 s18, s64, 4
  v_mov_b32 v14, s18
  buffer_store_dword v14, v9, s[36:39], 0 offen sc1
  s_branch f_tail
f_prole:
  s_lshl_b32 s68, s3, 3
  s_add_u32 s68, s68, s61
  s_cmp_lt_u32 s68, 2
  s_cselect_b32 s69, 8, -2
  s_cselect_b32 s70, 1, 0
  s_mov_b32 s71, 3456
  s_cselect_b32 s71, 3840, s71
  s_add_u32 s68, s68, s69
  s_cmp_lt_u32 s68, 27
  s_cselect_b32 s69, 0, 3
  s_sub_u32 s68, s68, s69
  s_lshl_b32 s69, s68, 7
  v_lshrrev_b32 v1, 3, v0
  v_and_b32 v2, 7, v0
  v_bfe_u32 v3, v0, 4, 1
  v_lshlrev_b32 v3, 2, v3
  v_xor_b32 v3, v3, v2
  v_mul_u32_u24 v5, s71, v1
  v_lshl_add_u32 v24, v3, 4, v5
  s_lshl_b32 s68, s71, 3
  s_sub_u32 s68, s68, 1024
  v_add_u32 v25, s68, v24
  v_add_u32 v26, s68, v25
  v_add_u32 v27, s68, v26
  s_lshl_b32 s67, s3, 12
  s_add_u32 s67, s67, 53248
  s_waitcnt lgkmcnt(0)
  s_mov_b32 s24, s4
  s_and_b32 s25, s5, 0xffff
  s_mov_b32 s26, 0x280000
  s_mov_b32 s27, 0x20000
  s_mov_b32 s36, s20
  s_and_b32 s37, s21, 0xffff
  s_mov_b32 s38, 0x10000000
  s_mov_b32 s39, 0x20000
  s_cmp_eq_u32 s70, 1
  s_cselect_b64 s[28:29], s[6:7], s[14:15]
  s_mov_b32 s30, 2211840
  s_cselect_b32 s30, 2457600, s30
  s_and_b32 s29, s29, 0xffff
  s_mov_b32 s31, 0x20000
  s_mov_b32 s4, s69
  s_lshl_b32 s5, s71, 5
  s_add_u32 m0, s66, 0
  s_add_u32 s21, s65, 0
  buffer_load_dwordx4 v16, s[24:27], s21 offen offset:0 lds
  s_mov_b32 s48, s22
  s_and_b32 s49, s23, 0xffff
  s_mov_b32 s50, 0x280000
  s_mov_b32 s51, 0x20000
  s_and_b32 s68, s2, 3
  s_lshl_b32 s68, s68, 1
  s_bfe_u32 s69, s2, 0x10003
  s_add_u32 s68, s68, s69
  buffer_load_dwordx4 v17, s[24:27], s21 offen offset:1024 lds
  s_bfe_u32 s69, s2, 0x30004
  s_lshl_b32 s22, s69, 3
  s_add_u32 s22, s22, s68
  s_cmp_lt_u32 s22, 2
  s_cselect_b32 s69, 8, 28
  s_add_u32 s22, s22, s69
  s_bfe_u32 s69, s2, 0x40003
  s_cmp_ge_u32 s69, 8
  s_cselect_b32 s22, s68, s22
  s_cmp_ge_u32 s69, 13
  s_cselect_b32 s68, 7, 0
  s_add_u32 s68, s68, s69
  buffer_load_dwordx4 v18, s[24:27], s21 offen offset:2048 lds
  s_cmp_ge_u32 s69, 10
  s_cselect_b32 s22, s68, s22
  s_cselect_b32 s69, 1, 0
  s_bfe_u32 s68, s2, 0x10001
  s_mul_i32 s68, s68, 5
  s_mul_i32 s68, s68, s69
  s_add_u32 s22, s22, s68
  s_and_b32 s68, s2, s69
  buffer_load_dwordx4 v19, s[24:27], s21 offen offset:3072 lds
  s_mul_i32 s68, s68, 3
  s_add_u32 s22, s22, s68
  s_bfe_u32 s69, s2, 0x40003
  s_lshl_b32 s69, 1, s69
  s_and_b32 s69, s69, 0x9000
  s_mul_i32 s69, s69, s68
  s_add_u32 s22, s22, s69
  s_min_u32 s22, s22, 63
  s_cmp_lt_u32 s22, 30
  s_cselect_b64 s[56:57], s[6:7], s[14:15]
  s_mov_b32 s58, 2211840
  s_cselect_b32 s58, 2457600, s58
  s_and_b32 s57, s57, 0xffff
  s_mov_b32 s59, 0x20000
  s_bfe_u32 s68, s2, 0x10006
  s_and_b32 s69, s2, 7
  s_lshl_b32 s69, s69, 1
  s_add_u32 s68, s68, s69
  s_lshl_b32 s69, s3, 4
  s_add_u32 s68, s68, s69
  s_cmp_lt_u32 s68, 54
  s_cselect_b64 s[52:53], s[18:19], s[10:11]
  s_mov_b32 s54, 819200
  s_cselect_b32 s54, 2211840, s54
  s_and_b32 s53, s53, 0xffff
  s_mov_b32 s55, 0x20000
  s_mov_b32 s32, s10
  s_and_b32 s33, s11, 0xffff
  s_mov_b32 s34, 0xc8000
  s_mov_b32 s35, 0x20000
  s_mov_b32 s40, s16
  s_and_b32 s41, s17, 0xffff
  s_mov_b32 s42, 0xd80
  s_mov_b32 s43, 0x20000
  s_mov_b32 s44, s8
  s_and_b32 s45, s9, 0xffff
  s_mov_b32 s46, 0x6400
  s_mov_b32 s47, 0x20000
  s_add_u32 m0, s67, 0
  s_nop 0
  buffer_load_dwordx4 v24, s[28:31], s4 offen offset:0 lds
  s_bfe_u32 s68, s2, 0x10006
  s_and_b32 s69, s2, 7
  s_lshl_b32 s69, s69, 1
  s_add_u32 s68, s68, s69
  s_lshl_b32 s69, s3, 4
  s_add_u32 s68, s68, s69
  s_bfe_u32 s16, s2, 0x30003
  s_mul_i32 s17, s16, 74
  s_add_u32 s13, s17, s68
  s_mul_i32 s13, s13, 5120
  s_add_u32 s13, s13, 131072
  s_sub_u32 s12, s68, 54
  s_mul_i32 s19, s12, 52
  s_lshr_b32 s19, s19, 8
  s_mul_i32 s69, s19, 5
  s_sub_u32 s18, s12, s69
  buffer_load_dwordx4 v25, s[28:31], s4 offen offset:1024 lds
  s_mul_i32 s69, s19, 160
  s_lshr_b32 s19, s18, 1
  s_mul_i32 s19, s19, 80
  s_and_b32 s70, s18, 1
  s_lshl_b32 s70, s70, 3
  s_add_u32 s19, s19, s70
  s_cmp_eq_u32 s18, 4
  s_cselect_b32 s19, 16, s19
  s_cselect_b32 s70, 40, 20
  s_cselect_b32 s71, 20, 4
  s_add_u32 s69, s69, s19
  s_lshl_b32 s19, s68, 5
  s_cmp_lt_u32 s68, 54
  s_cselect_b32 s69, s19, s69
  s_cselect_b32 s70, 8, s70
  s_cselect_b32 s71, 4, s71
  s_mul_i32 s69, s69, 1280
  s_mul_i32 s16, s16, 160
  s_add_u32 s12, s16, s69
  buffer_load_dwordx4 v26, s[28:31], s4 offen offset:2048 lds
  v_add_u32 v1, 0, v0
  v_mul_u32_u24 v2, 6554, v1
  v_lshrrev_b32 v2, 16, v2
  v_mul_u32_u24 v3, 10, v2
  v_sub_u32 v3, v1, v3
  v_lshrrev_b32 v4, 3, v2
  v_mul_u32_u24 v4, s70, v4
  v_bfe_u32 v5, v2, 2, 1
  v_mad_u32_u24 v4, v5, s71, v4
  v_and_b32 v5, 3, v2
  v_add_u32 v4, v4, v5
  v_mul_u32_u24 v4, 1280, v4
  v_lshl_add_u32 v56, v3, 4, v4
  v_add_u32 v1, 64, v0
  v_mul_u32_u24 v2, 6554, v1
  v_lshrrev_b32 v2, 16, v2
  buffer_load_dwordx4 v27, s[28:31], s4 offen offset:3072 lds
  s_add_u32 m0, s67, 16384
  s_add_u32 s4, s4, s5
  v_mul_u32_u24 v3, 10, v2
  v_sub_u32 v3, v1, v3
  v_lshrrev_b32 v4, 3, v2
  v_mul_u32_u24 v4, s70, v4
  v_bfe_u32 v5, v2, 2, 1
  v_mad_u32_u24 v4, v5, s71, v4
  v_and_b32 v5, 3, v2
  v_add_u32 v4, v4, v5
  v_mul_u32_u24 v4, 1280, v4
  v_lshl_add_u32 v57, v3, 4, v4
  v_subrev_u32 v57, 1024, v57
  v_add_u32 v1, 128, v0
  v_mul_u32_u24 v2, 6554, v1
  v_lshrrev_b32 v2, 16, v2
  v_mul_u32_u24 v3, 10, v2
  v_sub_u32 v3, v1, v3
  buffer_load_dwordx4 v24, s[28:31], s4 offen offset:0 lds
  v_lshrrev_b32 v4, 3, v2
  v_mul_u32_u24 v4, s70, v4
  v_bfe_u32 v5, v2, 2, 1
  v_mad_u32_u24 v4, v5, s71, v4
  v_and_b32 v5, 3, v2
  v_add_u32 v4, v4, v5
  v_mul_u32_u24 v4, 1280, v4
  v_lshl_add_u32 v58, v3, 4, v4
  v_subrev_u32 v58, 2048, v58
  v_add_u32 v1, 192, v0
  v_mul_u32_u24 v2, 6554, v1
  v_lshrrev_b32 v2, 16, v2
  v_mul_u32_u24 v3, 10, v2
  v_sub_u32 v3, v1, v3
  v_lshrrev_b32 v4, 3, v2
  v_mul_u32_u24 v4, s70, v4
  buffer_load_dwordx4 v25, s[28:31], s4 offen offset:1024 lds
  v_bfe_u32 v5, v2, 2, 1
  v_mad_u32_u24 v4, v5, s71, v4
  v_and_b32 v5, 3, v2
  v_add_u32 v4, v4, v5
  v_mul_u32_u24 v4, 1280, v4
  v_lshl_add_u32 v59, v3, 4, v4
  v_subrev_u32 v59, 3072, v59
  v_add_u32 v1, 256, v0
  v_mul_u32_u24 v2, 6554, v1
  v_lshrrev_b32 v2, 16, v2
  v_mul_u32_u24 v3, 10, v2
  v_sub_u32 v3, v1, v3
  v_lshrrev_b32 v4, 3, v2
  v_mul_u32_u24 v4, s70, v4
  v_bfe_u32 v5, v2, 2, 1
  v_mad_u32_u24 v4, v5, s71, v4
  buffer_load_dwordx4 v26, s[28:31], s4 offen offset:2048 lds
  v_and_b32 v5, 3, v2
  v_add_u32 v4, v4, v5
  v_mul_u32_u24 v4, 1280, v4
  v_lshl_add_u32 v60, v3, 4, v4
  s_bfe_u32 s68, s2, 0x10006
  s_lshl_b32 s68, s68, 3
  s_and_b32 s69, s2, 7
  s_add_u32 s68, s68, s69
  s_add_u32 s68, s68, 10
  s_add_u32 s17, s17, s68
  s_add_u32 s17, s17, 54
  s_mul_i32 s17, s17, 5120
  s_add_u32 s17, s17, 131072
  s_mul_i32 s19, s68, 52
  s_lshr_b32 s19, s19, 8
  s_mul_i32 s69, s19, 5
  buffer_load_dwordx4 v27, s[28:31], s4 offen offset:3072 lds
  s_sub_u32 s18, s68, s69
  s_mul_i32 s69, s19, 160
  s_lshr_b32 s19, s18, 1
  s_mul_i32 s19, s19, 80
  s_and_b32 s70, s18, 1
  s_lshl_b32 s70, s70, 3
  s_add_u32 s19, s19, s70
  s_cmp_eq_u32 s18, 4
  s_cselect_b32 s19, 16, s19
  s_cselect_b32 s70, 40, 20
  s_cselect_b32 s71, 20, 4
  s_add_u32 s69, s69, s19
  s_mul_i32 s69, s69, 1280
  s_add_u32 s16, s16, s69
  s_cmp_lt_u32 s68, 20
  s_cselect_b32 s17, s17, 0x40000000
  s_cselect_b32 s16, s16, 0x40000000
  s_cmp_eq_u32 s3, 0
  s_cselect_b64 s[10:11], -1, 0
  s_lshl_b32 s18, s3, 6
  v_add_u32 v1, s18, v0
  v_mul_u32_u24 v2, 6554, v1
  v_lshrrev_b32 v2, 16, v2
  v_mul_u32_u24 v3, 10, v2
  v_sub_u32 v3, v1, v3
  v_lshrrev_b32 v4, 3, v2
  v_mul_u32_u24 v4, s70, v4
  v_bfe_u32 v5, v2, 2, 1
  v_mad_u32_u24 v4, v5, s71, v4
  v_and_b32 v5, 3, v2
  v_add_u32 v4, v4, v5
  v_mul_u32_u24 v4, 1280, v4
  v_lshl_add_u32 v28, v3, 4, v4
  v_add_u32 v1, 256, v0
  v_mul_u32_u24 v2, 6554, v1
  v_lshrrev_b32 v2, 16, v2
  v_mul_u32_u24 v3, 10, v2
  v_sub_u32 v3, v1, v3
  v_lshrrev_b32 v4, 3, v2
  v_mul_u32_u24 v4, s70, v4
  v_bfe_u32 v5, v2, 2, 1
  v_mad_u32_u24 v4, v5, s71, v4
  v_and_b32 v5, 3, v2
  v_add_u32 v4, v4, v5
  v_mul_u32_u24 v4, 1280, v4
  v_lshl_add_u32 v29, v3, 4, v4
  v_mov_b32 v55, 0
  buffer_load_dword v55, v55, s[36:39], 0 offen sc1
  s_add_u32 m0, s66, 8192
  s_nop 0
  buffer_load_dwordx4 v56, s[52:55], s12 offen offset:0 lds
  v_and_b32 v1, 31, v0
  v_lshrrev_b32 v2, 5, v0
  v_bfe_u32 v3, v0, 1, 3
  v_lshlrev_b32 v4, 7, v1
  v_add_u32 v4, s66, v4
  v_add_u32 v5, 0, v2
  v_xor_b32 v5, v5, v3
  buffer_load_dwordx4 v57, s[52:55], s12 offen offset:1024 lds
  v_lshl_add_u32 v20, v5, 4, v4
  v_add_u32 v5, 2, v2
  v_xor_b32 v5, v5, v3
  v_lshl_add_u32 v21, v5, 4, v4
  v_add_u32 v5, 4, v2
  v_xor_b32 v5, v5, v3
  v_lshl_add_u32 v22, v5, 4, v4
  buffer_load_dwordx4 v58, s[52:55], s12 offen offset:2048 lds
  v_add_u32 v5, 6, v2
  v_xor_b32 v5, v5, v3
  v_lshl_add_u32 v23, v5, 4, v4
  v_lshrrev_b32 v3, 4, v1
  v_mul_u32_u24 v3, 96256, v3
  v_lshl_add_u32 v3, v2, 8, v3
  v_and_b32 v4, 15, v0
  buffer_load_dwordx4 v59, s[52:55], s12 offen offset:3072 lds
  s_add_u32 m0, m0, 4096
  v_lshl_add_u32 v44, v4, 4, v3
  s_lshl_b32 s68, s60, 3
  s_lshl_b32 s69, s3, 1
  s_add_u32 s68, s68, s69
  s_mul_i32 s6, s68, 96256
  s_add_u32 s6, s6, 3276800
  s_lshl_b32 s68, s2, 8
  buffer_load_dwordx4 v60, s[52:55], s12 offen lds
  s_lshl_b32 m0, s3, 10
  s_add_u32 m0, m0, 157312
  s_add_u32 s68, s68, 4096
  v_mov_b32 v3, s68
  v_mov_b32 v4, 0x40000000
  v_cmp_eq_u32 vcc, 0, v8
  s_nop 1
  v_cndmask_b32 v9, v4, v3, vcc
  v_and_b32 v11, 127, v8
  v_lshlrev_b32 v11, 8, v11
  buffer_load_dwordx4 v28, s[32:35], s16 offen lds
  s_mov_b32 m0, 161408
  v_add_u32 v11, 36864, v11
  s_mul_i32 s8, s63, 74
  s_add_u32 s8, s8, s3
  s_mul_i32 s8, s8, 5120
  s_add_u32 s8, s8, 131072
  s_add_u32 s20, s8, 266240
  s_cmp_lt_u32 s3, 2
  s_cselect_b32 s20, s20, 0x40000000
  s_mul_i32 s23, s3, 20480
  s_add_u32 s23, s23, 276480
  s_mov_b64 exec, s[10:11]
  buffer_load_dwordx4 v29, s[32:35], s16 offen lds
  s_mov_b64 exec, -1
  s_add_u32 m0, s66, 4096
  s_add_u32 s21, s65, 128
  s_add_u32 s23, s23, s8
  v_and_b32 v1, 3, v0
  v_bfe_u32 v2, v0, 2, 1
  v_bfe_u32 v3, v0, 3, 2
  v_lshrrev_b32 v4, 1, v3
  v_lshl_add_u32 v4, v4, 1, v2
  v_and_b32 v5, 1, v3
  buffer_load_dwordx4 v16, s[24:27], s21 offen offset:0 lds
  v_lshl_add_u32 v5, v5, 2, v1
  v_lshl_add_u32 v4, v4, 3, v5
  v_lshlrev_b32 v47, 4, v4
  v_lshrrev_b32 v1, 5, v0
  v_bfe_u32 v2, v0, 2, 2
  v_and_b32 v3, 1, v0
  v_bfe_u32 v4, v0, 1, 1
  buffer_load_dwordx4 v17, s[24:27], s21 offen offset:1024 lds
  v_bfe_u32 v5, v0, 4, 1
  v_lshl_add_u32 v4, v5, 1, v4
  v_lshl_add_u32 v6, v1, 3, v2
  v_lshrrev_b32 v7, 1, v4
  v_lshlrev_b32 v7, 2, v7
  v_lshl_add_u32 v7, v3, 1, v7
  v_and_b32 v5, 1, v4
  buffer_load_dwordx4 v18, s[24:27], s21 offen offset:2048 lds
  v_add_u32 v7, v7, v5
  v_lshlrev_b32 v7, 3, v7
  v_lshl_add_u32 v7, v6, 7, v7
  v_bfe_u32 v5, v0, 3, 1
  v_lshl_add_u32 v32, v5, 6, v7
  v_add_u32 v32, 53248, v32
  v_xor_b32 v33, 64, v32
  buffer_load_dwordx4 v19, s[24:27], s21 offen offset:3072 lds
  s_add_u32 m0, s67, 32768
  s_add_u32 s4, s4, s5
  v_add_u32 v34, 65536, v32
  v_add_u32 v35, 65536, v33
  v_lshrrev_b32 v1, 4, v0
  v_bfe_u32 v2, v0, 2, 2
  v_lshl_add_u32 v1, v1, 3, v2
  v_mul_u32_u24 v1, 160, v1
  v_and_b32 v2, 3, v0
  buffer_load_dwordx4 v24, s[28:31], s4 offen offset:0 lds
  v_lshl_add_u32 v3, v2, 4, v1
  v_lshl_add_u32 v4, v2, 3, v1
  s_add_u32 s68, s66, 8192
  v_add_u32 v61, s68, v3
  v_add_u32 v62, s68, v4
  s_lshr_b32 s68, s3, 1
  s_lshl_b32 s68, s68, 6
  buffer_load_dwordx4 v25, s[28:31], s4 offen offset:1024 lds
  s_and_b32 s69, s3, 1
  s_lshl_b32 s69, s69, 3
  s_add_u32 s68, s68, s69
  s_add_u32 s68, s68, 157312
  v_add_u32 v30, s68, v3
  v_add_u32 v31, 157312, v4
  s_lshl_b32 s68, s60, 7
  buffer_load_dwordx4 v26, s[28:31], s4 offen offset:2048 lds
  s_lshl_b32 s69, s61, 4
  s_add_u32 s68, s68, s69
  s_lshl_b32 s69, s3, 2
  s_add_u32 s68, s68, s69
  s_mul_i32 s7, s68, 1280
  v_lshrrev_b32 v1, 4, v0
  v_and_b32 v2, 15, v0
  buffer_load_dwordx4 v27, s[28:31], s4 offen offset:3072 lds
  s_add_u32 m0, s67, 49152
  s_add_u32 s4, s4, s5
  v_mul_u32_u24 v1, 1280, v1
  v_lshl_add_u32 v15, v2, 4, v1
  s_cmp_lt_u32 s22, 30
  s_mov_b32 s70, 3456
  s_cselect_b32 s70, 3840, s70
  s_cselect_b32 s71, 0, 30
  s_sub_u32 s68, s22, s71
  buffer_load_dwordx4 v24, s[28:31], s4 offen offset:0 lds
  s_lshl_b32 s68, s68, 7
  s_bfe_u32 s69, s2, 0x10002
  s_lshl_b32 s71, s3, 1
  s_add_u32 s69, s69, s71
  s_mul_i32 s69, s69, 80
  s_mul_i32 s69, s69, s70
  s_add_u32 s68, s68, s69
  buffer_load_dwordx4 v25, s[28:31], s4 offen offset:1024 lds
  s_cmp_lt_u32 s22, 57
  s_cselect_b32 s9, s68, 0x40000000
  v_lshrrev_b32 v1, 3, v0
  v_and_b32 v2, 7, v0
  v_mul_u32_u24 v1, s70, v1
  v_lshl_add_u32 v54, v2, 4, v1
  s_lshl_b32 s15, s70, 3
  buffer_load_dwordx4 v26, s[28:31], s4 offen offset:2048 lds
  s_lshl_b32 s0, s63, 2
  s_add_u32 s0, s0, s3
  s_mul_i32 s0, s0, 800
  s_and_b32 s1, s3, 1
  s_mul_i32 s1, s1, 10
  v_add_u32 v1, s1, v0
  v_subrev_u32 v2, 50, v1
  buffer_load_dwordx4 v27, s[28:31], s4 offen offset:3072 lds
  v_min_u32 v1, v1, v2
  v_lshlrev_b32 v1, 4, v1
  v_mov_b32 v2, 0x40000000
  v_cmp_gt_u32 vcc, 50, v0
  s_nop 1
  v_cndmask_b32 v1, v2, v1, vcc
  v_cndmask_b32 v3, v2, v12, vcc
  buffer_load_dwordx4 a[28:31], v1, s[44:47], s0 offen
  s_waitcnt vmcnt(25) lgkmcnt(0)
  s_barrier
  ds_read_b128 a[224:227], v20 offset:0
  ds_read_b64_tr_b16 a[160:161], v32 offset:0
  ds_read_b64_tr_b16 a[162:163], v32 offset:512
  ds_read_b64_tr_b16 a[164:165], v33 offset:0
  ds_read_b64_tr_b16 a[166:167], v33 offset:512
  ds_read_b64_tr_b16 a[168:169], v32 offset:4096
  ds_read_b64_tr_b16 a[170:171], v32 offset:4608
  ds_read_b64_tr_b16 a[172:173], v33 offset:4096
  ds_read_b64_tr_b16 a[174:175], v33 offset:4608
  ds_read_b64_tr_b16 a[176:177], v32 offset:8192
  ds_read_b64_tr_b16 a[178:179], v32 offset:8704
  ds_read_b64_tr_b16 a[180:181], v33 offset:8192
  ds_read_b64_tr_b16 a[182:183], v33 offset:8704
  ds_read_b64_tr_b16 a[184:185], v32 offset:12288
  ds_read_b64_tr_b16 a[186:187], v32 offset:12800
  ds_read_b64_tr_b16 a[188:189], v33 offset:12288
  ds_read_b64_tr_b16 a[190:191], v33 offset:12800
  ds_read_b128 a[228:231], v21 offset:0
  s_waitcnt lgkmcnt(13)
  v_mfma_f32_32x32x16_bf16 v[128:143], a[160:163], a[224:227], 0
  ds_read_b64_tr_b16 a[192:193], v32 offset:2048
  ds_read_b64_tr_b16 a[194:195], v32 offset:2560
  ds_read_b64_tr_b16 a[196:197], v33 offset:2048
  v_mfma_f32_32x32x16_bf16 v[144:159], a[164:167], a[224:227], 0
  ds_read_b64_tr_b16 a[198:199], v33 offset:2560
  ds_read_b64_tr_b16 a[200:201], v32 offset:6144
  ds_read_b64_tr_b16 a[202:203], v32 offset:6656
  buffer_load_dwordx4 v[84:87], v54, s[56:59], s9 offen
  s_add_u32 s9, s9, s15
  s_waitcnt lgkmcnt(15)
  v_mfma_f32_32x32x16_bf16 v[160:175], a[168:171], a[224:227], 0
  ds_read_b64_tr_b16 a[204:205], v33 offset:6144
  ds_read_b64_tr_b16 a[206:207], v33 offset:6656
  buffer_load_dwordx4 v[88:91], v54, s[56:59], s9 offen
  s_add_u32 s9, s9, s15
  v_and_b32 v1, 15, v0
  v_mfma_f32_32x32x16_bf16 v[176:191], a[172:175], a[224:227], 0
  ds_read_b64_tr_b16 a[208:209], v32 offset:10240
  ds_read_b64_tr_b16 a[210:211], v32 offset:10752
  v_lshrrev_b32 v2, 1, v1
  v_and_b32 v3, 1, v0
  v_lshlrev_b32 v3, 4, v3
  v_mov_b32 v4, 0x3f80
  s_waitcnt lgkmcnt(15)
  v_mfma_f32_32x32x16_bf16 v[192:207], a[176:179], a[224:227], 0
  ds_read_b64_tr_b16 a[212:213], v33 offset:10240
  ds_read_b64_tr_b16 a[214:215], v33 offset:10752
  buffer_load_dwordx4 v[92:95], v54, s[56:59], s9 offen
  s_add_u32 s9, s9, s15
  v_lshlrev_b32 v4, v3, v4
  v_mfma_f32_32x32x16_bf16 v[208:223], a[180:183], a[224:227], 0
  ds_read_b64_tr_b16 a[216:217], v32 offset:14336
  ds_read_b64_tr_b16 a[218:219], v32 offset:14848
  buffer_load_dwordx4 v[96:99], v54, s[56:59], s9 offen
  s_add_u32 s9, s9, s15
  v_cmp_eq_u32 vcc, 0, v2
  s_nop 1
  v_cndmask_b32 v36, 0, v4, vcc
  s_waitcnt lgkmcnt(15)
  v_mfma_f32_32x32x16_bf16 v[224:239], a[184:187], a[224:227], 0
  ds_read_b64_tr_b16 a[220:221], v33 offset:14336
  ds_read_b64_tr_b16 a[222:223], v33 offset:14848
  buffer_load_dwordx4 v[100:103], v54, s[56:59], s9 offen
  s_add_u32 s9, s9, s15
  v_mfma_f32_32x32x16_bf16 v[240:255], a[188:191], a[224:227], 0
  ds_read_b128 a[232:235], v22 offset:0
  ds_read_b128 a[236:239], v23 offset:0
  v_cmp_eq_u32 vcc, 1, v2
  s_nop 1
  v_cndmask_b32 v37, 0, v4, vcc
  s_waitcnt lgkmcnt(14)
  v_mfma_f32_32x32x16_bf16 v[128:143], a[192:195], a[228:231], v[128:143]
  buffer_load_dwordx4 v[104:107], v54, s[56:59], s9 offen
  s_add_u32 s9, s9, s15
  v_cmp_eq_u32 vcc, 2, v2
  s_nop 1
  v_cndmask_b32 v38, 0, v4, vcc
  v_mfma_f32_32x32x16_bf16 v[144:159], a[196:199], a[228:231], v[144:159]
  buffer_load_dwordx4 v[108:111], v54, s[56:59], s9 offen
  s_add_u32 s9, s9, s15
  v_cmp_eq_u32 vcc, 3, v2
  s_nop 1
  v_cndmask_b32 v39, 0, v4, vcc
  s_waitcnt lgkmcnt(10)
  v_mfma_f32_32x32x16_bf16 v[160:175], a[200:203], a[228:231], v[160:175]
  s_waitcnt vmcnt(28) lgkmcnt(0)
  s_barrier
  ds_read_b64_tr_b16 a[160:161], v32 offset:16384
  ds_read_b64_tr_b16 a[162:163], v32 offset:16896
  ds_read_b64_tr_b16 a[164:165], v33 offset:16384
  v_mfma_f32_32x32x16_bf16 v[176:191], a[204:207], a[228:231], v[176:191]
  ds_read_b64_tr_b16 a[166:167], v33 offset:16896
  ds_read_b64_tr_b16 a[168:169], v32 offset:20480
  ds_read_b64_tr_b16 a[170:171], v32 offset:20992
  buffer_load_dwordx4 v[112:115], v54, s[56:59], s9 offen
  s_add_u32 s9, s9, s15
  v_mfma_f32_32x32x16_bf16 v[192:207], a[208:211], a[228:231], v[192:207]
  ds_read_b64_tr_b16 a[172:173], v33 offset:20480
  ds_read_b64_tr_b16 a[174:175], v33 offset:20992
  ds_read_b64_tr_b16 a[176:177], v32 offset:24576
  buffer_load_dwordx4 v[116:119], v54, s[56:59], s9 offen
  s_add_u32 s9, s9, s15
  v_mfma_f32_32x32x16_bf16 v[208:223], a[212:215], a[228:231], v[208:223]
  ds_read_b64_tr_b16 a[178:179], v32 offset:25088
  ds_read_b64_tr_b16 a[180:181], v33 offset:24576
  ds_read_b64_tr_b16 a[182:183], v33 offset:25088
  buffer_load_dwordx4 v[120:123], v54, s[56:59], s9 offen
  s_sub_u32 s18, s22, 30
  s_lshl_b32 s18, s18, 7
  s_min_u32 s18, s18, 0x40000000
  v_mfma_f32_32x32x16_bf16 v[224:239], a[216:219], a[228:231], v[224:239]
  ds_read_b64_tr_b16 a[184:185], v32 offset:28672
  ds_read_b64_tr_b16 a[186:187], v32 offset:29184
  v_and_b32 v2, 7, v0
  v_bfe_u32 v3, v0, 4, 1
  v_mfma_f32_32x32x16_bf16 v[240:255], a[220:223], a[228:231], v[240:255]
  ds_read_b64_tr_b16 a[188:189], v33 offset:28672
  ds_read_b64_tr_b16 a[190:191], v33 offset:29184
  v_lshlrev_b32 v14, 1, v0
  buffer_load_ushort v63, v14, s[40:43], s18 offen
  s_add_u32 m0, s67, 65536
  s_add_u32 s4, s4, s5
  s_waitcnt lgkmcnt(12)
  v_mfma_f32_32x32x16_bf16 v[128:143], a[160:163], a[232:235], v[128:143]
  ds_read_b64_tr_b16 a[192:193], v32 offset:18432
  ds_read_b64_tr_b16 a[194:195], v32 offset:18944
  buffer_load_dwordx4 v24, s[28:31], s4 offen offset:0 lds
  v_lshlrev_b32 v2, 7, v2
  v_lshl_add_u32 v2, v3, 6, v2
  v_mfma_f32_32x32x16_bf16 v[144:159], a[164:167], a[232:235], v[144:159]
  ds_read_b64_tr_b16 a[196:197], v33 offset:18432
  ds_read_b64_tr_b16 a[198:199], v33 offset:18944
  s_lshl_b32 s0, s3, 2
  s_add_u32 s0, s0, 162432
  v_add_u32 v124, s0, v2
  v_mov_b32 v4, 0
  s_waitcnt lgkmcnt(12)
  v_mfma_f32_32x32x16_bf16 v[160:175], a[168:171], a[232:235], v[160:175]
  ds_read_b64_tr_b16 a[200:201], v32 offset:22528
  ds_read_b64_tr_b16 a[202:203], v32 offset:23040
  buffer_load_dwordx4 v25, s[28:31], s4 offen offset:1024 lds
  v_mov_b32 v5, 0
  v_mov_b32 v6, 0
  v_mfma_f32_32x32x16_bf16 v[176:191], a[172:175], a[232:235], v[176:191]
  ds_read_b64_tr_b16 a[204:205], v33 offset:22528
  ds_read_b64_tr_b16 a[206:207], v33 offset:23040
  buffer_load_dwordx4 v26, s[28:31], s4 offen offset:2048 lds
  v_mov_b32 v7, 0
  s_and_b32 s0, s2, 127
  s_lshl_b32 s0, s0, 2
  s_waitcnt lgkmcnt(12)
  v_mfma_f32_32x32x16_bf16 v[192:207], a[176:179], a[232:235], v[192:207]
  ds_read_b64_tr_b16 a[208:209], v32 offset:26624
  ds_read_b64_tr_b16 a[210:211], v32 offset:27136
  buffer_load_dwordx4 v27, s[28:31], s4 offen offset:3072 lds
  s_add_u32 s0, s0, s3
  s_mul_i32 s0, s0, 480
  v_mfma_f32_32x32x16_bf16 v[208:223], a[180:183], a[232:235], v[208:223]
  ds_read_b64_tr_b16 a[212:213], v33 offset:26624
  ds_read_b64_tr_b16 a[214:215], v33 offset:27136
  s_add_u32 s0, s0, 15597568
  v_mov_b32 v1, 0x40000000
  v_cmp_gt_u32 vcc, 30, v0
  s_nop 1
  v_cndmask_b32 v1, v1, v12, vcc
  s_waitcnt lgkmcnt(12)
  v_mfma_f32_32x32x16_bf16 v[224:239], a[184:187], a[232:235], v[224:239]
  ds_read_b64_tr_b16 a[216:217], v32 offset:30720
  ds_read_b64_tr_b16 a[218:219], v32 offset:31232
  s_waitcnt vmcnt(30)
  ds_read_b64_tr_b16 a[0:1], v61 offset:0
  ds_read_b64_tr_b16 a[2:3], v61 offset:640
  ds_read_b64_tr_b16 a[4:5], v61 offset:8
  v_mfma_f32_32x32x16_bf16 v[240:255], a[188:191], a[232:235], v[240:255]
  ds_read_b64_tr_b16 a[220:221], v33 offset:30720
  ds_read_b64_tr_b16 a[222:223], v33 offset:31232
  ds_read_b64_tr_b16 a[6:7], v61 offset:648
  ds_read_b64_tr_b16 a[8:9], v61 offset:64
  ds_read_b64_tr_b16 a[10:11], v61 offset:704
  buffer_store_dwordx4 v[4:7], v1, s[36:39], s0 offen sc1
  s_waitcnt lgkmcnt(15)
  v_mfma_f32_32x32x16_bf16 v[128:143], a[192:195], a[236:239], v[128:143]
  v_mfma_f32_32x32x16_bf16 v[144:159], a[196:199], a[236:239], v[144:159]
  ds_read_b64_tr_b16 a[12:13], v61 offset:72
  ds_read_b64_tr_b16 a[14:15], v61 offset:712
  ds_read_b64_tr_b16 a[16:17], v62 offset:128
  s_waitcnt lgkmcnt(15)
  v_mfma_f32_32x32x16_bf16 v[160:175], a[200:203], a[236:239], v[160:175]
  s_waitcnt vmcnt(21) lgkmcnt(0)
  s_barrier
  v_readfirstlane_b32 s64, v55
  ds_read_b128 a[240:243], v20 offset:4096
  ds_read_b64_tr_b16 a[160:161], v32 offset:32768
  ds_read_b64_tr_b16 a[162:163], v32 offset:33280
  ds_read_b64_tr_b16 a[18:19], v62 offset:768
  buffer_load_dwordx4 v[64:67], v15, s[24:27], s7 offen offset:0
  v_mfma_f32_32x32x16_bf16 v[176:191], a[204:207], a[236:239], v[176:191]
  ds_read_b64_tr_b16 a[164:165], v33 offset:32768
  ds_read_b64_tr_b16 a[166:167], v33 offset:33280
  ds_read_b64_tr_b16 a[168:169], v32 offset:36864
  buffer_load_dwordx4 v[68:71], v15, s[24:27], s7 offen offset:256
  v_mfma_f32_32x32x16_bf16 v[192:207], a[208:211], a[236:239], v[192:207]
  ds_read_b64_tr_b16 a[170:171], v32 offset:37376
  ds_read_b64_tr_b16 a[172:173], v33 offset:36864
  ds_read_b64_tr_b16 a[174:175], v33 offset:37376
  v_mfma_f32_32x32x16_bf16 v[208:223], a[212:215], a[236:239], v[208:223]
  ds_read_b64_tr_b16 a[176:177], v32 offset:40960
  ds_read_b64_tr_b16 a[178:179], v32 offset:41472
  ds_read_b64_tr_b16 a[180:181], v33 offset:40960
  buffer_load_dwordx4 v[72:75], v15, s[24:27], s7 offen offset:512
  v_mfma_f32_32x32x16_bf16 v[224:239], a[216:219], a[236:239], v[224:239]
  ds_read_b64_tr_b16 a[182:183], v33 offset:41472
  ds_read_b64_tr_b16 a[184:185], v32 offset:45056
  ds_read_b64_tr_b16 a[186:187], v32 offset:45568
  buffer_load_dwordx4 v[76:79], v15, s[24:27], s7 offen offset:768
  s_mul_i32 s0, s3, 960
  v_mfma_f32_32x32x16_bf16 v[240:255], a[220:223], a[236:239], v[240:255]
  ds_read_b64_tr_b16 a[188:189], v33 offset:45056
  ds_read_b64_tr_b16 a[190:191], v33 offset:45568
  ds_read_b128 a[244:247], v21 offset:4096
  s_add_u32 s0, s0, 151552
  v_add_u32 v1, s0, v12
  s_mul_i32 s0, s3, 480
  s_waitcnt lgkmcnt(13)
  v_mfma_f32_32x32x16_bf16 v[128:143], a[160:163], a[240:243], v[128:143]
  ds_read_b64_tr_b16 a[192:193], v32 offset:34816
  ds_read_b64_tr_b16 a[194:195], v32 offset:35328
  ds_read_b64_tr_b16 a[196:197], v33 offset:34816
  buffer_load_dwordx4 v[80:83], v15, s[24:27], s7 offen offset:1024
  s_add_u32 s0, s0, 155392
  v_mfma_f32_32x32x16_bf16 v[144:159], a[164:167], a[240:243], v[144:159]
  ds_read_b64_tr_b16 a[198:199], v33 offset:35328
  ds_read_b64_tr_b16 a[200:201], v32 offset:38912
  ds_read_b64_tr_b16 a[202:203], v32 offset:39424
  s_add_u32 m0, s66, 8192
  s_add_u32 s21, s65, 256
  buffer_load_dwordx4 v16, s[24:27], s21 offen offset:0 lds
  s_waitcnt lgkmcnt(15)
  v_mfma_f32_32x32x16_bf16 v[160:175], a[168:171], a[240:243], v[160:175]
  ds_read_b64_tr_b16 a[204:205], v33 offset:38912
  ds_read_b64_tr_b16 a[206:207], v33 offset:39424
  buffer_load_dwordx4 v17, s[24:27], s21 offen offset:1024 lds
  v_lshl_add_u32 v2, v0, 3, s0
  v_mov_b32 v4, 0
  v_mfma_f32_32x32x16_bf16 v[176:191], a[172:175], a[240:243], v[176:191]
  ds_read_b64_tr_b16 a[208:209], v32 offset:43008
  ds_read_b64_tr_b16 a[210:211], v32 offset:43520
  v_mov_b32 v5, 0
  s_bfm_b64 exec, 60, 0
  s_waitcnt vmcnt(23)
  ds_write_b128 v1, a[28:31]
  ds_write_b64 v2, v[4:5]
  s_mov_b64 exec, -1
  s_waitcnt lgkmcnt(15)
  v_mfma_f32_32x32x16_bf16 v[192:207], a[176:179], a[240:243], v[192:207]
  ds_read_b64_tr_b16 a[212:213], v33 offset:43008
  ds_read_b64_tr_b16 a[214:215], v33 offset:43520
  buffer_load_dwordx4 v18, s[24:27], s21 offen offset:2048 lds
  v_mfma_f32_32x32x16_bf16 v[208:223], a[180:183], a[240:243], v[208:223]
  ds_read_b64_tr_b16 a[216:217], v32 offset:47104
  ds_read_b64_tr_b16 a[218:219], v32 offset:47616
  buffer_load_dwordx4 v19, s[24:27], s21 offen offset:3072 lds
  s_add_u32 m0, s67, 81920
  s_add_u32 s4, s4, s5
  s_waitcnt lgkmcnt(15)
  v_mfma_f32_32x32x16_bf16 v[224:239], a[184:187], a[240:243], v[224:239]
  ds_read_b64_tr_b16 a[220:221], v33 offset:47104
  ds_read_b64_tr_b16 a[222:223], v33 offset:47616
  s_waitcnt vmcnt(24)
  v_mfma_f32_16x16x32_bf16 v[40:43], v[36:39], v[84:87], 0
  s_waitcnt vmcnt(23)
  v_mfma_f32_16x16x32_bf16 v[40:43], v[36:39], v[88:91], v[40:43]
  v_mfma_f32_32x32x16_bf16 v[240:255], a[188:191], a[240:243], v[240:255]
  ds_read_b128 a[248:251], v22 offset:4096
  ds_read_b128 a[252:255], v23 offset:4096
  buffer_load_dwordx4 v24, s[28:31], s4 offen offset:0 lds
  s_waitcnt vmcnt(23)
  v_mfma_f32_16x16x32_bf16 v[40:43], v[36:39], v[92:95], v[40:43]
  s_waitcnt lgkmcnt(15)
  v_mfma_f32_32x32x16_bf16 v[128:143], a[192:195], a[244:247], v[128:143]
  buffer_load_dwordx4 v25, s[28:31], s4 offen offset:1024 lds
  s_waitcnt vmcnt(23)
  v_mfma_f32_16x16x32_bf16 v[40:43], v[36:39], v[96:99], v[40:43]
  s_waitcnt vmcnt(22)
  v_mfma_f32_16x16x32_bf16 v[40:43], v[36:39], v[100:103], v[40:43]
  v_mfma_f32_32x32x16_bf16 v[144:159], a[196:199], a[244:247], v[144:159]
  buffer_load_dwordx4 v26, s[28:31], s4 offen offset:2048 lds
  s_waitcnt vmcnt(22)
  v_mfma_f32_16x16x32_bf16 v[40:43], v[36:39], v[104:107], v[40:43]
  s_waitcnt vmcnt(21)
  v_mfma_f32_16x16x32_bf16 v[40:43], v[36:39], v[108:111], v[40:43]
  s_waitcnt lgkmcnt(12)
  v_mfma_f32_32x32x16_bf16 v[160:175], a[200:203], a[244:247], v[160:175]
  s_waitcnt vmcnt(20)
  v_mfma_f32_16x16x32_bf16 v[40:43], v[36:39], v[112:115], v[40:43]
  s_waitcnt lgkmcnt(0)
  s_barrier
  ds_read_b64_tr_b16 a[160:161], v32 offset:49152
  ds_read_b64_tr_b16 a[162:163], v32 offset:49664
  ds_read_b64_tr_b16 a[164:165], v33 offset:49152
  v_mfma_f32_32x32x16_bf16 v[176:191], a[204:207], a[244:247], v[176:191]
  ds_read_b64_tr_b16 a[166:167], v33 offset:49664
  ds_read_b64_tr_b16 a[168:169], v32 offset:53248
  ds_read_b64_tr_b16 a[170:171], v32 offset:53760
  buffer_load_dwordx4 v27, s[28:31], s4 offen offset:3072 lds
  s_add_u32 m0, s67, 0
  s_add_u32 s4, s4, s5
  v_mfma_f32_32x32x16_bf16 v[192:207], a[208:211], a[244:247], v[192:207]
  ds_read_b64_tr_b16 a[172:173], v33 offset:53248
  ds_read_b64_tr_b16 a[174:175], v33 offset:53760
  ds_read_b64_tr_b16 a[176:177], v32 offset:57344
  buffer_load_dwordx4 v24, s[28:31], s4 offen offset:0 lds
  v_mfma_f32_32x32x16_bf16 v[208:223], a[212:215], a[244:247], v[208:223]
  ds_read_b64_tr_b16 a[178:179], v32 offset:57856
  ds_read_b64_tr_b16 a[180:181], v33 offset:57344
  ds_read_b64_tr_b16 a[182:183], v33 offset:57856
  s_waitcnt vmcnt(21)
  v_mfma_f32_16x16x32_bf16 v[40:43], v[36:39], v[116:119], v[40:43]
  v_mfma_f32_32x32x16_bf16 v[224:239], a[216:219], a[244:247], v[224:239]
  ds_read_b64_tr_b16 a[184:185], v32 offset:61440
  ds_read_b64_tr_b16 a[186:187], v32 offset:61952
  buffer_load_dwordx4 v25, s[28:31], s4 offen offset:1024 lds
  s_waitcnt vmcnt(21)
  v_mfma_f32_16x16x32_bf16 v[40:43], v[36:39], v[120:123], v[40:43]
  s_waitcnt vmcnt(14)
  v_lshlrev_b32 v84, 16, v64
  v_mfma_f32_32x32x16_bf16 v[240:255], a[220:223], a[244:247], v[240:255]
  ds_read_b64_tr_b16 a[188:189], v33 offset:61440
  ds_read_b64_tr_b16 a[190:191], v33 offset:61952
  buffer_load_dwordx4 v26, s[28:31], s4 offen offset:2048 lds
  v_and_b32 v85, 0xffff0000, v64
  v_lshlrev_b32 v86, 16, v65
  v_and_b32 v87, 0xffff0000, v65
  s_waitcnt lgkmcnt(12)
  v_mfma_f32_32x32x16_bf16 v[128:143], a[160:163], a[248:251], v[128:143]
  ds_read_b64_tr_b16 a[192:193], v32 offset:51200
  ds_read_b64_tr_b16 a[194:195], v32 offset:51712
  buffer_load_dwordx4 v27, s[28:31], s4 offen offset:3072 lds
  s_add_u32 m0, s66, 0
  s_add_u32 s21, s65, 384
  v_mfma_f32_32x32x16_bf16 v[144:159], a[164:167], a[248:251], v[144:159]
  ds_read_b64_tr_b16 a[196:197], v33 offset:51200
  ds_read_b64_tr_b16 a[198:199], v33 offset:51712
  v_add_f32 v2, v84, v85
  v_lshlrev_b32 v88, 16, v66
  v_and_b32 v89, 0xffff0000, v66
  v_add_f32 v3, v86, v87
  s_waitcnt lgkmcnt(12)
  v_mfma_f32_32x32x16_bf16 v[160:175], a[168:171], a[248:251], v[160:175]
  ds_read_b64_tr_b16 a[200:201], v32 offset:55296
  ds_read_b64_tr_b16 a[202:203], v32 offset:55808
  buffer_load_dwordx4 v16, s[24:27], s21 offen offset:0 lds
  v_lshlrev_b32 v90, 16, v67
  v_and_b32 v91, 0xffff0000, v67
  v_mfma_f32_32x32x16_bf16 v[176:191], a[172:175], a[248:251], v[176:191]
  ds_read_b64_tr_b16 a[204:205], v33 offset:55296
  ds_read_b64_tr_b16 a[206:207], v33 offset:55808
  buffer_load_dwordx4 v17, s[24:27], s21 offen offset:1024 lds
  v_add_f32 v2, v2, v88
  v_add_f32 v3, v3, v89
  s_waitcnt vmcnt(17)
  v_lshlrev_b32 v92, 16, v68
  s_waitcnt lgkmcnt(12)
  v_mfma_f32_32x32x16_bf16 v[192:207], a[176:179], a[248:251], v[192:207]
  ds_read_b64_tr_b16 a[208:209], v32 offset:59392
  ds_read_b64_tr_b16 a[210:211], v32 offset:59904
  v_and_b32 v93, 0xffff0000, v68
  v_add_f32 v2, v2, v90
  v_add_f32 v3, v3, v91
  v_mfma_f32_32x32x16_bf16 v[208:223], a[180:183], a[248:251], v[208:223]
  ds_read_b64_tr_b16 a[212:213], v33 offset:59392
  ds_read_b64_tr_b16 a[214:215], v33 offset:59904
  buffer_load_dwordx4 v18, s[24:27], s21 offen offset:2048 lds
  v_lshlrev_b32 v94, 16, v69
  v_and_b32 v95, 0xffff0000, v69
  v_add_f32 v2, v2, v92
  s_waitcnt lgkmcnt(12)
  v_mfma_f32_32x32x16_bf16 v[224:239], a[184:187], a[248:251], v[224:239]
  ds_read_b64_tr_b16 a[216:217], v32 offset:63488
  ds_read_b64_tr_b16 a[218:219], v32 offset:64000
  buffer_load_dwordx4 v19, s[24:27], s21 offen offset:3072 lds
  s_add_u32 m0, s67, 16384
  s_add_u32 s4, s4, s5
  v_mfma_f32_32x32x16_bf16 v[240:255], a[188:191], a[248:251], v[240:255]
  ds_read_b64_tr_b16 a[220:221], v33 offset:63488
  ds_read_b64_tr_b16 a[222:223], v33 offset:64000
  buffer_load_dwordx4 v24, s[28:31], s4 offen offset:0 lds
  v_add_f32 v3, v3, v93
  v_lshlrev_b32 v96, 16, v70
  v_and_b32 v97, 0xffff0000, v70
  s_waitcnt lgkmcnt(12)
  v_mfma_f32_32x32x16_bf16 v[128:143], a[192:195], a[252:255], v[128:143]
  v_add_f32 v2, v2, v94
  v_add_f32 v3, v3, v95
  v_lshlrev_b32 v98, 16, v71
  v_and_b32 v99, 0xffff0000, v71
  v_add_f32 v2, v2, v96
  v_mfma_f32_32x32x16_bf16 v[144:159], a[196:199], a[252:255], v[144:159]
  buffer_load_dwordx4 v25, s[28:31], s4 offen offset:1024 lds
  v_add_f32 v3, v3, v97
  s_waitcnt vmcnt(20)
  v_lshlrev_b32 v100, 16, v72
  v_and_b32 v101, 0xffff0000, v72
  v_add_f32 v2, v2, v98
  v_add_f32 v3, v3, v99
  s_waitcnt lgkmcnt(8)
  v_mfma_f32_32x32x16_bf16 v[160:175], a[200:203], a[252:255], v[160:175]
  s_waitcnt vmcnt(14) lgkmcnt(0)
  s_barrier
  ds_read_b128 a[224:227], v20 offset:8192
  ds_read_b64_tr_b16 a[160:161], v34 offset:0
  ds_read_b64_tr_b16 a[162:163], v34 offset:512
  buffer_load_dwordx4 v26, s[28:31], s4 offen offset:2048 lds
  v_mfma_f32_32x32x16_bf16 v[176:191], a[204:207], a[252:255], v[176:191]
  ds_read_b64_tr_b16 a[164:165], v35 offset:0
  ds_read_b64_tr_b16 a[166:167], v35 offset:512
  ds_read_b64_tr_b16 a[168:169], v34 offset:4096
  v_lshlrev_b32 v102, 16, v73
  v_and_b32 v103, 0xffff0000, v73
  v_add_f32 v2, v2, v100
  v_mfma_f32_32x32x16_bf16 v[192:207], a[208:211], a[252:255], v[192:207]
  ds_read_b64_tr_b16 a[170:171], v34 offset:4608
  ds_read_b64_tr_b16 a[172:173], v35 offset:4096
  ds_read_b64_tr_b16 a[174:175], v35 offset:4608
  buffer_load_dwordx4 v27, s[28:31], s4 offen offset:3072 lds
  v_add_f32 v3, v3, v101
  v_mfma_f32_32x32x16_bf16 v[208:223], a[212:215], a[252:255], v[208:223]
  ds_read_b64_tr_b16 a[176:177], v34 offset:8192
  ds_read_b64_tr_b16 a[178:179], v34 offset:8704
  ds_read_b64_tr_b16 a[180:181], v35 offset:8192
  buffer_store_dwordx4 a[0:3], v12, s[36:39], s13 offen offset:0 sc1
  v_lshlrev_b32 v104, 16, v74
  v_and_b32 v105, 0xffff0000, v74
  v_mfma_f32_32x32x16_bf16 v[224:239], a[216:219], a[252:255], v[224:239]
  ds_read_b64_tr_b16 a[182:183], v35 offset:8704
  ds_read_b64_tr_b16 a[184:185], v34 offset:12288
  ds_read_b64_tr_b16 a[186:187], v34 offset:12800
  buffer_store_dwordx4 a[4:7], v12, s[36:39], s13 offen offset:1024 sc1
  v_add_f32 v2, v2, v102
  v_mfma_f32_32x32x16_bf16 v[240:255], a[220:223], a[252:255], v[240:255]
  ds_read_b64_tr_b16 a[188:189], v35 offset:12288
  ds_read_b64_tr_b16 a[190:191], v35 offset:12800
  ds_read_b128 a[228:231], v21 offset:8192
  v_add_f32 v3, v3, v103
  v_add_f32_dpp v40, v40, v40 row_ror:8 row_mask:0xf bank_mask:0xf
  v_add_f32_dpp v41, v41, v41 row_ror:8 row_mask:0xf bank_mask:0xf
  s_waitcnt lgkmcnt(13)
  v_mfma_f32_32x32x16_bf16 v[128:143], a[160:163], a[224:227], v[128:143]
  ds_read_b64_tr_b16 a[192:193], v34 offset:2048
  ds_read_b64_tr_b16 a[194:195], v34 offset:2560
  ds_read_b64_tr_b16 a[196:197], v35 offset:2048
  buffer_store_dwordx4 a[8:11], v12, s[36:39], s13 offen offset:2048 sc1
  v_add_f32_dpp v42, v42, v42 row_ror:8 row_mask:0xf bank_mask:0xf
  v_mfma_f32_32x32x16_bf16 v[144:159], a[164:167], a[224:227], v[144:159]
  ds_read_b64_tr_b16 a[198:199], v35 offset:2560
  ds_read_b64_tr_b16 a[200:201], v34 offset:6144
  ds_read_b64_tr_b16 a[202:203], v34 offset:6656
  v_add_f32_dpp v43, v43, v43 row_ror:8 row_mask:0xf bank_mask:0xf
  s_mov_b64 exec, 0xffffffff
  ds_write_b32 v124, v40 offset:0
  ds_write_b32 v124, v41 offset:16
  ds_write_b32 v124, v42 offset:32
  ds_write_b32 v124, v43 offset:48
  s_mov_b64 exec, -1
  s_waitcnt lgkmcnt(15)
  v_mfma_f32_32x32x16_bf16 v[160:175], a[168:171], a[224:227], v[160:175]
  ds_read_b64_tr_b16 a[204:205], v35 offset:6144
  ds_read_b64_tr_b16 a[206:207], v35 offset:6656
  buffer_store_dwordx4 a[12:15], v12, s[36:39], s13 offen offset:3072 sc1
  v_mfma_f32_32x32x16_bf16 v[176:191], a[172:175], a[224:227], v[176:191]
  ds_read_b64_tr_b16 a[208:209], v34 offset:10240
  ds_read_b64_tr_b16 a[210:211], v34 offset:10752
  buffer_store_dwordx4 a[16:19], v13, s[36:39], s13 offen offset:0 sc1
  v_mfma_f32_32x32x16_bf16 v[192:207], a[176:179], a[224:227], v[192:207]
  ds_read_b64_tr_b16 a[212:213], v35 offset:10240
  ds_read_b64_tr_b16 a[214:215], v35 offset:10752
  v_mfma_f32_32x32x16_bf16 v[208:223], a[180:183], a[224:227], v[208:223]
  ds_read_b64_tr_b16 a[216:217], v34 offset:14336
  ds_read_b64_tr_b16 a[218:219], v34 offset:14848
  ds_read_b64_tr_b16 a[20:21], v30 offset:0
  ds_read_b64_tr_b16 a[24:25], v31 offset:128
  ds_read_b64_tr_b16 a[22:23], v30 offset:640
  ds_read_b64_tr_b16 a[26:27], v31 offset:768
  s_lshl_b32 s18, s3, 10
  s_add_u32 s18, s18, s17
  s_cmp_eq_u32 s3, 0
  s_cselect_b32 s19, s17, 0x40000000
  s_waitcnt lgkmcnt(15)
  v_mfma_f32_32x32x16_bf16 v[224:239], a[184:187], a[224:227], v[224:239]
  ds_read_b64_tr_b16 a[220:221], v35 offset:14336
  ds_read_b64_tr_b16 a[222:223], v35 offset:14848
  s_waitcnt lgkmcnt(3)
  buffer_store_dwordx4 a[20:23], v12, s[36:39], s18 offen sc1
  v_mfma_f32_32x32x16_bf16 v[240:255], a[188:191], a[224:227], v[240:255]
  ds_read_b128 a[232:235], v22 offset:8192
  ds_read_b128 a[236:239], v23 offset:8192
  v_mfma_f32_32x32x16_bf16 v[128:143], a[192:195], a[228:231], v[128:143]
  s_waitcnt lgkmcnt(4)
  buffer_store_dwordx4 a[24:27], v13, s[36:39], s19 offen sc1
  s_add_u32 m0, s67, 32768
  s_add_u32 s4, s4, s5
  v_mfma_f32_32x32x16_bf16 v[144:159], a[196:199], a[228:231], v[144:159]
  v_mfma_f32_32x32x16_bf16 v[160:175], a[200:203], a[228:231], v[160:175]
  s_waitcnt vmcnt(19) lgkmcnt(0)
  s_barrier
  ds_read_b64_tr_b16 a[160:161], v34 offset:16384
  ds_read_b64_tr_b16 a[162:163], v34 offset:16896
  ds_read_b64_tr_b16 a[164:165], v35 offset:16384
  buffer_load_dwordx4 v24, s[28:31], s4 offen offset:0 lds
  v_mfma_f32_32x32x16_bf16 v[176:191], a[204:207], a[228:231], v[176:191]
  ds_read_b64_tr_b16 a[166:167], v35 offset:16896
  ds_read_b64_tr_b16 a[168:169], v34 offset:20480
  ds_read_b64_tr_b16 a[170:171], v34 offset:20992
  buffer_load_dwordx4 v25, s[28:31], s4 offen offset:1024 lds
  v_add_u32 v124, 162432, v12
  v_mfma_f32_32x32x16_bf16 v[192:207], a[208:211], a[228:231], v[192:207]
  ds_read_b64_tr_b16 a[172:173], v35 offset:20480
  ds_read_b64_tr_b16 a[174:175], v35 offset:20992
  ds_read_b64_tr_b16 a[176:177], v34 offset:24576
  ds_read_b128 v[36:39], v124
  s_lshl_b32 s1, s22, 10
  s_bfe_u32 s15, s2, 0x10002
  v_mfma_f32_32x32x16_bf16 v[208:223], a[212:215], a[228:231], v[208:223]
  ds_read_b64_tr_b16 a[178:179], v34 offset:25088
  ds_read_b64_tr_b16 a[180:181], v35 offset:24576
  ds_read_b64_tr_b16 a[182:183], v35 offset:25088
  buffer_load_dwordx4 v26, s[28:31], s4 offen offset:2048 lds
  s_lshl_b32 s15, s15, 3
  v_mfma_f32_32x32x16_bf16 v[224:239], a[216:219], a[228:231], v[224:239]
  ds_read_b64_tr_b16 a[184:185], v34 offset:28672
  ds_read_b64_tr_b16 a[186:187], v34 offset:29184
  buffer_load_dwordx4 v27, s[28:31], s4 offen offset:3072 lds
  s_add_u32 m0, s66, 4096
  s_add_u32 s21, s65, 512
  s_add_u32 s1, s1, s15
  v_mfma_f32_32x32x16_bf16 v[240:255], a[220:223], a[228:231], v[240:255]
  ds_read_b64_tr_b16 a[188:189], v35 offset:28672
  ds_read_b64_tr_b16 a[190:191], v35 offset:29184
  s_add_u32 s1, s1, 15925248
  s_cmp_lt_u32 s22, 57
  s_cselect_b32 s1, s1, 0x40000000
  s_waitcnt lgkmcnt(13)
  v_mfma_f32_32x32x16_bf16 v[128:143], a[160:163], a[232:235], v[128:143]
  ds_read_b64_tr_b16 a[192:193], v34 offset:18432
  ds_read_b64_tr_b16 a[194:195], v34 offset:18944
  buffer_load_dwordx4 v16, s[24:27], s21 offen offset:0 lds
  s_cmp_eq_u32 s3, 0
  s_cselect_b32 s1, s1, 0x40000000
  v_lshlrev_b32 v41, 16, v63
  v_mfma_f32_32x32x16_bf16 v[144:159], a[164:167], a[232:235], v[144:159]
  ds_read_b64_tr_b16 a[196:197], v35 offset:18432
  ds_read_b64_tr_b16 a[198:199], v35 offset:18944
  s_waitcnt lgkmcnt(11)
  v_add_f32 v36, v36, v37
  v_add_f32 v38, v38, v39
  v_add_f32 v40, v36, v38
  v_mfma_f32_32x32x16_bf16 v[160:175], a[168:171], a[232:235], v[160:175]
  ds_read_b64_tr_b16 a[200:201], v34 offset:22528
  ds_read_b64_tr_b16 a[202:203], v34 offset:23040
  buffer_load_dwordx4 v17, s[24:27], s21 offen offset:1024 lds
  buffer_store_dwordx2 v[40:41], v12, s[36:39], s1 offen sc1
  v_lshlrev_b32 v106, 16, v75
  v_and_b32 v107, 0xffff0000, v75
  v_mfma_f32_32x32x16_bf16 v[176:191], a[172:175], a[232:235], v[176:191]
  ds_read_b64_tr_b16 a[204:205], v35 offset:22528
  ds_read_b64_tr_b16 a[206:207], v35 offset:23040
  buffer_load_dwordx4 v18, s[24:27], s21 offen offset:2048 lds
  v_add_f32 v2, v2, v104
  v_add_f32 v3, v3, v105
  s_waitcnt lgkmcnt(12)
  v_mfma_f32_32x32x16_bf16 v[192:207], a[176:179], a[232:235], v[192:207]
  ds_read_b64_tr_b16 a[208:209], v34 offset:26624
  ds_read_b64_tr_b16 a[210:211], v34 offset:27136
  v_lshlrev_b32 v108, 16, v76
  v_and_b32 v109, 0xffff0000, v76
  v_add_f32 v2, v2, v106
  v_add_f32 v3, v3, v107
  v_mfma_f32_32x32x16_bf16 v[208:223], a[180:183], a[232:235], v[208:223]
  ds_read_b64_tr_b16 a[212:213], v35 offset:26624
  ds_read_b64_tr_b16 a[214:215], v35 offset:27136
  buffer_load_dwordx4 v19, s[24:27], s21 offen offset:3072 lds
  s_add_u32 m0, s67, 49152
  s_add_u32 s4, s4, s5
  s_waitcnt lgkmcnt(12)
  v_mfma_f32_32x32x16_bf16 v[224:239], a[184:187], a[232:235], v[224:239]
  ds_read_b64_tr_b16 a[216:217], v34 offset:30720
  ds_read_b64_tr_b16 a[218:219], v34 offset:31232
  buffer_load_dwordx4 v24, s[28:31], s4 offen offset:0 lds
  v_lshlrev_b32 v110, 16, v77
  v_and_b32 v111, 0xffff0000, v77
  v_add_f32 v2, v2, v108
  v_mfma_f32_32x32x16_bf16 v[240:255], a[188:191], a[232:235], v[240:255]
  ds_read_b64_tr_b16 a[220:221], v35 offset:30720
  ds_read_b64_tr_b16 a[222:223], v35 offset:31232
  v_add_f32 v3, v3, v109
  v_lshlrev_b32 v112, 16, v78
  v_and_b32 v113, 0xffff0000, v78
  s_waitcnt lgkmcnt(12)
  v_mfma_f32_32x32x16_bf16 v[128:143], a[192:195], a[236:239], v[128:143]
  buffer_load_dwordx4 v25, s[28:31], s4 offen offset:1024 lds
  v_add_f32 v2, v2, v110
  v_add_f32 v3, v3, v111
  v_lshlrev_b32 v114, 16, v79
  v_and_b32 v115, 0xffff0000, v79
  v_add_f32 v2, v2, v112
  v_mfma_f32_32x32x16_bf16 v[144:159], a[196:199], a[236:239], v[144:159]
  v_add_f32 v3, v3, v113
  v_lshlrev_b32 v116, 16, v80
  v_and_b32 v117, 0xffff0000, v80
  v_add_f32 v2, v2, v114
  v_add_f32 v3, v3, v115
  s_waitcnt lgkmcnt(8)
  v_mfma_f32_32x32x16_bf16 v[160:175], a[200:203], a[236:239], v[160:175]
  v_lshlrev_b32 v118, 16, v81
  s_waitcnt vmcnt(22) lgkmcnt(0)
  s_barrier
  ds_read_b128 a[240:243], v20 offset:0
  ds_read_b64_tr_b16 a[160:161], v32 offset:0
  ds_read_b64_tr_b16 a[162:163], v32 offset:512
  buffer_load_dwordx4 v26, s[28:31], s4 offen offset:2048 lds
  v_mfma_f32_32x32x16_bf16 v[176:191], a[204:207], a[236:239], v[176:191]
  ds_read_b64_tr_b16 a[164:165], v33 offset:0
  ds_read_b64_tr_b16 a[166:167], v33 offset:512
  ds_read_b64_tr_b16 a[168:169], v32 offset:4096
  buffer_load_dwordx4 v27, s[28:31], s4 offen offset:3072 lds
  s_add_u32 m0, s67, 65536
  s_add_u32 s4, s4, s5
  v_mfma_f32_32x32x16_bf16 v[192:207], a[208:211], a[236:239], v[192:207]
  ds_read_b64_tr_b16 a[170:171], v32 offset:4608
  ds_read_b64_tr_b16 a[172:173], v33 offset:4096
  ds_read_b64_tr_b16 a[174:175], v33 offset:4608
  v_and_b32 v119, 0xffff0000, v81
  v_add_f32 v2, v2, v116
  v_mfma_f32_32x32x16_bf16 v[208:223], a[212:215], a[236:239], v[208:223]
  ds_read_b64_tr_b16 a[176:177], v32 offset:8192
  ds_read_b64_tr_b16 a[178:179], v32 offset:8704
  ds_read_b64_tr_b16 a[180:181], v33 offset:8192
  buffer_load_dwordx4 v24, s[28:31], s4 offen offset:0 lds
  v_add_f32 v3, v3, v117
  v_mfma_f32_32x32x16_bf16 v[224:239], a[216:219], a[236:239], v[224:239]
  ds_read_b64_tr_b16 a[182:183], v33 offset:8704
  ds_read_b64_tr_b16 a[184:185], v32 offset:12288
  ds_read_b64_tr_b16 a[186:187], v32 offset:12800
  buffer_load_dwordx4 v25, s[28:31], s4 offen offset:1024 lds
  v_lshlrev_b32 v120, 16, v82
  v_and_b32 v121, 0xffff0000, v82
  v_mfma_f32_32x32x16_bf16 v[240:255], a[220:223], a[236:239], v[240:255]
  ds_read_b64_tr_b16 a[188:189], v33 offset:12288
  ds_read_b64_tr_b16 a[190:191], v33 offset:12800
  ds_read_b128 a[244:247], v21 offset:0
  v_add_f32 v2, v2, v118
  v_add_f32 v3, v3, v119
  s_waitcnt lgkmcnt(13)
  v_mfma_f32_32x32x16_bf16 v[128:143], a[160:163], a[240:243], v[128:143]
  ds_read_b64_tr_b16 a[192:193], v32 offset:2048
  ds_read_b64_tr_b16 a[194:195], v32 offset:2560
  ds_read_b64_tr_b16 a[196:197], v33 offset:2048
  buffer_load_dwordx4 v26, s[28:31], s4 offen offset:2048 lds
  v_lshlrev_b32 v122, 16, v83
  v_and_b32 v123, 0xffff0000, v83
  v_mfma_f32_32x32x16_bf16 v[144:159], a[164:167], a[240:243], v[144:159]
  ds_read_b64_tr_b16 a[198:199], v33 offset:2560
  ds_read_b64_tr_b16 a[200:201], v32 offset:6144
  ds_read_b64_tr_b16 a[202:203], v32 offset:6656
  v_add_f32 v2, v2, v120
  v_add_f32 v3, v3, v121
  s_waitcnt lgkmcnt(15)
  v_mfma_f32_32x32x16_bf16 v[160:175], a[168:171], a[240:243], v[160:175]
  ds_read_b64_tr_b16 a[204:205], v33 offset:6144
  ds_read_b64_tr_b16 a[206:207], v33 offset:6656
  buffer_load_dwordx4 v27, s[28:31], s4 offen offset:3072 lds
  s_add_u32 m0, s66, 8192
  s_add_u32 s21, s65, 640
  v_add_f32 v2, v2, v122
  v_mfma_f32_32x32x16_bf16 v[176:191], a[172:175], a[240:243], v[176:191]
  ds_read_b64_tr_b16 a[208:209], v32 offset:10240
  ds_read_b64_tr_b16 a[210:211], v32 offset:10752
  v_add_f32 v3, v3, v123
  s_lshr_b32 s0, s7, 5
  s_mul_hi_u32 s0, s0, 0x33333334
  s_waitcnt lgkmcnt(15)
  v_mfma_f32_32x32x16_bf16 v[192:207], a[176:179], a[240:243], v[192:207]
  ds_read_b64_tr_b16 a[212:213], v33 offset:10240
  ds_read_b64_tr_b16 a[214:215], v33 offset:10752
  buffer_load_dwordx4 v16, s[24:27], s21 offen offset:0 lds
  v_add_f32 v2, v2, v3
  v_lshrrev_b32 v1, 4, v0
  v_lshlrev_b32 v1, 3, v1
  v_mfma_f32_32x32x16_bf16 v[208:223], a[180:183], a[240:243], v[208:223]
  ds_read_b64_tr_b16 a[216:217], v32 offset:14336
  ds_read_b64_tr_b16 a[218:219], v32 offset:14848
  v_add_f32_dpp v2, v2, v2 row_ror:8 row_mask:0xf bank_mask:0xf
  v_and_b32 v6, 15, v0
  v_mov_b32 v7, 0x40000000
  s_waitcnt lgkmcnt(15)
  v_mfma_f32_32x32x16_bf16 v[224:239], a[184:187], a[240:243], v[224:239]
  ds_read_b64_tr_b16 a[220:221], v33 offset:14336
  ds_read_b64_tr_b16 a[222:223], v33 offset:14848
  buffer_load_dwordx4 v17, s[24:27], s21 offen offset:1024 lds
  v_add_f32_dpp v2, v2, v2 row_ror:4 row_mask:0xf bank_mask:0xf
  s_add_u32 s0, s0, 15859712
  v_mov_b32 v5, 0x3727c5ac
  v_mfma_f32_32x32x16_bf16 v[240:255], a[188:191], a[240:243], v[240:255]
  ds_read_b128 a[248:251], v22 offset:0
  ds_read_b128 a[252:255], v23 offset:0
  v_add_f32_dpp v2, v2, v2 row_ror:2 row_mask:0xf bank_mask:0xf
  v_cmp_eq_u32 vcc, 0, v6
  s_nop 0
  s_waitcnt lgkmcnt(14)
  v_mfma_f32_32x32x16_bf16 v[128:143], a[192:195], a[244:247], v[128:143]
  buffer_load_dwordx4 v18, s[24:27], s21 offen offset:2048 lds
  v_add_f32_dpp v2, v2, v2 row_ror:1 row_mask:0xf bank_mask:0xf
  v_cndmask_b32 v1, v7, v1, vcc
  v_mul_f32 v4, 0x3acccccd, v2
  v_sub_f32 v84, v84, v4
  v_sub_f32 v85, v85, v4
  v_mfma_f32_32x32x16_bf16 v[144:159], a[196:199], a[244:247], v[144:159]
  v_mul_f32 v3, v84, v84
  v_sub_f32 v86, v86, v4
  v_mul_f32 v2, v85, v85
  v_sub_f32 v87, v87, v4
  v_fmac_f32 v3, v86, v86
  s_waitcnt lgkmcnt(10)
  v_mfma_f32_32x32x16_bf16 v[160:175], a[200:203], a[244:247], v[160:175]
  s_waitcnt vmcnt(27) lgkmcnt(0)
  s_barrier
  ds_read_b64_tr_b16 a[160:161], v32 offset:16384
  ds_read_b64_tr_b16 a[162:163], v32 offset:16896
  ds_read_b64_tr_b16 a[164:165], v33 offset:16384
  buffer_load_dwordx4 v19, s[24:27], s21 offen offset:3072 lds
  s_add_u32 m0, s67, 81920
  s_add_u32 s4, s4, s5
  v_mfma_f32_32x32x16_bf16 v[176:191], a[204:207], a[244:247], v[176:191]
  ds_read_b64_tr_b16 a[166:167], v33 offset:16896
  ds_read_b64_tr_b16 a[168:169], v32 offset:20480
  ds_read_b64_tr_b16 a[170:171], v32 offset:20992
  v_sub_f32 v88, v88, v4
  v_mfma_f32_32x32x16_bf16 v[192:207], a[208:211], a[244:247], v[192:207]
  ds_read_b64_tr_b16 a[172:173], v33 offset:20480
  ds_read_b64_tr_b16 a[174:175], v33 offset:20992
  ds_read_b64_tr_b16 a[176:177], v32 offset:24576
  buffer_load_dwordx4 v24, s[28:31], s4 offen offset:0 lds
  v_fmac_f32 v2, v87, v87
  v_sub_f32 v89, v89, v4
  v_mfma_f32_32x32x16_bf16 v[208:223], a[212:215], a[244:247], v[208:223]
  ds_read_b64_tr_b16 a[178:179], v32 offset:25088
  ds_read_b64_tr_b16 a[180:181], v33 offset:24576
  ds_read_b64_tr_b16 a[182:183], v33 offset:25088
  v_fmac_f32 v3, v88, v88
  v_sub_f32 v90, v90, v4
  v_mfma_f32_32x32x16_bf16 v[224:239], a[216:219], a[244:247], v[224:239]
  ds_read_b64_tr_b16 a[184:185], v32 offset:28672
  ds_read_b64_tr_b16 a[186:187], v32 offset:29184
  buffer_load_dwordx4 v25, s[28:31], s4 offen offset:1024 lds
  v_fmac_f32 v2, v89, v89
  v_sub_f32 v91, v91, v4
  v_fmac_f32 v3, v90, v90
  v_mfma_f32_32x32x16_bf16 v[240:255], a[220:223], a[244:247], v[240:255]
  ds_read_b64_tr_b16 a[188:189], v33 offset:28672
  ds_read_b64_tr_b16 a[190:191], v33 offset:29184
  v_sub_f32 v92, v92, v4
  v_fmac_f32 v2, v91, v91
  v_sub_f32 v93, v93, v4
  s_waitcnt lgkmcnt(12)
  v_mfma_f32_32x32x16_bf16 v[128:143], a[160:163], a[248:251], v[128:143]
  ds_read_b64_tr_b16 a[192:193], v32 offset:18432
  ds_read_b64_tr_b16 a[194:195], v32 offset:18944
  buffer_load_dwordx4 v26, s[28:31], s4 offen offset:2048 lds
  v_fmac_f32 v3, v92, v92
  v_sub_f32 v94, v94, v4
  v_fmac_f32 v2, v93, v93
  v_mfma_f32_32x32x16_bf16 v[144:159], a[164:167], a[248:251], v[144:159]
  ds_read_b64_tr_b16 a[196:197], v33 offset:18432
  ds_read_b64_tr_b16 a[198:199], v33 offset:18944
  v_sub_f32 v95, v95, v4
  v_fmac_f32 v3, v94, v94
  v_sub_f32 v96, v96, v4
  s_waitcnt lgkmcnt(12)
  v_mfma_f32_32x32x16_bf16 v[160:175], a[168:171], a[248:251], v[160:175]
  ds_read_b64_tr_b16 a[200:201], v32 offset:22528
  ds_read_b64_tr_b16 a[202:203], v32 offset:23040
  buffer_load_dwordx4 v27, s[28:31], s4 offen offset:3072 lds
  s_add_u32 m0, s67, 0
  s_add_u32 s4, s4, s5
  v_fmac_f32 v2, v95, v95
  v_mfma_f32_32x32x16_bf16 v[176:191], a[172:175], a[248:251], v[176:191]
  ds_read_b64_tr_b16 a[204:205], v33 offset:22528
  ds_read_b64_tr_b16 a[206:207], v33 offset:23040
  v_sub_f32 v97, v97, v4
  v_fmac_f32 v3, v96, v96
  v_sub_f32 v98, v98, v4
  s_waitcnt lgkmcnt(12)
  v_mfma_f32_32x32x16_bf16 v[192:207], a[176:179], a[248:251], v[192:207]
  ds_read_b64_tr_b16 a[208:209], v32 offset:26624
  ds_read_b64_tr_b16 a[210:211], v32 offset:27136
  buffer_load_dwordx4 v24, s[28:31], s4 offen offset:0 lds
  v_fmac_f32 v2, v97, v97
  v_sub_f32 v99, v99, v4
  v_fmac_f32 v3, v98, v98
  v_mfma_f32_32x32x16_bf16 v[208:223], a[180:183], a[248:251], v[208:223]
  ds_read_b64_tr_b16 a[212:213], v33 offset:26624
  ds_read_b64_tr_b16 a[214:215], v33 offset:27136
  v_sub_f32 v100, v100, v4
  v_fmac_f32 v2, v99, v99
  v_sub_f32 v101, v101, v4
  s_waitcnt lgkmcnt(12)
  v_mfma_f32_32x32x16_bf16 v[224:239], a[184:187], a[248:251], v[224:239]
  ds_read_b64_tr_b16 a[216:217], v32 offset:30720
  ds_read_b64_tr_b16 a[218:219], v32 offset:31232
  buffer_load_dwordx4 v25, s[28:31], s4 offen offset:1024 lds
  v_fmac_f32 v3, v100, v100
  v_sub_f32 v102, v102, v4
  v_fmac_f32 v2, v101, v101
  v_mfma_f32_32x32x16_bf16 v[240:255], a[188:191], a[248:251], v[240:255]
  ds_read_b64_tr_b16 a[220:221], v33 offset:30720
  ds_read_b64_tr_b16 a[222:223], v33 offset:31232
  v_sub_f32 v103, v103, v4
  v_fmac_f32 v3, v102, v102
  v_sub_f32 v104, v104, v4
  s_waitcnt lgkmcnt(12)
  v_mfma_f32_32x32x16_bf16 v[128:143], a[192:195], a[252:255], v[128:143]
  buffer_load_dwordx4 v26, s[28:31], s4 offen offset:2048 lds
  v_fmac_f32 v2, v103, v103
  v_sub_f32 v105, v105, v4
  v_fmac_f32 v3, v104, v104
  v_sub_f32 v106, v106, v4
  v_fmac_f32 v2, v105, v105
  v_mfma_f32_32x32x16_bf16 v[144:159], a[196:199], a[252:255], v[144:159]
  v_sub_f32 v107, v107, v4
  v_fmac_f32 v3, v106, v106
  v_sub_f32 v108, v108, v4
  v_fmac_f32 v2, v107, v107
  v_sub_f32 v109, v109, v4
  s_waitcnt lgkmcnt(8)
  v_mfma_f32_32x32x16_bf16 v[160:175], a[200:203], a[252:255], v[160:175]
  s_waitcnt vmcnt(19) lgkmcnt(0)
  s_barrier
  ds_read_b128 a[224:227], v20 offset:4096
  ds_read_b64_tr_b16 a[160:161], v32 offset:32768
  ds_read_b64_tr_b16 a[162:163], v32 offset:33280
  buffer_load_dwordx4 v27, s[28:31], s4 offen offset:3072 lds
  s_add_u32 m0, s66, 0
  s_add_u32 s21, s65, 768
  v_mfma_f32_32x32x16_bf16 v[176:191], a[204:207], a[252:255], v[176:191]
  ds_read_b64_tr_b16 a[164:165], v33 offset:32768
  ds_read_b64_tr_b16 a[166:167], v33 offset:33280
  ds_read_b64_tr_b16 a[168:169], v32 offset:36864
  v_fmac_f32 v3, v108, v108
  v_mfma_f32_32x32x16_bf16 v[192:207], a[208:211], a[252:255], v[192:207]
  ds_read_b64_tr_b16 a[170:171], v32 offset:37376
  ds_read_b64_tr_b16 a[172:173], v33 offset:36864
  ds_read_b64_tr_b16 a[174:175], v33 offset:37376
  buffer_load_dwordx4 v16, s[24:27], s21 offen offset:0 lds
  v_sub_f32 v110, v110, v4
  v_fmac_f32 v2, v109, v109
  v_mfma_f32_32x32x16_bf16 v[208:223], a[212:215], a[252:255], v[208:223]
  ds_read_b64_tr_b16 a[176:177], v32 offset:40960
  ds_read_b64_tr_b16 a[178:179], v32 offset:41472
  ds_read_b64_tr_b16 a[180:181], v33 offset:40960
  v_sub_f32 v111, v111, v4
  v_fmac_f32 v3, v110, v110
  v_mfma_f32_32x32x16_bf16 v[224:239], a[216:219], a[252:255], v[224:239]
  ds_read_b64_tr_b16 a[182:183], v33 offset:41472
  ds_read_b64_tr_b16 a[184:185], v32 offset:45056
  ds_read_b64_tr_b16 a[186:187], v32 offset:45568
  buffer_load_dwordx4 v17, s[24:27], s21 offen offset:1024 lds
  v_sub_f32 v112, v112, v4
  v_fmac_f32 v2, v111, v111
  v_mfma_f32_32x32x16_bf16 v[240:255], a[220:223], a[252:255], v[240:255]
  ds_read_b64_tr_b16 a[188:189], v33 offset:45056
  ds_read_b64_tr_b16 a[190:191], v33 offset:45568
  ds_read_b128 a[228:231], v21 offset:4096
  v_sub_f32 v113, v113, v4
  v_fmac_f32 v3, v112, v112
  s_waitcnt lgkmcnt(13)
  v_mfma_f32_32x32x16_bf16 v[128:143], a[160:163], a[224:227], v[128:143]
  ds_read_b64_tr_b16 a[192:193], v32 offset:34816
  ds_read_b64_tr_b16 a[194:195], v32 offset:35328
  ds_read_b64_tr_b16 a[196:197], v33 offset:34816
  buffer_load_dwordx4 v18, s[24:27], s21 offen offset:2048 lds
  v_sub_f32 v114, v114, v4
  v_fmac_f32 v2, v113, v113
  v_mfma_f32_32x32x16_bf16 v[144:159], a[164:167], a[224:227], v[144:159]
  ds_read_b64_tr_b16 a[198:199], v33 offset:35328
  ds_read_b64_tr_b16 a[200:201], v32 offset:38912
  ds_read_b64_tr_b16 a[202:203], v32 offset:39424
  v_sub_f32 v115, v115, v4
  v_fmac_f32 v3, v114, v114
  s_waitcnt lgkmcnt(15)
  v_mfma_f32_32x32x16_bf16 v[160:175], a[168:171], a[224:227], v[160:175]
  ds_read_b64_tr_b16 a[204:205], v33 offset:38912
  ds_read_b64_tr_b16 a[206:207], v33 offset:39424
  buffer_load_dwordx4 v19, s[24:27], s21 offen offset:3072 lds
  s_add_u32 m0, s67, 16384
  s_add_u32 s4, s4, s5
  v_sub_f32 v116, v116, v4
  v_mfma_f32_32x32x16_bf16 v[176:191], a[172:175], a[224:227], v[176:191]
  ds_read_b64_tr_b16 a[208:209], v32 offset:43008
  ds_read_b64_tr_b16 a[210:211], v32 offset:43520
  v_fmac_f32 v2, v115, v115
  v_sub_f32 v117, v117, v4
  v_fmac_f32 v3, v116, v116
  s_waitcnt lgkmcnt(15)
  v_mfma_f32_32x32x16_bf16 v[192:207], a[176:179], a[224:227], v[192:207]
  ds_read_b64_tr_b16 a[212:213], v33 offset:43008
  ds_read_b64_tr_b16 a[214:215], v33 offset:43520
  buffer_load_dwordx4 v24, s[28:31], s4 offen offset:0 lds
  v_sub_f32 v118, v118, v4
  v_fmac_f32 v2, v117, v117
  v_sub_f32 v119, v119, v4
  v_mfma_f32_32x32x16_bf16 v[208:223], a[180:183], a[224:227], v[208:223]
  ds_read_b64_tr_b16 a[216:217], v32 offset:47104
  ds_read_b64_tr_b16 a[218:219], v32 offset:47616
  v_fmac_f32 v3, v118, v118
  v_sub_f32 v120, v120, v4
  v_fmac_f32 v2, v119, v119
  s_waitcnt lgkmcnt(15)
  v_mfma_f32_32x32x16_bf16 v[224:239], a[184:187], a[224:227], v[224:239]
  ds_read_b64_tr_b16 a[220:221], v33 offset:47104
  ds_read_b64_tr_b16 a[222:223], v33 offset:47616
  buffer_load_dwordx4 v25, s[28:31], s4 offen offset:1024 lds
  v_sub_f32 v121, v121, v4
  v_fmac_f32 v3, v120, v120
  v_sub_f32 v122, v122, v4
  v_mfma_f32_32x32x16_bf16 v[240:255], a[188:191], a[224:227], v[240:255]
  ds_read_b128 a[232:235], v22 offset:4096
  ds_read_b128 a[236:239], v23 offset:4096
  v_fmac_f32 v2, v121, v121
  v_sub_f32 v123, v123, v4
  v_fmac_f32 v3, v122, v122
  s_waitcnt lgkmcnt(14)
  v_mfma_f32_32x32x16_bf16 v[128:143], a[192:195], a[228:231], v[128:143]
  buffer_load_dwordx4 v26, s[28:31], s4 offen offset:2048 lds
  v_fmac_f32 v2, v123, v123
  v_add_f32 v2, v2, v3
  s_nop 1
  v_add_f32_dpp v2, v2, v2 row_ror:8 row_mask:0xf bank_mask:0xf
  s_nop 1
  v_add_f32_dpp v2, v2, v2 row_ror:4 row_mask:0xf bank_mask:0xf
  s_nop 1
  v_add_f32_dpp v2, v2, v2 row_ror:2 row_mask:0xf bank_mask:0xf
  v_mfma_f32_32x32x16_bf16 v[144:159], a[196:199], a[228:231], v[144:159]
  s_nop 0
  v_add_f32_dpp v2, v2, v2 row_ror:1 row_mask:0xf bank_mask:0xf
  v_fmac_f32 v5, 0x3acccccd, v2
  buffer_store_dwordx2 v[4:5], v1, s[36:39], s0 offen sc1
  s_waitcnt lgkmcnt(10)
  v_mfma_f32_32x32x16_bf16 v[160:175], a[200:203], a[228:231], v[160:175]
  s_waitcnt vmcnt(24) lgkmcnt(0)
  s_barrier
  ds_read_b64_tr_b16 a[160:161], v32 offset:49152
  ds_read_b64_tr_b16 a[162:163], v32 offset:49664
  ds_read_b64_tr_b16 a[164:165], v33 offset:49152
  buffer_load_dwordx4 v27, s[28:31], s4 offen offset:3072 lds
  s_add_u32 m0, s67, 32768
  s_add_u32 s4, s4, s5
  v_mfma_f32_32x32x16_bf16 v[176:191], a[204:207], a[228:231], v[176:191]
  ds_read_b64_tr_b16 a[166:167], v33 offset:49664
  ds_read_b64_tr_b16 a[168:169], v32 offset:53248
  ds_read_b64_tr_b16 a[170:171], v32 offset:53760
  v_mfma_f32_32x32x16_bf16 v[192:207], a[208:211], a[228:231], v[192:207]
  ds_read_b64_tr_b16 a[172:173], v33 offset:53248
  ds_read_b64_tr_b16 a[174:175], v33 offset:53760
  ds_read_b64_tr_b16 a[176:177], v32 offset:57344
  buffer_load_dwordx4 v24, s[28:31], s4 offen offset:0 lds
  v_mfma_f32_32x32x16_bf16 v[208:223], a[212:215], a[228:231], v[208:223]
  ds_read_b64_tr_b16 a[178:179], v32 offset:57856
  ds_read_b64_tr_b16 a[180:181], v33 offset:57344
  ds_read_b64_tr_b16 a[182:183], v33 offset:57856
  v_mfma_f32_32x32x16_bf16 v[224:239], a[216:219], a[228:231], v[224:239]
  ds_read_b64_tr_b16 a[184:185], v32 offset:61440
  ds_read_b64_tr_b16 a[186:187], v32 offset:61952
  buffer_load_dwordx4 v25, s[28:31], s4 offen offset:1024 lds
  v_mfma_f32_32x32x16_bf16 v[240:255], a[220:223], a[228:231], v[240:255]
  ds_read_b64_tr_b16 a[188:189], v33 offset:61440
  ds_read_b64_tr_b16 a[190:191], v33 offset:61952
  s_waitcnt lgkmcnt(12)
  v_mfma_f32_32x32x16_bf16 v[128:143], a[160:163], a[232:235], v[128:143]
  ds_read_b64_tr_b16 a[192:193], v32 offset:51200
  ds_read_b64_tr_b16 a[194:195], v32 offset:51712
  buffer_load_dwordx4 v26, s[28:31], s4 offen offset:2048 lds
  v_mfma_f32_32x32x16_bf16 v[144:159], a[164:167], a[232:235], v[144:159]
  ds_read_b64_tr_b16 a[196:197], v33 offset:51200
  ds_read_b64_tr_b16 a[198:199], v33 offset:51712
  s_waitcnt lgkmcnt(12)
  v_mfma_f32_32x32x16_bf16 v[160:175], a[168:171], a[232:235], v[160:175]
  ds_read_b64_tr_b16 a[200:201], v32 offset:55296
  ds_read_b64_tr_b16 a[202:203], v32 offset:55808
  buffer_load_dwordx4 v27, s[28:31], s4 offen offset:3072 lds
  s_add_u32 m0, s66, 4096
  s_add_u32 s21, s65, 896
  v_mfma_f32_32x32x16_bf16 v[176:191], a[172:175], a[232:235], v[176:191]
  ds_read_b64_tr_b16 a[204:205], v33 offset:55296
  ds_read_b64_tr_b16 a[206:207], v33 offset:55808
  s_waitcnt lgkmcnt(12)
  v_mfma_f32_32x32x16_bf16 v[192:207], a[176:179], a[232:235], v[192:207]
  ds_read_b64_tr_b16 a[208:209], v32 offset:59392
  ds_read_b64_tr_b16 a[210:211], v32 offset:59904
  buffer_load_dwordx4 v16, s[24:27], s21 offen offset:0 lds
  v_mfma_f32_32x32x16_bf16 v[208:223], a[180:183], a[232:235], v[208:223]
  ds_read_b64_tr_b16 a[212:213], v33 offset:59392
  ds_read_b64_tr_b16 a[214:215], v33 offset:59904
  s_waitcnt lgkmcnt(12)
  v_mfma_f32_32x32x16_bf16 v[224:239], a[184:187], a[232:235], v[224:239]
  ds_read_b64_tr_b16 a[216:217], v32 offset:63488
  ds_read_b64_tr_b16 a[218:219], v32 offset:64000
  buffer_load_dwordx4 v17, s[24:27], s21 offen offset:1024 lds
  v_mfma_f32_32x32x16_bf16 v[240:255], a[188:191], a[232:235], v[240:255]
  ds_read_b64_tr_b16 a[220:221], v33 offset:63488
  ds_read_b64_tr_b16 a[222:223], v33 offset:64000
  s_waitcnt lgkmcnt(12)
  v_mfma_f32_32x32x16_bf16 v[128:143], a[192:195], a[236:239], v[128:143]
  buffer_load_dwordx4 v18, s[24:27], s21 offen offset:2048 lds
  v_mfma_f32_32x32x16_bf16 v[144:159], a[196:199], a[236:239], v[144:159]
  s_waitcnt lgkmcnt(8)
  v_mfma_f32_32x32x16_bf16 v[160:175], a[200:203], a[236:239], v[160:175]
  s_waitcnt vmcnt(8) lgkmcnt(0)
  s_barrier
  s_add_u32 s18, s64, 1
  v_mov_b32 v14, s18
  buffer_store_dword v14, v9, s[36:39], 0 offen sc1
  ds_read_b128 a[240:243], v20 offset:8192
  ds_read_b64_tr_b16 a[160:161], v34 offset:0
  ds_read_b64_tr_b16 a[162:163], v34 offset:512
  buffer_load_dwordx4 v19, s[24:27], s21 offen offset:3072 lds
  s_add_u32 m0, s67, 49152
  s_add_u32 s4, s4, s5
  v_mfma_f32_32x32x16_bf16 v[176:191], a[204:207], a[236:239], v[176:191]
  ds_read_b64_tr_b16 a[164:165], v35 offset:0
  ds_read_b64_tr_b16 a[166:167], v35 offset:512
  ds_read_b64_tr_b16 a[168:169], v34 offset:4096
  v_mfma_f32_32x32x16_bf16 v[192:207], a[208:211], a[236:239], v[192:207]
  ds_read_b64_tr_b16 a[170:171], v34 offset:4608
  ds_read_b64_tr_b16 a[172:173], v35 offset:4096
  ds_read_b64_tr_b16 a[174:175], v35 offset:4608
  buffer_load_dwordx4 v24, s[28:31], s4 offen offset:0 lds
  v_mfma_f32_32x32x16_bf16 v[208:223], a[212:215], a[236:239], v[208:223]
  ds_read_b64_tr_b16 a[176:177], v34 offset:8192
  ds_read_b64_tr_b16 a[178:179], v34 offset:8704
  ds_read_b64_tr_b16 a[180:181], v35 offset:8192
  v_mfma_f32_32x32x16_bf16 v[224:239], a[216:219], a[236:239], v[224:239]
  ds_read_b64_tr_b16 a[182:183], v35 offset:8704
  ds_read_b64_tr_b16 a[184:185], v34 offset:12288
  ds_read_b64_tr_b16 a[186:187], v34 offset:12800
  buffer_load_dwordx4 v25, s[28:31], s4 offen offset:1024 lds
  v_mfma_f32_32x32x16_bf16 v[240:255], a[220:223], a[236:239], v[240:255]
  ds_read_b64_tr_b16 a[188:189], v35 offset:12288
  ds_read_b64_tr_b16 a[190:191], v35 offset:12800
  ds_read_b128 a[244:247], v21 offset:8192
  s_waitcnt lgkmcnt(13)
  v_mfma_f32_32x32x16_bf16 v[128:143], a[160:163], a[240:243], v[128:143]
  ds_read_b64_tr_b16 a[192:193], v34 offset:2048
  ds_read_b64_tr_b16 a[194:195], v34 offset:2560
  ds_read_b64_tr_b16 a[196:197], v35 offset:2048
  buffer_load_dwordx4 v26, s[28:31], s4 offen offset:2048 lds
  v_mfma_f32_32x32x16_bf16 v[144:159], a[164:167], a[240:243], v[144:159]
  ds_read_b64_tr_b16 a[198:199], v35 offset:2560
  ds_read_b64_tr_b16 a[200:201], v34 offset:6144
  ds_read_b64_tr_b16 a[202:203], v34 offset:6656
  s_waitcnt lgkmcnt(15)
  v_mfma_f32_32x32x16_bf16 v[160:175], a[168:171], a[240:243], v[160:175]
  ds_read_b64_tr_b16 a[204:205], v35 offset:6144
  ds_read_b64_tr_b16 a[206:207], v35 offset:6656
  buffer_load_dwordx4 v27, s[28:31], s4 offen offset:3072 lds
  v_mfma_f32_32x32x16_bf16 v[176:191], a[172:175], a[240:243], v[176:191]
  ds_read_b64_tr_b16 a[208:209], v34 offset:10240
  ds_read_b64_tr_b16 a[210:211], v34 offset:10752
  s_waitcnt lgkmcnt(15)
  v_mfma_f32_32x32x16_bf16 v[192:207], a[176:179], a[240:243], v[192:207]
  ds_read_b64_tr_b16 a[212:213], v35 offset:10240
  ds_read_b64_tr_b16 a[214:215], v35 offset:10752
  v_mfma_f32_32x32x16_bf16 v[208:223], a[180:183], a[240:243], v[208:223]
  ds_read_b64_tr_b16 a[216:217], v34 offset:14336
  ds_read_b64_tr_b16 a[218:219], v34 offset:14848
  s_waitcnt lgkmcnt(15)
  v_mfma_f32_32x32x16_bf16 v[224:239], a[184:187], a[240:243], v[224:239]
  ds_read_b64_tr_b16 a[220:221], v35 offset:14336
  ds_read_b64_tr_b16 a[222:223], v35 offset:14848
  v_mfma_f32_32x32x16_bf16 v[240:255], a[188:191], a[240:243], v[240:255]
  ds_read_b128 a[248:251], v22 offset:8192
  ds_read_b128 a[252:255], v23 offset:8192
  s_waitcnt lgkmcnt(14)
  v_mfma_f32_32x32x16_bf16 v[128:143], a[192:195], a[244:247], v[128:143]
  v_mfma_f32_32x32x16_bf16 v[144:159], a[196:199], a[244:247], v[144:159]
  s_waitcnt lgkmcnt(10)
  v_mfma_f32_32x32x16_bf16 v[160:175], a[200:203], a[244:247], v[160:175]
  s_waitcnt lgkmcnt(0)
  s_barrier
  ds_read_b64_tr_b16 a[160:161], v34 offset:16384
  ds_read_b64_tr_b16 a[162:163], v34 offset:16896
  ds_read_b64_tr_b16 a[164:165], v35 offset:16384
  s_add_u32 m0, s67, 65536
  s_add_u32 s4, s4, s5
  buffer_load_dwordx4 v24, s[28:31], s4 offen offset:0 lds
  v_mfma_f32_32x32x16_bf16 v[176:191], a[204:207], a[244:247], v[176:191]
  ds_read_b64_tr_b16 a[166:167], v35 offset:16896
  ds_read_b64_tr_b16 a[168:169], v34 offset:20480
  ds_read_b64_tr_b16 a[170:171], v34 offset:20992
  buffer_load_dwordx4 v25, s[28:31], s4 offen offset:1024 lds
  v_mfma_f32_32x32x16_bf16 v[192:207], a[208:211], a[244:247], v[192:207]
  ds_read_b64_tr_b16 a[172:173], v35 offset:20480
  ds_read_b64_tr_b16 a[174:175], v35 offset:20992
  ds_read_b64_tr_b16 a[176:177], v34 offset:24576
  v_mfma_f32_32x32x16_bf16 v[208:223], a[212:215], a[244:247], v[208:223]
  ds_read_b64_tr_b16 a[178:179], v34 offset:25088
  ds_read_b64_tr_b16 a[180:181], v35 offset:24576
  ds_read_b64_tr_b16 a[182:183], v35 offset:25088
  buffer_load_dwordx4 v26, s[28:31], s4 offen offset:2048 lds
  v_mfma_f32_32x32x16_bf16 v[224:239], a[216:219], a[244:247], v[224:239]
  ds_read_b64_tr_b16 a[184:185], v34 offset:28672
  ds_read_b64_tr_b16 a[186:187], v34 offset:29184
  v_mfma_f32_32x32x16_bf16 v[240:255], a[220:223], a[244:247], v[240:255]
  ds_read_b64_tr_b16 a[188:189], v35 offset:28672
  ds_read_b64_tr_b16 a[190:191], v35 offset:29184
  buffer_load_dwordx4 v27, s[28:31], s4 offen offset:3072 lds
  s_add_u32 m0, s66, 8192
  s_add_u32 s21, s65, 1024
  s_waitcnt lgkmcnt(12)
  v_mfma_f32_32x32x16_bf16 v[128:143], a[160:163], a[248:251], v[128:143]
  ds_read_b64_tr_b16 a[192:193], v34 offset:18432
  ds_read_b64_tr_b16 a[194:195], v34 offset:18944
  v_mfma_f32_32x32x16_bf16 v[144:159], a[164:167], a[248:251], v[144:159]
  ds_read_b64_tr_b16 a[196:197], v35 offset:18432
  ds_read_b64_tr_b16 a[198:199], v35 offset:18944
  buffer_load_dwordx4 v16, s[24:27], s21 offen offset:0 lds
  s_waitcnt lgkmcnt(12)
  v_mfma_f32_32x32x16_bf16 v[160:175], a[168:171], a[248:251], v[160:175]
  ds_read_b64_tr_b16 a[200:201], v34 offset:22528
  ds_read_b64_tr_b16 a[202:203], v34 offset:23040
  v_mfma_f32_32x32x16_bf16 v[176:191], a[172:175], a[248:251], v[176:191]
  ds_read_b64_tr_b16 a[204:205], v35 offset:22528
  ds_read_b64_tr_b16 a[206:207], v35 offset:23040
  buffer_load_dwordx4 v17, s[24:27], s21 offen offset:1024 lds
  s_waitcnt lgkmcnt(12)
  v_mfma_f32_32x32x16_bf16 v[192:207], a[176:179], a[248:251], v[192:207]
  ds_read_b64_tr_b16 a[208:209], v34 offset:26624
  ds_read_b64_tr_b16 a[210:211], v34 offset:27136
  v_mfma_f32_32x32x16_bf16 v[208:223], a[180:183], a[248:251], v[208:223]
  ds_read_b64_tr_b16 a[212:213], v35 offset:26624
  ds_read_b64_tr_b16 a[214:215], v35 offset:27136
  buffer_load_dwordx4 v18, s[24:27], s21 offen offset:2048 lds
  s_waitcnt lgkmcnt(12)
  v_mfma_f32_32x32x16_bf16 v[224:239], a[184:187], a[248:251], v[224:239]
  ds_read_b64_tr_b16 a[216:217], v34 offset:30720
  ds_read_b64_tr_b16 a[218:219], v34 offset:31232
  v_mfma_f32_32x32x16_bf16 v[240:255], a[188:191], a[248:251], v[240:255]
  ds_read_b64_tr_b16 a[220:221], v35 offset:30720
  ds_read_b64_tr_b16 a[222:223], v35 offset:31232
  buffer_load_dwordx4 v19, s[24:27], s21 offen offset:3072 lds
  s_waitcnt lgkmcnt(12)
  v_mfma_f32_32x32x16_bf16 v[128:143], a[192:195], a[252:255], v[128:143]
  v_mfma_f32_32x32x16_bf16 v[144:159], a[196:199], a[252:255], v[144:159]
  s_waitcnt lgkmcnt(8)
  v_mfma_f32_32x32x16_bf16 v[160:175], a[200:203], a[252:255], v[160:175]
  s_waitcnt lgkmcnt(0)
  s_barrier
  ds_read_b128 a[224:227], v20 offset:0
  ds_read_b64_tr_b16 a[160:161], v32 offset:0
  ds_read_b64_tr_b16 a[162:163], v32 offset:512
  s_add_u32 m0, s67, 81920
  s_add_u32 s4, s4, s5
  buffer_load_dwordx4 v24, s[28:31], s4 offen offset:0 lds
  v_mfma_f32_32x32x16_bf16 v[176:191], a[204:207], a[252:255], v[176:191]
  ds_read_b64_tr_b16 a[164:165], v33 offset:0
  ds_read_b64_tr_b16 a[166:167], v33 offset:512
  ds_read_b64_tr_b16 a[168:169], v32 offset:4096
  buffer_load_dwordx4 v25, s[28:31], s4 offen offset:1024 lds
  v_mfma_f32_32x32x16_bf16 v[192:207], a[208:211], a[252:255], v[192:207]
  ds_read_b64_tr_b16 a[170:171], v32 offset:4608
  ds_read_b64_tr_b16 a[172:173], v33 offset:4096
  ds_read_b64_tr_b16 a[174:175], v33 offset:4608
  v_mfma_f32_32x32x16_bf16 v[208:223], a[212:215], a[252:255], v[208:223]
  ds_read_b64_tr_b16 a[176:177], v32 offset:8192
  ds_read_b64_tr_b16 a[178:179], v32 offset:8704
  ds_read_b64_tr_b16 a[180:181], v33 offset:8192
  buffer_load_dwordx4 v26, s[28:31], s4 offen offset:2048 lds
  v_mfma_f32_32x32x16_bf16 v[224:239], a[216:219], a[252:255], v[224:239]
  ds_read_b64_tr_b16 a[182:183], v33 offset:8704
  ds_read_b64_tr_b16 a[184:185], v32 offset:12288
  ds_read_b64_tr_b16 a[186:187], v32 offset:12800
  v_mfma_f32_32x32x16_bf16 v[240:255], a[220:223], a[252:255], v[240:255]
  ds_read_b64_tr_b16 a[188:189], v33 offset:12288
  ds_read_b64_tr_b16 a[190:191], v33 offset:12800
  ds_read_b128 a[228:231], v21 offset:0
  buffer_load_dwordx4 v27, s[28:31], s4 offen offset:3072 lds
  s_waitcnt lgkmcnt(13)
  v_mfma_f32_32x32x16_bf16 v[128:143], a[160:163], a[224:227], v[128:143]
  ds_read_b64_tr_b16 a[192:193], v32 offset:2048
  ds_read_b64_tr_b16 a[194:195], v32 offset:2560
  ds_read_b64_tr_b16 a[196:197], v33 offset:2048
  v_mfma_f32_32x32x16_bf16 v[144:159], a[164:167], a[224:227], v[144:159]
  ds_read_b64_tr_b16 a[198:199], v33 offset:2560
  ds_read_b64_tr_b16 a[200:201], v32 offset:6144
  ds_read_b64_tr_b16 a[202:203], v32 offset:6656
  s_waitcnt lgkmcnt(15)
  v_mfma_f32_32x32x16_bf16 v[160:175], a[168:171], a[224:227], v[160:175]
  ds_read_b64_tr_b16 a[204:205], v33 offset:6144
  ds_read_b64_tr_b16 a[206:207], v33 offset:6656
  v_mfma_f32_32x32x16_bf16 v[176:191], a[172:175], a[224:227], v[176:191]
  ds_read_b64_tr_b16 a[208:209], v32 offset:10240
  ds_read_b64_tr_b16 a[210:211], v32 offset:10752
  s_waitcnt lgkmcnt(15)
  v_mfma_f32_32x32x16_bf16 v[192:207], a[176:179], a[224:227], v[192:207]
  ds_read_b64_tr_b16 a[212:213], v33 offset:10240
  ds_read_b64_tr_b16 a[214:215], v33 offset:10752
  v_mfma_f32_32x32x16_bf16 v[208:223], a[180:183], a[224:227], v[208:223]
  ds_read_b64_tr_b16 a[216:217], v32 offset:14336
  ds_read_b64_tr_b16 a[218:219], v32 offset:14848
  s_waitcnt lgkmcnt(15)
  v_mfma_f32_32x32x16_bf16 v[224:239], a[184:187], a[224:227], v[224:239]
  ds_read_b64_tr_b16 a[220:221], v33 offset:14336
  ds_read_b64_tr_b16 a[222:223], v33 offset:14848
  v_mfma_f32_32x32x16_bf16 v[240:255], a[188:191], a[224:227], v[240:255]
  ds_read_b128 a[232:235], v22 offset:0
  ds_read_b128 a[236:239], v23 offset:0
  s_waitcnt lgkmcnt(14)
  v_mfma_f32_32x32x16_bf16 v[128:143], a[192:195], a[228:231], v[128:143]
  v_mfma_f32_32x32x16_bf16 v[144:159], a[196:199], a[228:231], v[144:159]
  s_waitcnt lgkmcnt(10)
  v_mfma_f32_32x32x16_bf16 v[160:175], a[200:203], a[228:231], v[160:175]
  s_waitcnt vmcnt(25) lgkmcnt(0)
  s_barrier
  ds_read_b64_tr_b16 a[160:161], v32 offset:16384
  ds_read_b64_tr_b16 a[162:163], v32 offset:16896
  ds_read_b64_tr_b16 a[164:165], v33 offset:16384
  s_add_u32 m0, s67, 0
  s_add_u32 s4, s4, s5
  buffer_load_dwordx4 v24, s[28:31], s4 offen offset:0 lds
  v_mfma_f32_32x32x16_bf16 v[176:191], a[204:207], a[228:231], v[176:191]
  ds_read_b64_tr_b16 a[166:167], v33 offset:16896
  ds_read_b64_tr_b16 a[168:169], v32 offset:20480
  ds_read_b64_tr_b16 a[170:171], v32 offset:20992
  buffer_load_dwordx4 v25, s[28:31], s4 offen offset:1024 lds
  v_mfma_f32_32x32x16_bf16 v[192:207], a[208:211], a[228:231], v[192:207]
  ds_read_b64_tr_b16 a[172:173], v33 offset:20480
  ds_read_b64_tr_b16 a[174:175], v33 offset:20992
  ds_read_b64_tr_b16 a[176:177], v32 offset:24576
  v_mfma_f32_32x32x16_bf16 v[208:223], a[212:215], a[228:231], v[208:223]
  ds_read_b64_tr_b16 a[178:179], v32 offset:25088
  ds_read_b64_tr_b16 a[180:181], v33 offset:24576
  ds_read_b64_tr_b16 a[182:183], v33 offset:25088
  buffer_load_dwordx4 v26, s[28:31], s4 offen offset:2048 lds
  v_mfma_f32_32x32x16_bf16 v[224:239], a[216:219], a[228:231], v[224:239]
  ds_read_b64_tr_b16 a[184:185], v32 offset:28672
  ds_read_b64_tr_b16 a[186:187], v32 offset:29184
  v_mfma_f32_32x32x16_bf16 v[240:255], a[220:223], a[228:231], v[240:255]
  ds_read_b64_tr_b16 a[188:189], v33 offset:28672
  ds_read_b64_tr_b16 a[190:191], v33 offset:29184
  buffer_load_dwordx4 v27, s[28:31], s4 offen offset:3072 lds
  s_add_u32 m0, s66, 0
  s_add_u32 s21, s65, 1152
  s_waitcnt lgkmcnt(12)
  v_mfma_f32_32x32x16_bf16 v[128:143], a[160:163], a[232:235], v[128:143]
  ds_read_b64_tr_b16 a[192:193], v32 offset:18432
  ds_read_b64_tr_b16 a[194:195], v32 offset:18944
  v_mfma_f32_32x32x16_bf16 v[144:159], a[164:167], a[232:235], v[144:159]
  ds_read_b64_tr_b16 a[196:197], v33 offset:18432
  ds_read_b64_tr_b16 a[198:199], v33 offset:18944
  buffer_load_dwordx4 v16, s[24:27], s21 offen offset:0 lds
  s_waitcnt lgkmcnt(12)
  v_mfma_f32_32x32x16_bf16 v[160:175], a[168:171], a[232:235], v[160:175]
  ds_read_b64_tr_b16 a[200:201], v32 offset:22528
  ds_read_b64_tr_b16 a[202:203], v32 offset:23040
  v_mfma_f32_32x32x16_bf16 v[176:191], a[172:175], a[232:235], v[176:191]
  ds_read_b64_tr_b16 a[204:205], v33 offset:22528
  ds_read_b64_tr_b16 a[206:207], v33 offset:23040
  buffer_load_dwordx4 v17, s[24:27], s21 offen offset:1024 lds
  s_waitcnt lgkmcnt(12)
  v_mfma_f32_32x32x16_bf16 v[192:207], a[176:179], a[232:235], v[192:207]
  ds_read_b64_tr_b16 a[208:209], v32 offset:26624
  ds_read_b64_tr_b16 a[210:211], v32 offset:27136
  v_mfma_f32_32x32x16_bf16 v[208:223], a[180:183], a[232:235], v[208:223]
  ds_read_b64_tr_b16 a[212:213], v33 offset:26624
  ds_read_b64_tr_b16 a[214:215], v33 offset:27136
  buffer_load_dwordx4 v18, s[24:27], s21 offen offset:2048 lds
  s_waitcnt lgkmcnt(12)
  v_mfma_f32_32x32x16_bf16 v[224:239], a[184:187], a[232:235], v[224:239]
  ds_read_b64_tr_b16 a[216:217], v32 offset:30720
  ds_read_b64_tr_b16 a[218:219], v32 offset:31232
  v_mfma_f32_32x32x16_bf16 v[240:255], a[188:191], a[232:235], v[240:255]
  ds_read_b64_tr_b16 a[220:221], v33 offset:30720
  ds_read_b64_tr_b16 a[222:223], v33 offset:31232
  buffer_load_dwordx4 v19, s[24:27], s21 offen offset:3072 lds
  s_waitcnt lgkmcnt(12)
  v_mfma_f32_32x32x16_bf16 v[128:143], a[192:195], a[236:239], v[128:143]
  v_mfma_f32_32x32x16_bf16 v[144:159], a[196:199], a[236:239], v[144:159]
  s_waitcnt lgkmcnt(8)
  v_mfma_f32_32x32x16_bf16 v[160:175], a[200:203], a[236:239], v[160:175]
  s_waitcnt vmcnt(24) lgkmcnt(0)
  s_barrier
  buffer_load_dword v10, v11, s[36:39], 0 offen sc1
  ds_read_b128 a[240:243], v20 offset:4096
  ds_read_b64_tr_b16 a[160:161], v32 offset:32768
  ds_read_b64_tr_b16 a[162:163], v32 offset:33280
  s_add_u32 m0, s67, 16384
  s_add_u32 s4, s4, s5
  buffer_load_dwordx4 v24, s[28:31], s4 offen offset:0 lds
  v_mfma_f32_32x32x16_bf16 v[176:191], a[204:207], a[236:239], v[176:191]
  ds_read_b64_tr_b16 a[164:165], v33 offset:32768
  ds_read_b64_tr_b16 a[166:167], v33 offset:33280
  ds_read_b64_tr_b16 a[168:169], v32 offset:36864
  buffer_load_dwordx4 v25, s[28:31], s4 offen offset:1024 lds
  v_mfma_f32_32x32x16_bf16 v[192:207], a[208:211], a[236:239], v[192:207]
  ds_read_b64_tr_b16 a[170:171], v32 offset:37376
  ds_read_b64_tr_b16 a[172:173], v33 offset:36864
  ds_read_b64_tr_b16 a[174:175], v33 offset:37376
  v_mfma_f32_32x32x16_bf16 v[208:223], a[212:215], a[236:239], v[208:223]
  ds_read_b64_tr_b16 a[176:177], v32 offset:40960
  ds_read_b64_tr_b16 a[178:179], v32 offset:41472
  ds_read_b64_tr_b16 a[180:181], v33 offset:40960
  buffer_load_dwordx4 v26, s[28:31], s4 offen offset:2048 lds
  v_mfma_f32_32x32x16_bf16 v[224:239], a[216:219], a[236:239], v[224:239]
  ds_read_b64_tr_b16 a[182:183], v33 offset:41472
  ds_read_b64_tr_b16 a[184:185], v32 offset:45056
  ds_read_b64_tr_b16 a[186:187], v32 offset:45568
  v_mfma_f32_32x32x16_bf16 v[240:255], a[220:223], a[236:239], v[240:255]
  ds_read_b64_tr_b16 a[188:189], v33 offset:45056
  ds_read_b64_tr_b16 a[190:191], v33 offset:45568
  ds_read_b128 a[244:247], v21 offset:4096
  buffer_load_dwordx4 v27, s[28:31], s4 offen offset:3072 lds
  s_waitcnt lgkmcnt(13)
  v_mfma_f32_32x32x16_bf16 v[128:143], a[160:163], a[240:243], v[128:143]
  ds_read_b64_tr_b16 a[192:193], v32 offset:34816
  ds_read_b64_tr_b16 a[194:195], v32 offset:35328
  ds_read_b64_tr_b16 a[196:197], v33 offset:34816
  v_mfma_f32_32x32x16_bf16 v[144:159], a[164:167], a[240:243], v[144:159]
  ds_read_b64_tr_b16 a[198:199], v33 offset:35328
  ds_read_b64_tr_b16 a[200:201], v32 offset:38912
  ds_read_b64_tr_b16 a[202:203], v32 offset:39424
  s_waitcnt lgkmcnt(15)
  v_mfma_f32_32x32x16_bf16 v[160:175], a[168:171], a[240:243], v[160:175]
  ds_read_b64_tr_b16 a[204:205], v33 offset:38912
  ds_read_b64_tr_b16 a[206:207], v33 offset:39424
  v_mfma_f32_32x32x16_bf16 v[176:191], a[172:175], a[240:243], v[176:191]
  ds_read_b64_tr_b16 a[208:209], v32 offset:43008
  ds_read_b64_tr_b16 a[210:211], v32 offset:43520
  s_waitcnt lgkmcnt(15)
  v_mfma_f32_32x32x16_bf16 v[192:207], a[176:179], a[240:243], v[192:207]
  ds_read_b64_tr_b16 a[212:213], v33 offset:43008
  ds_read_b64_tr_b16 a[214:215], v33 offset:43520
  v_mfma_f32_32x32x16_bf16 v[208:223], a[180:183], a[240:243], v[208:223]
  ds_read_b64_tr_b16 a[216:217], v32 offset:47104
  ds_read_b64_tr_b16 a[218:219], v32 offset:47616
  s_waitcnt lgkmcnt(15)
  v_mfma_f32_32x32x16_bf16 v[224:239], a[184:187], a[240:243], v[224:239]
  ds_read_b64_tr_b16 a[220:221], v33 offset:47104
  ds_read_b64_tr_b16 a[222:223], v33 offset:47616
  v_mfma_f32_32x32x16_bf16 v[240:255], a[188:191], a[240:243], v[240:255]
  ds_read_b128 a[248:251], v22 offset:4096
  ds_read_b128 a[252:255], v23 offset:4096
  s_waitcnt lgkmcnt(14)
  v_mfma_f32_32x32x16_bf16 v[128:143], a[192:195], a[244:247], v[128:143]
  v_mfma_f32_32x32x16_bf16 v[144:159], a[196:199], a[244:247], v[144:159]
  s_waitcnt lgkmcnt(10)
  v_mfma_f32_32x32x16_bf16 v[160:175], a[200:203], a[244:247], v[160:175]
  s_waitcnt vmcnt(25) lgkmcnt(0)
  s_barrier
  ds_read_b64_tr_b16 a[160:161], v32 offset:49152
  ds_read_b64_tr_b16 a[162:163], v32 offset:49664
  ds_read_b64_tr_b16 a[164:165], v33 offset:49152
  v_mfma_f32_32x32x16_bf16 v[176:191], a[204:207], a[244:247], v[176:191]
  ds_read_b64_tr_b16 a[166:167], v33 offset:49664
  ds_read_b64_tr_b16 a[168:169], v32 offset:53248
  ds_read_b64_tr_b16 a[170:171], v32 offset:53760
  v_mfma_f32_32x32x16_bf16 v[192:207], a[208:211], a[244:247], v[192:207]
  ds_read_b64_tr_b16 a[172:173], v33 offset:53248
  ds_read_b64_tr_b16 a[174:175], v33 offset:53760
  ds_read_b64_tr_b16 a[176:177], v32 offset:57344
  v_mfma_f32_32x32x16_bf16 v[208:223], a[212:215], a[244:247], v[208:223]
  ds_read_b64_tr_b16 a[178:179], v32 offset:57856
  ds_read_b64_tr_b16 a[180:181], v33 offset:57344
  ds_read_b64_tr_b16 a[182:183], v33 offset:57856
  v_mfma_f32_32x32x16_bf16 v[224:239], a[216:219], a[244:247], v[224:239]
  ds_read_b64_tr_b16 a[184:185], v32 offset:61440
  ds_read_b64_tr_b16 a[186:187], v32 offset:61952
  v_mfma_f32_32x32x16_bf16 v[240:255], a[220:223], a[244:247], v[240:255]
  ds_read_b64_tr_b16 a[188:189], v33 offset:61440
  ds_read_b64_tr_b16 a[190:191], v33 offset:61952
  s_waitcnt lgkmcnt(12)
  v_mfma_f32_32x32x16_bf16 v[128:143], a[160:163], a[248:251], v[128:143]
  ds_read_b64_tr_b16 a[192:193], v32 offset:51200
  ds_read_b64_tr_b16 a[194:195], v32 offset:51712
  v_mfma_f32_32x32x16_bf16 v[144:159], a[164:167], a[248:251], v[144:159]
  ds_read_b64_tr_b16 a[196:197], v33 offset:51200
  ds_read_b64_tr_b16 a[198:199], v33 offset:51712
  s_waitcnt lgkmcnt(12)
  v_mfma_f32_32x32x16_bf16 v[160:175], a[168:171], a[248:251], v[160:175]
  ds_read_b64_tr_b16 a[200:201], v32 offset:55296
  ds_read_b64_tr_b16 a[202:203], v32 offset:55808
  v_mfma_f32_32x32x16_bf16 v[176:191], a[172:175], a[248:251], v[176:191]
  ds_read_b64_tr_b16 a[204:205], v33 offset:55296
  ds_read_b64_tr_b16 a[206:207], v33 offset:55808
  s_waitcnt lgkmcnt(12)
  v_mfma_f32_32x32x16_bf16 v[192:207], a[176:179], a[248:251], v[192:207]
  ds_read_b64_tr_b16 a[208:209], v32 offset:59392
  ds_read_b64_tr_b16 a[210:211], v32 offset:59904
  v_mfma_f32_32x32x16_bf16 v[208:223], a[180:183], a[248:251], v[208:223]
  ds_read_b64_tr_b16 a[212:213], v33 offset:59392
  ds_read_b64_tr_b16 a[214:215], v33 offset:59904
  s_waitcnt lgkmcnt(12)
  v_mfma_f32_32x32x16_bf16 v[224:239], a[184:187], a[248:251], v[224:239]
  ds_read_b64_tr_b16 a[216:217], v32 offset:63488
  ds_read_b64_tr_b16 a[218:219], v32 offset:64000
  v_mfma_f32_32x32x16_bf16 v[240:255], a[188:191], a[248:251], v[240:255]
  ds_read_b64_tr_b16 a[220:221], v33 offset:63488
  ds_read_b64_tr_b16 a[222:223], v33 offset:64000
  s_waitcnt lgkmcnt(12)
  v_mfma_f32_32x32x16_bf16 v[128:143], a[192:195], a[252:255], v[128:143]
  v_mfma_f32_32x32x16_bf16 v[144:159], a[196:199], a[252:255], v[144:159]
  s_waitcnt lgkmcnt(8)
  v_mfma_f32_32x32x16_bf16 v[160:175], a[200:203], a[252:255], v[160:175]
  s_add_u32 s18, s64, 1
  s_waitcnt vmcnt(4)
  v_subrev_u32 v14, s18, v10
  v_cmp_gt_u32_e64 s[100:101], 8, v14
  s_nop 0
  s_cmp_eq_u64 s[100:101], -1
  s_cbranch_scc0 f_spin3
f_back3:
  s_waitcnt lgkmcnt(0)
  s_barrier
  ds_read_b128 a[224:227], v20 offset:8192
  ds_read_b64_tr_b16 a[160:161], v34 offset:0
  ds_read_b64_tr_b16 a[162:163], v34 offset:512
  s_lshl_b32 s18, s60, 2
  s_add_u32 s18, s18, s3
  s_lshl_b32 s18, s18, 8
  s_add_u32 s18, s18, 15859712
  v_and_b32 v14, 31, v0
  v_lshlrev_b32 v14, 3, v14
  buffer_load_dwordx2 v[52:53], v14, s[36:39], s18 offen sc1
  s_cmp_lt_u32 s61, 2
  s_cselect_b32 s68, 8, -2
  s_cselect_b32 s69, 1, 0
  s_add_u32 s68, s68, s61
  s_lshl_b32 s68, s68, 10
  s_mul_i32 s69, s69, -30720
  s_add_u32 s68, s68, s69
  s_add_u32 s68, s68, 15955968
  v_mfma_f32_32x32x16_bf16 v[176:191], a[204:207], a[252:255], v[176:191]
  ds_read_b64_tr_b16 a[164:165], v35 offset:0
  ds_read_b64_tr_b16 a[166:167], v35 offset:512
  ds_read_b64_tr_b16 a[168:169], v34 offset:4096
  buffer_load_dwordx4 v[64:67], v47, s[36:39], s68 offen offset:0 sc1
  v_mfma_f32_32x32x16_bf16 v[192:207], a[208:211], a[252:255], v[192:207]
  ds_read_b64_tr_b16 a[170:171], v34 offset:4608
  ds_read_b64_tr_b16 a[172:173], v35 offset:4096
  ds_read_b64_tr_b16 a[174:175], v35 offset:4608
  v_mfma_f32_32x32x16_bf16 v[208:223], a[212:215], a[252:255], v[208:223]
  ds_read_b64_tr_b16 a[176:177], v34 offset:8192
  ds_read_b64_tr_b16 a[178:179], v34 offset:8704
  ds_read_b64_tr_b16 a[180:181], v35 offset:8192
  buffer_load_dwordx4 v[68:71], v47, s[36:39], s68 offen offset:512 sc1
  s_mov_b32 s68, 6
  s_mov_b32 s69, 0
  s_add_u32 s68, s68, s61
  s_lshl_b32 s68, s68, 10
  s_mul_i32 s69, s69, -30720
  s_add_u32 s68, s68, s69
  s_add_u32 s68, s68, 15955968
  v_mfma_f32_32x32x16_bf16 v[224:239], a[216:219], a[252:255], v[224:239]
  ds_read_b64_tr_b16 a[182:183], v35 offset:8704
  ds_read_b64_tr_b16 a[184:185], v34 offset:12288
  ds_read_b64_tr_b16 a[186:187], v34 offset:12800
  v_mfma_f32_32x32x16_bf16 v[240:255], a[220:223], a[252:255], v[240:255]
  ds_read_b64_tr_b16 a[188:189], v35 offset:12288
  ds_read_b64_tr_b16 a[190:191], v35 offset:12800
  ds_read_b128 a[228:231], v21 offset:8192
  buffer_load_dwordx4 v[72:75], v47, s[36:39], s68 offen offset:0 sc1
  s_waitcnt lgkmcnt(13)
  v_mfma_f32_32x32x16_bf16 v[128:143], a[160:163], a[224:227], v[128:143]
  ds_read_b64_tr_b16 a[192:193], v34 offset:2048
  ds_read_b64_tr_b16 a[194:195], v34 offset:2560
  ds_read_b64_tr_b16 a[196:197], v35 offset:2048
  v_mfma_f32_32x32x16_bf16 v[144:159], a[164:167], a[224:227], v[144:159]
  ds_read_b64_tr_b16 a[198:199], v35 offset:2560
  ds_read_b64_tr_b16 a[200:201], v34 offset:6144
  ds_read_b64_tr_b16 a[202:203], v34 offset:6656
  buffer_load_dwordx4 v[76:79], v47, s[36:39], s68 offen offset:512 sc1
  s_mov_b32 s68, 14
  s_mov_b32 s69, 0
  s_add_u32 s68, s68, s61
  s_lshl_b32 s68, s68, 10
  s_mul_i32 s69, s69, -30720
  s_add_u32 s68, s68, s69
  s_add_u32 s68, s68, 15955968
  s_waitcnt lgkmcnt(15)
  v_mfma_f32_32x32x16_bf16 v[160:175], a[168:171], a[224:227], v[160:175]
  ds_read_b64_tr_b16 a[204:205], v35 offset:6144
  ds_read_b64_tr_b16 a[206:207], v35 offset:6656
  v_mfma_f32_32x32x16_bf16 v[176:191], a[172:175], a[224:227], v[176:191]
  ds_read_b64_tr_b16 a[208:209], v34 offset:10240
  ds_read_b64_tr_b16 a[210:211], v34 offset:10752
  buffer_load_dwordx4 v[80:83], v47, s[36:39], s68 offen offset:0 sc1
  s_waitcnt lgkmcnt(15)
  v_mfma_f32_32x32x16_bf16 v[192:207], a[176:179], a[224:227], v[192:207]
  ds_read_b64_tr_b16 a[212:213], v35 offset:10240
  ds_read_b64_tr_b16 a[214:215], v35 offset:10752
  v_mfma_f32_32x32x16_bf16 v[208:223], a[180:183], a[224:227], v[208:223]
  ds_read_b64_tr_b16 a[216:217], v34 offset:14336
  ds_read_b64_tr_b16 a[218:219], v34 offset:14848
  buffer_load_dwordx4 v[84:87], v47, s[36:39], s68 offen offset:512 sc1
  s_cmp_lt_u32 s61, 5
  s_cselect_b32 s68, 22, 19
  s_mov_b32 s69, 0
  s_add_u32 s68, s68, s61
  s_lshl_b32 s68, s68, 10
  s_mul_i32 s69, s69, -30720
  s_add_u32 s68, s68, s69
  s_add_u32 s68, s68, 15955968
  s_waitcnt lgkmcnt(15)
  v_mfma_f32_32x32x16_bf16 v[224:239], a[184:187], a[224:227], v[224:239]
  ds_read_b64_tr_b16 a[220:221], v35 offset:14336
  ds_read_b64_tr_b16 a[222:223], v35 offset:14848
  v_mfma_f32_32x32x16_bf16 v[240:255], a[188:191], a[224:227], v[240:255]
  ds_read_b128 a[232:235], v22 offset:8192
  ds_read_b128 a[236:239], v23 offset:8192
  buffer_load_dwordx4 v[88:91], v47, s[36:39], s68 offen offset:0 sc1
  s_waitcnt lgkmcnt(14)
  v_mfma_f32_32x32x16_bf16 v[128:143], a[192:195], a[228:231], v[128:143]
  v_mfma_f32_32x32x16_bf16 v[144:159], a[196:199], a[228:231], v[144:159]
  buffer_load_dwordx4 v[92:95], v47, s[36:39], s68 offen offset:512 sc1
  s_add_u32 s22, s8, 40960
  s_waitcnt lgkmcnt(10)
  v_mfma_f32_32x32x16_bf16 v[160:175], a[200:203], a[228:231], v[160:175]
  s_waitcnt lgkmcnt(0)
  s_barrier
  ds_read_b64_tr_b16 a[160:161], v34 offset:16384
  ds_read_b64_tr_b16 a[162:163], v34 offset:16896
  ds_read_b64_tr_b16 a[164:165], v35 offset:16384
  v_mfma_f32_32x32x16_bf16 v[176:191], a[204:207], a[228:231], v[176:191]
  ds_read_b64_tr_b16 a[166:167], v35 offset:16896
  ds_read_b64_tr_b16 a[168:169], v34 offset:20480
  ds_read_b64_tr_b16 a[170:171], v34 offset:20992
  buffer_load_dwordx4 a[0:3], v12, s[36:39], s22 offen offset:0 sc1
  v_mfma_f32_32x32x16_bf16 v[192:207], a[208:211], a[228:231], v[192:207]
  ds_read_b64_tr_b16 a[172:173], v35 offset:20480
  ds_read_b64_tr_b16 a[174:175], v35 offset:20992
  ds_read_b64_tr_b16 a[176:177], v34 offset:24576
  v_mfma_f32_32x32x16_bf16 v[208:223], a[212:215], a[228:231], v[208:223]
  ds_read_b64_tr_b16 a[178:179], v34 offset:25088
  ds_read_b64_tr_b16 a[180:181], v35 offset:24576
  ds_read_b64_tr_b16 a[182:183], v35 offset:25088
  buffer_load_dwordx4 a[4:7], v12, s[36:39], s22 offen offset:1024 sc1
  v_mfma_f32_32x32x16_bf16 v[224:239], a[216:219], a[228:231], v[224:239]
  ds_read_b64_tr_b16 a[184:185], v34 offset:28672
  ds_read_b64_tr_b16 a[186:187], v34 offset:29184
  v_mfma_f32_32x32x16_bf16 v[240:255], a[220:223], a[228:231], v[240:255]
  ds_read_b64_tr_b16 a[188:189], v35 offset:28672
  ds_read_b64_tr_b16 a[190:191], v35 offset:29184
  buffer_load_dwordx4 a[8:11], v12, s[36:39], s22 offen offset:2048 sc1
  s_waitcnt lgkmcnt(12)
  v_mfma_f32_32x32x16_bf16 v[128:143], a[160:163], a[232:235], v[128:143]
  ds_read_b64_tr_b16 a[192:193], v34 offset:18432
  ds_read_b64_tr_b16 a[194:195], v34 offset:18944
  v_mfma_f32_32x32x16_bf16 v[144:159], a[164:167], a[232:235], v[144:159]
  ds_read_b64_tr_b16 a[196:197], v35 offset:18432
  ds_read_b64_tr_b16 a[198:199], v35 offset:18944
  buffer_load_dwordx4 a[12:15], v12, s[36:39], s22 offen offset:3072 sc1
  s_waitcnt lgkmcnt(12)
  v_mfma_f32_32x32x16_bf16 v[160:175], a[168:171], a[232:235], v[160:175]
  ds_read_b64_tr_b16 a[200:201], v34 offset:22528
  ds_read_b64_tr_b16 a[202:203], v34 offset:23040
  v_mfma_f32_32x32x16_bf16 v[176:191], a[172:175], a[232:235], v[176:191]
  ds_read_b64_tr_b16 a[204:205], v35 offset:22528
  ds_read_b64_tr_b16 a[206:207], v35 offset:23040
  buffer_load_dwordx4 a[16:19], v13, s[36:39], s22 offen offset:0 sc1
  s_add_u32 s22, s8, 61440
  s_waitcnt lgkmcnt(12)
  v_mfma_f32_32x32x16_bf16 v[192:207], a[176:179], a[232:235], v[192:207]
  ds_read_b64_tr_b16 a[208:209], v34 offset:26624
  ds_read_b64_tr_b16 a[210:211], v34 offset:27136
  v_mfma_f32_32x32x16_bf16 v[208:223], a[180:183], a[232:235], v[208:223]
  ds_read_b64_tr_b16 a[212:213], v35 offset:26624
  ds_read_b64_tr_b16 a[214:215], v35 offset:27136
  buffer_load_dwordx4 a[20:23], v12, s[36:39], s22 offen offset:0 sc1
  s_waitcnt lgkmcnt(12)
  v_mfma_f32_32x32x16_bf16 v[224:239], a[184:187], a[232:235], v[224:239]
  ds_read_b64_tr_b16 a[216:217], v34 offset:30720
  ds_read_b64_tr_b16 a[218:219], v34 offset:31232
  v_mfma_f32_32x32x16_bf16 v[240:255], a[188:191], a[232:235], v[240:255]
  ds_read_b64_tr_b16 a[220:221], v35 offset:30720
  ds_read_b64_tr_b16 a[222:223], v35 offset:31232
  buffer_load_dwordx4 a[24:27], v12, s[36:39], s22 offen offset:1024 sc1
  s_waitcnt lgkmcnt(12)
  v_mfma_f32_32x32x16_bf16 v[128:143], a[192:195], a[236:239], v[128:143]
  v_mfma_f32_32x32x16_bf16 v[144:159], a[196:199], a[236:239], v[144:159]
  buffer_load_dwordx4 a[28:31], v12, s[36:39], s22 offen offset:2048 sc1
  s_waitcnt lgkmcnt(8)
  v_mfma_f32_32x32x16_bf16 v[160:175], a[200:203], a[236:239], v[160:175]
  s_waitcnt lgkmcnt(0)
  s_barrier
  ds_read_b128 a[240:243], v20 offset:0
  ds_read_b64_tr_b16 a[160:161], v32 offset:0
  ds_read_b64_tr_b16 a[162:163], v32 offset:512
  v_mfma_f32_32x32x16_bf16 v[176:191], a[204:207], a[236:239], v[176:191]
  ds_read_b64_tr_b16 a[164:165], v33 offset:0
  ds_read_b64_tr_b16 a[166:167], v33 offset:512
  ds_read_b64_tr_b16 a[168:169], v32 offset:4096
  buffer_load_dwordx4 a[32:35], v12, s[36:39], s22 offen offset:3072 sc1
  v_mfma_f32_32x32x16_bf16 v[192:207], a[208:211], a[236:239], v[192:207]
  ds_read_b64_tr_b16 a[170:171], v32 offset:4608
  ds_read_b64_tr_b16 a[172:173], v33 offset:4096
  ds_read_b64_tr_b16 a[174:175], v33 offset:4608
  s_waitcnt vmcnt(17)
  v_rsq_f32 v46, v53
  v_mfma_f32_32x32x16_bf16 v[208:223], a[212:215], a[236:239], v[208:223]
  ds_read_b64_tr_b16 a[176:177], v32 offset:8192
  ds_read_b64_tr_b16 a[178:179], v32 offset:8704
  ds_read_b64_tr_b16 a[180:181], v33 offset:8192
  buffer_load_dwordx4 a[36:39], v13, s[36:39], s22 offen offset:0 sc1
  s_add_u32 s22, s8, 81920
  v_sub_f32 v1, 0, v52
  v_mfma_f32_32x32x16_bf16 v[224:239], a[216:219], a[236:239], v[224:239]
  ds_read_b64_tr_b16 a[182:183], v33 offset:8704
  ds_read_b64_tr_b16 a[184:185], v32 offset:12288
  ds_read_b64_tr_b16 a[186:187], v32 offset:12800
  v_mul_f32 v2, v53, v46
  v_mul_f32 v45, 0x3fb8aa3b, v46
  v_mfma_f32_32x32x16_bf16 v[240:255], a[220:223], a[236:239], v[240:255]
  ds_read_b64_tr_b16 a[188:189], v33 offset:12288
  ds_read_b64_tr_b16 a[190:191], v33 offset:12800
  ds_read_b128 a[244:247], v21 offset:0
  buffer_load_dwordx4 a[40:43], v12, s[36:39], s22 offen offset:0 sc1
  v_cvt_pk_bf16_f32 v49, v1, v2
  v_lshlrev_b32 v3, 16, v49
  s_waitcnt lgkmcnt(13)
  v_mfma_f32_32x32x16_bf16 v[128:143], a[160:163], a[240:243], v[128:143]
  ds_read_b64_tr_b16 a[192:193], v32 offset:2048
  ds_read_b64_tr_b16 a[194:195], v32 offset:2560
  ds_read_b64_tr_b16 a[196:197], v33 offset:2048
  v_and_b32 v4, 0xffff0000, v49
  v_sub_f32 v3, v1, v3
  v_mfma_f32_32x32x16_bf16 v[144:159], a[164:167], a[240:243], v[144:159]
  ds_read_b64_tr_b16 a[198:199], v33 offset:2560
  ds_read_b64_tr_b16 a[200:201], v32 offset:6144
  ds_read_b64_tr_b16 a[202:203], v32 offset:6656
  buffer_load_dwordx4 a[44:47], v12, s[36:39], s22 offen offset:1024 sc1
  v_sub_f32 v4, v2, v4
  v_cvt_pk_bf16_f32 v48, v1, v3
  s_waitcnt lgkmcnt(15)
  v_mfma_f32_32x32x16_bf16 v[160:175], a[168:171], a[240:243], v[160:175]
  ds_read_b64_tr_b16 a[204:205], v33 offset:6144
  ds_read_b64_tr_b16 a[206:207], v33 offset:6656
  v_cvt_pk_bf16_f32 v50, v4, 0
  v_mov_b32 v51, 0
  v_cmp_gt_u32 vcc, 32, v0
  s_nop 1
  v_cndmask_b32 v48, 0, v48, vcc
  v_cndmask_b32 v49, 0, v49, vcc
  v_cndmask_b32 v50, 0, v50, vcc
  v_mfma_f32_32x32x16_bf16 v[176:191], a[172:175], a[240:243], v[176:191]
  ds_read_b64_tr_b16 a[208:209], v32 offset:10240
  ds_read_b64_tr_b16 a[210:211], v32 offset:10752
  buffer_load_dwordx4 a[48:51], v12, s[36:39], s22 offen offset:2048 sc1
  s_waitcnt lgkmcnt(15)
  v_mfma_f32_32x32x16_bf16 v[192:207], a[176:179], a[240:243], v[192:207]
  ds_read_b64_tr_b16 a[212:213], v33 offset:10240
  ds_read_b64_tr_b16 a[214:215], v33 offset:10752
  s_waitcnt vmcnt(20)
  v_add_f32 v1, v64, v66
  v_lshrrev_b32 v66, 16, v65
  v_cvt_pk_bf16_f32 v64, v1, v1
  v_mfma_f32_32x32x16_bf16 v[208:223], a[180:183], a[240:243], v[208:223]
  ds_read_b64_tr_b16 a[216:217], v32 offset:14336
  ds_read_b64_tr_b16 a[218:219], v32 offset:14848
  buffer_load_dwordx4 a[52:55], v12, s[36:39], s22 offen offset:3072 sc1
  v_and_b32 v67, 0xffff0000, v64
  v_sub_f32 v1, v1, v67
  v_mov_b32 v67, 0
  s_waitcnt lgkmcnt(15)
  v_mfma_f32_32x32x16_bf16 v[224:239], a[184:187], a[240:243], v[224:239]
  ds_read_b64_tr_b16 a[220:221], v33 offset:14336
  ds_read_b64_tr_b16 a[222:223], v33 offset:14848
  v_cvt_pk_bf16_f32 v65, v1, v65
  s_waitcnt vmcnt(20)
  v_add_f32 v2, v68, v70
  v_lshrrev_b32 v70, 16, v69
  v_mfma_f32_32x32x16_bf16 v[240:255], a[188:191], a[240:243], v[240:255]
  ds_read_b128 a[248:251], v22 offset:0
  ds_read_b128 a[252:255], v23 offset:0
  buffer_load_dwordx4 a[56:59], v13, s[36:39], s22 offen offset:0 sc1
  s_add_u32 s22, s8, 102400
  v_cvt_pk_bf16_f32 v68, v2, v2
  v_and_b32 v71, 0xffff0000, v68
  s_waitcnt lgkmcnt(14)
  v_mfma_f32_32x32x16_bf16 v[128:143], a[192:195], a[244:247], v[128:143]
  v_sub_f32 v2, v2, v71
  v_mov_b32 v71, 0
  v_cvt_pk_bf16_f32 v69, v2, v69
  s_waitcnt vmcnt(20)
  v_add_f32 v1, v72, v74
  v_lshrrev_b32 v74, 16, v73
  v_mfma_f32_32x32x16_bf16 v[144:159], a[196:199], a[244:247], v[144:159]
  buffer_load_dwordx4 a[60:63], v12, s[36:39], s22 offen offset:0 sc1
  v_cvt_pk_bf16_f32 v72, v1, v1
  v_and_b32 v75, 0xffff0000, v72
  v_sub_f32 v1, v1, v75
  v_mov_b32 v75, 0
  v_cvt_pk_bf16_f32 v73, v1, v73
  s_waitcnt lgkmcnt(10)
  v_mfma_f32_32x32x16_bf16 v[160:175], a[200:203], a[244:247], v[160:175]
  s_waitcnt vmcnt(20)
  v_add_f32 v2, v76, v78
  s_waitcnt lgkmcnt(0)
  s_barrier
  ds_read_b64_tr_b16 a[160:161], v32 offset:16384
  ds_read_b64_tr_b16 a[162:163], v32 offset:16896
  ds_read_b64_tr_b16 a[164:165], v33 offset:16384
  v_mfma_f32_32x32x16_bf16 v[176:191], a[204:207], a[244:247], v[176:191]
  ds_read_b64_tr_b16 a[166:167], v33 offset:16896
  ds_read_b64_tr_b16 a[168:169], v32 offset:20480
  ds_read_b64_tr_b16 a[170:171], v32 offset:20992
  buffer_load_dwordx4 a[64:67], v12, s[36:39], s22 offen offset:1024 sc1
  v_lshrrev_b32 v78, 16, v77
  v_cvt_pk_bf16_f32 v76, v2, v2
  v_mfma_f32_32x32x16_bf16 v[192:207], a[208:211], a[244:247], v[192:207]
  ds_read_b64_tr_b16 a[172:173], v33 offset:20480
  ds_read_b64_tr_b16 a[174:175], v33 offset:20992
  ds_read_b64_tr_b16 a[176:177], v32 offset:24576
  v_and_b32 v79, 0xffff0000, v76
  v_sub_f32 v2, v2, v79
  v_mfma_f32_32x32x16_bf16 v[208:223], a[212:215], a[244:247], v[208:223]
  ds_read_b64_tr_b16 a[178:179], v32 offset:25088
  ds_read_b64_tr_b16 a[180:181], v33 offset:24576
  ds_read_b64_tr_b16 a[182:183], v33 offset:25088
  buffer_load_dwordx4 a[68:71], v12, s[36:39], s22 offen offset:2048 sc1
  v_mov_b32 v79, 0
  v_cvt_pk_bf16_f32 v77, v2, v77
  v_mfma_f32_32x32x16_bf16 v[224:239], a[216:219], a[244:247], v[224:239]
  ds_read_b64_tr_b16 a[184:185], v32 offset:28672
  ds_read_b64_tr_b16 a[186:187], v32 offset:29184
  s_waitcnt vmcnt(21)
  v_add_f32 v1, v80, v82
  v_lshrrev_b32 v82, 16, v81
  v_cvt_pk_bf16_f32 v80, v1, v1
  v_mfma_f32_32x32x16_bf16 v[240:255], a[220:223], a[244:247], v[240:255]
  ds_read_b64_tr_b16 a[188:189], v33 offset:28672
  ds_read_b64_tr_b16 a[190:191], v33 offset:29184
  buffer_load_dwordx4 a[72:75], v12, s[36:39], s22 offen offset:3072 sc1
  v_and_b32 v83, 0xffff0000, v80
  v_sub_f32 v1, v1, v83
  v_mov_b32 v83, 0
  s_waitcnt lgkmcnt(12)
  v_mfma_f32_32x32x16_bf16 v[128:143], a[160:163], a[248:251], v[128:143]
  ds_read_b64_tr_b16 a[192:193], v32 offset:18432
  ds_read_b64_tr_b16 a[194:195], v32 offset:18944
  v_cvt_pk_bf16_f32 v81, v1, v81
  s_waitcnt vmcnt(21)
  v_add_f32 v2, v84, v86
  v_lshrrev_b32 v86, 16, v85
  v_mfma_f32_32x32x16_bf16 v[144:159], a[164:167], a[248:251], v[144:159]
  ds_read_b64_tr_b16 a[196:197], v33 offset:18432
  ds_read_b64_tr_b16 a[198:199], v33 offset:18944
  buffer_load_dwordx4 a[76:79], v13, s[36:39], s22 offen offset:0 sc1
  v_cvt_pk_bf16_f32 v84, v2, v2
  v_and_b32 v87, 0xffff0000, v84
  v_sub_f32 v2, v2, v87
  s_waitcnt lgkmcnt(12)
  v_mfma_f32_32x32x16_bf16 v[160:175], a[168:171], a[248:251], v[160:175]
  ds_read_b64_tr_b16 a[200:201], v32 offset:22528
  ds_read_b64_tr_b16 a[202:203], v32 offset:23040
  v_mov_b32 v87, 0
  v_cvt_pk_bf16_f32 v85, v2, v85
  s_waitcnt vmcnt(21)
  v_add_f32 v1, v88, v90
  v_mfma_f32_32x32x16_bf16 v[176:191], a[172:175], a[248:251], v[176:191]
  ds_read_b64_tr_b16 a[204:205], v33 offset:22528
  ds_read_b64_tr_b16 a[206:207], v33 offset:23040
  v_lshrrev_b32 v90, 16, v89
  v_cvt_pk_bf16_f32 v88, v1, v1
  v_and_b32 v91, 0xffff0000, v88
  v_sub_f32 v1, v1, v91
  s_waitcnt lgkmcnt(12)
  v_mfma_f32_32x32x16_bf16 v[192:207], a[176:179], a[248:251], v[192:207]
  ds_read_b64_tr_b16 a[208:209], v32 offset:26624
  ds_read_b64_tr_b16 a[210:211], v32 offset:27136
  v_mov_b32 v91, 0
  v_cvt_pk_bf16_f32 v89, v1, v89
  s_waitcnt vmcnt(20)
  v_add_f32 v2, v92, v94
  v_mfma_f32_32x32x16_bf16 v[208:223], a[180:183], a[248:251], v[208:223]
  ds_read_b64_tr_b16 a[212:213], v33 offset:26624
  ds_read_b64_tr_b16 a[214:215], v33 offset:27136
  v_lshrrev_b32 v94, 16, v93
  v_cvt_pk_bf16_f32 v92, v2, v2
  v_and_b32 v95, 0xffff0000, v92
  v_sub_f32 v2, v2, v95
  s_waitcnt lgkmcnt(12)
  v_mfma_f32_32x32x16_bf16 v[224:239], a[184:187], a[248:251], v[224:239]
  ds_read_b64_tr_b16 a[216:217], v32 offset:30720
  ds_read_b64_tr_b16 a[218:219], v32 offset:31232
  v_mov_b32 v95, 0
  v_cvt_pk_bf16_f32 v93, v2, v93
  s_cmp_lt_u32 s61, 2
  s_cselect_b32 s12, 8, -2
  s_cselect_b32 s0, 1, 0
  v_mfma_f32_32x32x16_bf16 v[240:255], a[188:191], a[248:251], v[240:255]
  ds_read_b64_tr_b16 a[220:221], v33 offset:30720
  ds_read_b64_tr_b16 a[222:223], v33 offset:31232
  s_add_u32 s12, s12, s61
  s_mov_b32 s14, s0
  s_waitcnt lgkmcnt(12)
  v_mfma_f32_32x32x16_bf16 v[128:143], a[192:195], a[252:255], v[128:143]
  s_mul_i32 s0, s0, 75776
  s_lshl_b32 s12, s12, 11
  s_add_u32 s12, s12, s6
  s_add_u32 s12, s12, s0
  s_mov_b32 s13, 6
  v_mfma_f32_32x32x16_bf16 v[144:159], a[196:199], a[252:255], v[144:159]
  s_mov_b32 s0, 0
  s_add_u32 s13, s13, s61
  s_lshl_b32 s13, s13, 11
  s_add_u32 s13, s13, s6
  s_mov_b32 s16, 14
  s_mov_b32 s0, 0
  s_waitcnt lgkmcnt(8)
  v_mfma_f32_32x32x16_bf16 v[160:175], a[200:203], a[252:255], v[160:175]
  s_add_u32 s16, s16, s61
  s_lshl_b32 s16, s16, 11
  s_add_u32 s16, s16, s6
  s_cmp_lt_u32 s61, 5
  s_cselect_b32 s17, 22, 19
  v_mfma_f32_32x32x16_bf16 v[176:191], a[204:207], a[252:255], v[176:191]
  s_mov_b32 s0, 0
  s_add_u32 s17, s17, s61
  s_lshl_b32 s17, s17, 11
  s_add_u32 s17, s17, s6
  s_waitcnt lgkmcnt(4)
  v_mfma_f32_32x32x16_bf16 v[192:207], a[208:211], a[252:255], v[192:207]
  v_mfma_f32_32x32x16_bf16 v[208:223], a[212:215], a[252:255], v[208:223]
  s_waitcnt lgkmcnt(0)
  v_mfma_f32_32x32x16_bf16 v[224:239], a[216:219], a[252:255], v[224:239]
  v_mfma_f32_32x32x16_bf16 v[240:255], a[220:223], a[252:255], v[240:255]
  v_mfma_f32_32x32x16_bf16 v[128:143], v[64:67], v[48:51], v[128:143]
  v_mfma_f32_32x32x16_bf16 v[144:159], v[68:71], v[48:51], v[144:159]
  v_mfma_f32_32x32x16_bf16 v[160:175], v[72:75], v[48:51], v[160:175]
  v_mfma_f32_32x32x16_bf16 v[176:191], v[76:79], v[48:51], v[176:191]
  v_mfma_f32_32x32x16_bf16 v[192:207], v[80:83], v[48:51], v[192:207]
  v_mfma_f32_32x32x16_bf16 v[208:223], v[84:87], v[48:51], v[208:223]
  v_mfma_f32_32x32x16_bf16 v[224:239], v[88:91], v[48:51], v[224:239]
  v_mfma_f32_32x32x16_bf16 v[240:255], v[92:95], v[48:51], v[240:255]
  s_lshr_b32 s0, s62, 4
  s_lshl_b32 s0, s0, 2
  s_bfe_u32 s1, s62, 0x30001
  s_lshl_b32 s1, s1, 3
  s_add_u32 s0, s0, s1
  s_mul_i32 s1, s63, 5
  s_lshr_b32 s1, s1, 2
  v_and_b32 v1, 1, v0
  v_add_u32 v1, s1, v1
  v_lshrrev_b32 v11, 3, v1
  v_bfe_u32 v2, v1, 1, 2
  v_and_b32 v1, 1, v1
  v_lshl_add_u32 v1, v11, 1, v1
  s_mov_b32 s1, 0
  v_lshl_add_u32 v1, v1, 6, v2
  s_add_u32 s0, s0, s1
  s_lshl_b32 s0, s0, 8
  s_add_u32 s0, s0, 4096
  v_lshl_add_u32 v11, v1, 8, s0
  s_add_u32 s0, s3, 0
  s_and_b32 s0, s0, 3
  s_mul_i32 s0, s0, 96256
  v_add_u32 v16, s0, v12
  s_add_u32 s0, s3, 1
  s_and_b32 s0, s0, 3
  s_mul_i32 s0, s0, 96256
  v_add_u32 v17, s0, v12
  s_add_u32 s0, s3, 2
  s_and_b32 s0, s0, 3
  s_mul_i32 s0, s0, 96256
  v_add_u32 v18, s0, v12
  s_add_u32 s0, s3, 3
  s_and_b32 s0, s0, 3
  s_mul_i32 s0, s0, 96256
  v_add_u32 v19, s0, v12
  v_lshrrev_b32 v1, 4, v0
  v_and_b32 v2, 1, v1
  v_lshrrev_b32 v3, 1, v1
  v_mul_u32_u24 v3, 5, v3
  s_mul_i32 s0, s63, 10
  v_add_u32 v3, s0, v3
  v_and_b32 v4, 15, v0
  v_lshlrev_b32 v4, 4, v4
  v_lshl_add_u32 v4, v3, 8, v4
  v_mul_u32_u24 v5, 768, v2
  v_add_u32 v20, v4, v5
  v_lshl_add_u32 v21, v2, 3, v4
  v_and_b32 v4, 15, v0
  v_lshlrev_b32 v22, 3, v4
  s_mul_i32 s9, s62, 385024
  s_add_u32 s9, s9, 3276800
  s_lshl_b32 s0, s3, 10
  s_add_u32 s7, s9, s0
  s_cmp_eq_u32 s14, 1
  s_cbranch_scc0 f_noq
  v_cvt_pk_bf16_f32 v128, v128, v129
  v_cvt_pk_bf16_f32 v129, v130, v131
  v_cvt_pk_bf16_f32 v130, v132, v133
  v_cvt_pk_bf16_f32 v131, v134, v135
  buffer_store_dwordx4 v[128:131], v44, s[36:39], s12 offen offset:0 sc1
  v_cvt_pk_bf16_f32 v136, v136, v137
  v_cvt_pk_bf16_f32 v137, v138, v139
  v_cvt_pk_bf16_f32 v138, v140, v141
  v_cvt_pk_bf16_f32 v139, v142, v143
  buffer_store_dwordx4 v[136:139], v44, s[36:39], s12 offen offset:512 sc1
  v_cvt_pk_bf16_f32 v144, v144, v145
  v_cvt_pk_bf16_f32 v145, v146, v147
  v_cvt_pk_bf16_f32 v146, v148, v149
  v_cvt_pk_bf16_f32 v147, v150, v151
  buffer_store_dwordx4 v[144:147], v44, s[36:39], s12 offen offset:1024 sc1
  v_cvt_pk_bf16_f32 v152, v152, v153
  v_cvt_pk_bf16_f32 v153, v154, v155
  v_cvt_pk_bf16_f32 v154, v156, v157
  v_cvt_pk_bf16_f32 v155, v158, v159
  buffer_store_dwordx4 v[152:155], v44, s[36:39], s12 offen offset:1536 sc1
  v_pk_mul_f32 v[160:161], v[160:161], v[44:45] op_sel:[0,1] op_sel_hi:[1,1]
  v_pk_mul_f32 v[162:163], v[162:163], v[44:45] op_sel:[0,1] op_sel_hi:[1,1]
  v_pk_mul_f32 v[164:165], v[164:165], v[44:45] op_sel:[0,1] op_sel_hi:[1,1]
  v_pk_mul_f32 v[166:167], v[166:167], v[44:45] op_sel:[0,1] op_sel_hi:[1,1]
  v_exp_f32 v64, v160
  v_exp_f32 v65, v161
  v_exp_f32 v66, v162
  v_exp_f32 v67, v163
  v_exp_f32 v68, v164
  v_exp_f32 v69, v165
  v_exp_f32 v70, v166
  v_exp_f32 v71, v167
  v_pk_fma_f32 v[72:73], v[64:65], 0.5, 1.0 op_sel_hi:[1,0,0]
  v_pk_fma_f32 v[74:75], v[66:67], 0.5, 1.0 op_sel_hi:[1,0,0]
  buffer_load_dwordx4 a[200:203], v12, s[36:39], s8 offen offset:0 sc1
  v_pk_fma_f32 v[76:77], v[68:69], 0.5, 1.0 op_sel_hi:[1,0,0]
  v_pk_fma_f32 v[78:79], v[70:71], 0.5, 1.0 op_sel_hi:[1,0,0]
  v_pk_fma_f32 v[64:65], v[64:65], v[72:73], 1.0 op_sel_hi:[1,1,0]
  v_pk_fma_f32 v[66:67], v[66:67], v[74:75], 1.0 op_sel_hi:[1,1,0]
  v_pk_fma_f32 v[68:69], v[68:69], v[76:77], 1.0 op_sel_hi:[1,1,0]
  v_pk_fma_f32 v[70:71], v[70:71], v[78:79], 1.0 op_sel_hi:[1,1,0]
  v_rcp_f32 v64, v64
  v_rcp_f32 v65, v65
  v_rcp_f32 v66, v66
  v_rcp_f32 v67, v67
  v_rcp_f32 v68, v68
  v_rcp_f32 v69, v69
  v_rcp_f32 v70, v70
  v_rcp_f32 v71, v71
  buffer_load_dwordx4 a[204:207], v12, s[36:39], s8 offen offset:1024 sc1
  v_pk_fma_f32 v[64:65], v[160:161], v[64:65], v[160:161] neg_lo:[1,0,0] neg_hi:[1,0,0]
  v_pk_fma_f32 v[66:67], v[162:163], v[66:67], v[162:163] neg_lo:[1,0,0] neg_hi:[1,0,0]
  v_pk_fma_f32 v[68:69], v[164:165], v[68:69], v[164:165] neg_lo:[1,0,0] neg_hi:[1,0,0]
  v_pk_fma_f32 v[70:71], v[166:167], v[70:71], v[166:167] neg_lo:[1,0,0] neg_hi:[1,0,0]
  v_cvt_pk_bf16_f32 v160, v64, v65
  v_cvt_pk_bf16_f32 v161, v66, v67
  v_cvt_pk_bf16_f32 v162, v68, v69
  v_cvt_pk_bf16_f32 v163, v70, v71
  buffer_store_dwordx4 v[160:163], v44, s[36:39], s13 offen offset:0 sc1
  v_pk_mul_f32 v[168:169], v[168:169], v[44:45] op_sel:[0,1] op_sel_hi:[1,1]
  v_pk_mul_f32 v[170:171], v[170:171], v[44:45] op_sel:[0,1] op_sel_hi:[1,1]
  v_pk_mul_f32 v[172:173], v[172:173], v[44:45] op_sel:[0,1] op_sel_hi:[1,1]
  v_pk_mul_f32 v[174:175], v[174:175], v[44:45] op_sel:[0,1] op_sel_hi:[1,1]
  v_exp_f32 v64, v168
  buffer_load_dwordx4 a[208:211], v12, s[36:39], s8 offen offset:2048 sc1
  v_exp_f32 v65, v169
  v_exp_f32 v66, v170
  v_exp_f32 v67, v171
  v_exp_f32 v68, v172
  v_exp_f32 v69, v173
  v_exp_f32 v70, v174
  v_exp_f32 v71, v175
  v_pk_fma_f32 v[72:73], v[64:65], 0.5, 1.0 op_sel_hi:[1,0,0]
  v_pk_fma_f32 v[74:75], v[66:67], 0.5, 1.0 op_sel_hi:[1,0,0]
  v_pk_fma_f32 v[76:77], v[68:69], 0.5, 1.0 op_sel_hi:[1,0,0]
  v_pk_fma_f32 v[78:79], v[70:71], 0.5, 1.0 op_sel_hi:[1,0,0]
  v_pk_fma_f32 v[64:65], v[64:65], v[72:73], 1.0 op_sel_hi:[1,1,0]
  v_pk_fma_f32 v[66:67], v[66:67], v[74:75], 1.0 op_sel_hi:[1,1,0]
  v_pk_fma_f32 v[68:69], v[68:69], v[76:77], 1.0 op_sel_hi:[1,1,0]
  buffer_load_dwordx4 a[212:215], v12, s[36:39], s8 offen offset:3072 sc1
  v_pk_fma_f32 v[70:71], v[70:71], v[78:79], 1.0 op_sel_hi:[1,1,0]
  v_rcp_f32 v64, v64
  v_rcp_f32 v65, v65
  v_rcp_f32 v66, v66
  v_rcp_f32 v67, v67
  v_rcp_f32 v68, v68
  v_rcp_f32 v69, v69
  v_rcp_f32 v70, v70
  v_rcp_f32 v71, v71
  v_pk_fma_f32 v[64:65], v[168:169], v[64:65], v[168:169] neg_lo:[1,0,0] neg_hi:[1,0,0]
  v_pk_fma_f32 v[66:67], v[170:171], v[66:67], v[170:171] neg_lo:[1,0,0] neg_hi:[1,0,0]
  v_pk_fma_f32 v[68:69], v[172:173], v[68:69], v[172:173] neg_lo:[1,0,0] neg_hi:[1,0,0]
  v_pk_fma_f32 v[70:71], v[174:175], v[70:71], v[174:175] neg_lo:[1,0,0] neg_hi:[1,0,0]
  v_cvt_pk_bf16_f32 v168, v64, v65
  buffer_load_dwordx4 a[216:219], v13, s[36:39], s8 offen offset:0 sc1
  v_cvt_pk_bf16_f32 v169, v66, v67
  v_cvt_pk_bf16_f32 v170, v68, v69
  v_cvt_pk_bf16_f32 v171, v70, v71
  buffer_store_dwordx4 v[168:171], v44, s[36:39], s13 offen offset:512 sc1
  s_waitcnt vmcnt(7)
  s_barrier
  s_add_u32 s18, s64, 2
  v_mov_b32 v14, s18
  buffer_store_dword v14, v9, s[36:39], 0 offen sc1
  s_add_u32 s22, s8, 20480
  buffer_load_dwordx4 a[220:223], v12, s[36:39], s22 offen offset:0 sc1
  buffer_load_dwordx4 a[224:227], v12, s[36:39], s22 offen offset:1024 sc1
  buffer_load_dwordx4 a[228:231], v12, s[36:39], s22 offen offset:2048 sc1
  buffer_load_dwordx4 a[232:235], v12, s[36:39], s22 offen offset:3072 sc1
  buffer_load_dwordx4 a[236:239], v13, s[36:39], s22 offen offset:0 sc1
  s_add_u32 s22, s8, 122880
  buffer_load_dwordx4 a[80:83], v12, s[36:39], s22 offen offset:0 sc1
  buffer_load_dwordx4 a[84:87], v12, s[36:39], s22 offen offset:1024 sc1
  buffer_load_dwordx4 a[88:91], v12, s[36:39], s22 offen offset:2048 sc1
  buffer_load_dwordx4 a[92:95], v12, s[36:39], s22 offen offset:3072 sc1
  buffer_load_dwordx4 a[96:99], v13, s[36:39], s22 offen offset:0 sc1
  s_branch f_q9
f_noq:
  v_pk_mul_f32 v[128:129], v[128:129], v[44:45] op_sel:[0,1] op_sel_hi:[1,1]
  v_pk_mul_f32 v[130:131], v[130:131], v[44:45] op_sel:[0,1] op_sel_hi:[1,1]
  v_pk_mul_f32 v[132:133], v[132:133], v[44:45] op_sel:[0,1] op_sel_hi:[1,1]
  v_pk_mul_f32 v[134:135], v[134:135], v[44:45] op_sel:[0,1] op_sel_hi:[1,1]
  v_exp_f32 v64, v128
  v_exp_f32 v65, v129
  v_exp_f32 v66, v130
  v_exp_f32 v67, v131
  v_exp_f32 v68, v132
  v_exp_f32 v69, v133
  v_exp_f32 v70, v134
  v_exp_f32 v71, v135
  v_pk_fma_f32 v[72:73], v[64:65], 0.5, 1.0 op_sel_hi:[1,0,0]
  v_pk_fma_f32 v[74:75], v[66:67], 0.5, 1.0 op_sel_hi:[1,0,0]
  buffer_load_dwordx4 a[200:203], v12, s[36:39], s8 offen offset:0 sc1
  v_pk_fma_f32 v[76:77], v[68:69], 0.5, 1.0 op_sel_hi:[1,0,0]
  v_pk_fma_f32 v[78:79], v[70:71], 0.5, 1.0 op_sel_hi:[1,0,0]
  v_pk_fma_f32 v[64:65], v[64:65], v[72:73], 1.0 op_sel_hi:[1,1,0]
  v_pk_fma_f32 v[66:67], v[66:67], v[74:75], 1.0 op_sel_hi:[1,1,0]
  v_pk_fma_f32 v[68:69], v[68:69], v[76:77], 1.0 op_sel_hi:[1,1,0]
  v_pk_fma_f32 v[70:71], v[70:71], v[78:79], 1.0 op_sel_hi:[1,1,0]
  v_rcp_f32 v64, v64
  v_rcp_f32 v65, v65
  v_rcp_f32 v66, v66
  v_rcp_f32 v67, v67
  v_rcp_f32 v68, v68
  v_rcp_f32 v69, v69
  v_rcp_f32 v70, v70
  v_rcp_f32 v71, v71
  buffer_load_dwordx4 a[204:207], v12, s[36:39], s8 offen offset:1024 sc1
  v_pk_fma_f32 v[64:65], v[128:129], v[64:65], v[128:129] neg_lo:[1,0,0] neg_hi:[1,0,0]
  v_pk_fma_f32 v[66:67], v[130:131], v[66:67], v[130:131] neg_lo:[1,0,0] neg_hi:[1,0,0]
  v_pk_fma_f32 v[68:69], v[132:133], v[68:69], v[132:133] neg_lo:[1,0,0] neg_hi:[1,0,0]
  v_pk_fma_f32 v[70:71], v[134:135], v[70:71], v[134:135] neg_lo:[1,0,0] neg_hi:[1,0,0]
  v_cvt_pk_bf16_f32 v128, v64, v65
  v_cvt_pk_bf16_f32 v129, v66, v67
  v_cvt_pk_bf16_f32 v130, v68, v69
  v_cvt_pk_bf16_f32 v131, v70, v71
  buffer_store_dwordx4 v[128:131], v44, s[36:39], s12 offen offset:0 sc1
  v_pk_mul_f32 v[136:137], v[136:137], v[44:45] op_sel:[0,1] op_sel_hi:[1,1]
  v_pk_mul_f32 v[138:139], v[138:139], v[44:45] op_sel:[0,1] op_sel_hi:[1,1]
  v_pk_mul_f32 v[140:141], v[140:141], v[44:45] op_sel:[0,1] op_sel_hi:[1,1]
  v_pk_mul_f32 v[142:143], v[142:143], v[44:45] op_sel:[0,1] op_sel_hi:[1,1]
  v_exp_f32 v64, v136
  buffer_load_dwordx4 a[208:211], v12, s[36:39], s8 offen offset:2048 sc1
  v_exp_f32 v65, v137
  v_exp_f32 v66, v138
  v_exp_f32 v67, v139
  v_exp_f32 v68, v140
  v_exp_f32 v69, v141
  v_exp_f32 v70, v142
  v_exp_f32 v71, v143
  v_pk_fma_f32 v[72:73], v[64:65], 0.5, 1.0 op_sel_hi:[1,0,0]
  v_pk_fma_f32 v[74:75], v[66:67], 0.5, 1.0 op_sel_hi:[1,0,0]
  v_pk_fma_f32 v[76:77], v[68:69], 0.5, 1.0 op_sel_hi:[1,0,0]
  v_pk_fma_f32 v[78:79], v[70:71], 0.5, 1.0 op_sel_hi:[1,0,0]
  v_pk_fma_f32 v[64:65], v[64:65], v[72:73], 1.0 op_sel_hi:[1,1,0]
  v_pk_fma_f32 v[66:67], v[66:67], v[74:75], 1.0 op_sel_hi:[1,1,0]
  v_pk_fma_f32 v[68:69], v[68:69], v[76:77], 1.0 op_sel_hi:[1,1,0]
  buffer_load_dwordx4 a[212:215], v12, s[36:39], s8 offen offset:3072 sc1
  v_pk_fma_f32 v[70:71], v[70:71], v[78:79], 1.0 op_sel_hi:[1,1,0]
  v_rcp_f32 v64, v64
  v_rcp_f32 v65, v65
  v_rcp_f32 v66, v66
  v_rcp_f32 v67, v67
  v_rcp_f32 v68, v68
  v_rcp_f32 v69, v69
  v_rcp_f32 v70, v70
  v_rcp_f32 v71, v71
  v_pk_fma_f32 v[64:65], v[136:137], v[64:65], v[136:137] neg_lo:[1,0,0] neg_hi:[1,0,0]
  v_pk_fma_f32 v[66:67], v[138:139], v[66:67], v[138:139] neg_lo:[1,0,0] neg_hi:[1,0,0]
  v_pk_fma_f32 v[68:69], v[140:141], v[68:69], v[140:141] neg_lo:[1,0,0] neg_hi:[1,0,0]
  v_pk_fma_f32 v[70:71], v[142:143], v[70:71], v[142:143] neg_lo:[1,0,0] neg_hi:[1,0,0]
  v_cvt_pk_bf16_f32 v136, v64, v65
  buffer_load_dwordx4 a[216:219], v13, s[36:39], s8 offen offset:0 sc1
  s_add_u32 s22, s8, 20480
  v_cvt_pk_bf16_f32 v137, v66, v67
  v_cvt_pk_bf16_f32 v138, v68, v69
  v_cvt_pk_bf16_f32 v139, v70, v71
  buffer_store_dwordx4 v[136:139], v44, s[36:39], s12 offen offset:512 sc1
  v_pk_mul_f32 v[144:145], v[144:145], v[44:45] op_sel:[0,1] op_sel_hi:[1,1]
  v_pk_mul_f32 v[146:147], v[146:147], v[44:45] op_sel:[0,1] op_sel_hi:[1,1]
  v_pk_mul_f32 v[148:149], v[148:149], v[44:45] op_sel:[0,1] op_sel_hi:[1,1]
  v_pk_mul_f32 v[150:151], v[150:151], v[44:45] op_sel:[0,1] op_sel_hi:[1,1]
  v_exp_f32 v64, v144
  v_exp_f32 v65, v145
  v_exp_f32 v66, v146
  v_exp_f32 v67, v147
  v_exp_f32 v68, v148
  v_exp_f32 v69, v149
  buffer_load_dwordx4 a[220:223], v12, s[36:39], s22 offen offset:0 sc1
  v_exp_f32 v70, v150
  v_exp_f32 v71, v151
  v_pk_fma_f32 v[72:73], v[64:65], 0.5, 1.0 op_sel_hi:[1,0,0]
  v_pk_fma_f32 v[74:75], v[66:67], 0.5, 1.0 op_sel_hi:[1,0,0]
  v_pk_fma_f32 v[76:77], v[68:69], 0.5, 1.0 op_sel_hi:[1,0,0]
  v_pk_fma_f32 v[78:79], v[70:71], 0.5, 1.0 op_sel_hi:[1,0,0]
  v_pk_fma_f32 v[64:65], v[64:65], v[72:73], 1.0 op_sel_hi:[1,1,0]
  v_pk_fma_f32 v[66:67], v[66:67], v[74:75], 1.0 op_sel_hi:[1,1,0]
  v_pk_fma_f32 v[68:69], v[68:69], v[76:77], 1.0 op_sel_hi:[1,1,0]
  v_pk_fma_f32 v[70:71], v[70:71], v[78:79], 1.0 op_sel_hi:[1,1,0]
  v_rcp_f32 v64, v64
  v_rcp_f32 v65, v65
  v_rcp_f32 v66, v66
  v_rcp_f32 v67, v67
  buffer_load_dwordx4 a[224:227], v12, s[36:39], s22 offen offset:1024 sc1
  v_rcp_f32 v68, v68
  v_rcp_f32 v69, v69
  v_rcp_f32 v70, v70
  v_rcp_f32 v71, v71
  v_pk_fma_f32 v[64:65], v[144:145], v[64:65], v[144:145] neg_lo:[1,0,0] neg_hi:[1,0,0]
  v_pk_fma_f32 v[66:67], v[146:147], v[66:67], v[146:147] neg_lo:[1,0,0] neg_hi:[1,0,0]
  v_pk_fma_f32 v[68:69], v[148:149], v[68:69], v[148:149] neg_lo:[1,0,0] neg_hi:[1,0,0]
  v_pk_fma_f32 v[70:71], v[150:151], v[70:71], v[150:151] neg_lo:[1,0,0] neg_hi:[1,0,0]
  v_cvt_pk_bf16_f32 v144, v64, v65
  v_cvt_pk_bf16_f32 v145, v66, v67
  v_cvt_pk_bf16_f32 v146, v68, v69
  v_cvt_pk_bf16_f32 v147, v70, v71
  buffer_store_dwordx4 v[144:147], v44, s[36:39], s12 offen offset:1024 sc1
  v_pk_mul_f32 v[152:153], v[152:153], v[44:45] op_sel:[0,1] op_sel_hi:[1,1]
  buffer_load_dwordx4 a[228:231], v12, s[36:39], s22 offen offset:2048 sc1
  v_pk_mul_f32 v[154:155], v[154:155], v[44:45] op_sel:[0,1] op_sel_hi:[1,1]
  v_pk_mul_f32 v[156:157], v[156:157], v[44:45] op_sel:[0,1] op_sel_hi:[1,1]
  v_pk_mul_f32 v[158:159], v[158:159], v[44:45] op_sel:[0,1] op_sel_hi:[1,1]
  v_exp_f32 v64, v152
  v_exp_f32 v65, v153
  v_exp_f32 v66, v154
  v_exp_f32 v67, v155
  v_exp_f32 v68, v156
  v_exp_f32 v69, v157
  v_exp_f32 v70, v158
  v_exp_f32 v71, v159
  v_pk_fma_f32 v[72:73], v[64:65], 0.5, 1.0 op_sel_hi:[1,0,0]
  v_pk_fma_f32 v[74:75], v[66:67], 0.5, 1.0 op_sel_hi:[1,0,0]
  v_pk_fma_f32 v[76:77], v[68:69], 0.5, 1.0 op_sel_hi:[1,0,0]
  buffer_load_dwordx4 a[232:235], v12, s[36:39], s22 offen offset:3072 sc1
  v_pk_fma_f32 v[78:79], v[70:71], 0.5, 1.0 op_sel_hi:[1,0,0]
  v_pk_fma_f32 v[64:65], v[64:65], v[72:73], 1.0 op_sel_hi:[1,1,0]
  v_pk_fma_f32 v[66:67], v[66:67], v[74:75], 1.0 op_sel_hi:[1,1,0]
  v_pk_fma_f32 v[68:69], v[68:69], v[76:77], 1.0 op_sel_hi:[1,1,0]
  v_pk_fma_f32 v[70:71], v[70:71], v[78:79], 1.0 op_sel_hi:[1,1,0]
  v_rcp_f32 v64, v64
  v_rcp_f32 v65, v65
  v_rcp_f32 v66, v66
  v_rcp_f32 v67, v67
  v_rcp_f32 v68, v68
  v_rcp_f32 v69, v69
  v_rcp_f32 v70, v70
  v_rcp_f32 v71, v71
  v_pk_fma_f32 v[64:65], v[152:153], v[64:65], v[152:153] neg_lo:[1,0,0] neg_hi:[1,0,0]
  buffer_load_dwordx4 a[236:239], v13, s[36:39], s22 offen offset:0 sc1
  s_add_u32 s22, s8, 122880
  v_pk_fma_f32 v[66:67], v[154:155], v[66:67], v[154:155] neg_lo:[1,0,0] neg_hi:[1,0,0]
  v_pk_fma_f32 v[68:69], v[156:157], v[68:69], v[156:157] neg_lo:[1,0,0] neg_hi:[1,0,0]
  v_pk_fma_f32 v[70:71], v[158:159], v[70:71], v[158:159] neg_lo:[1,0,0] neg_hi:[1,0,0]
  v_cvt_pk_bf16_f32 v152, v64, v65
  v_cvt_pk_bf16_f32 v153, v66, v67
  v_cvt_pk_bf16_f32 v154, v68, v69
  v_cvt_pk_bf16_f32 v155, v70, v71
  buffer_store_dwordx4 v[152:155], v44, s[36:39], s12 offen offset:1536 sc1
  v_pk_mul_f32 v[160:161], v[160:161], v[44:45] op_sel:[0,1] op_sel_hi:[1,1]
  v_pk_mul_f32 v[162:163], v[162:163], v[44:45] op_sel:[0,1] op_sel_hi:[1,1]
  v_pk_mul_f32 v[164:165], v[164:165], v[44:45] op_sel:[0,1] op_sel_hi:[1,1]
  v_pk_mul_f32 v[166:167], v[166:167], v[44:45] op_sel:[0,1] op_sel_hi:[1,1]
  v_exp_f32 v64, v160
  v_exp_f32 v65, v161
  buffer_load_dwordx4 a[80:83], v12, s[36:39], s22 offen offset:0 sc1
  v_exp_f32 v66, v162
  v_exp_f32 v67, v163
  v_exp_f32 v68, v164
  v_exp_f32 v69, v165
  v_exp_f32 v70, v166
  v_exp_f32 v71, v167
  v_pk_fma_f32 v[72:73], v[64:65], 0.5, 1.0 op_sel_hi:[1,0,0]
  v_pk_fma_f32 v[74:75], v[66:67], 0.5, 1.0 op_sel_hi:[1,0,0]
  v_pk_fma_f32 v[76:77], v[68:69], 0.5, 1.0 op_sel_hi:[1,0,0]
  v_pk_fma_f32 v[78:79], v[70:71], 0.5, 1.0 op_sel_hi:[1,0,0]
  v_pk_fma_f32 v[64:65], v[64:65], v[72:73], 1.0 op_sel_hi:[1,1,0]
  v_pk_fma_f32 v[66:67], v[66:67], v[74:75], 1.0 op_sel_hi:[1,1,0]
  v_pk_fma_f32 v[68:69], v[68:69], v[76:77], 1.0 op_sel_hi:[1,1,0]
  v_pk_fma_f32 v[70:71], v[70:71], v[78:79], 1.0 op_sel_hi:[1,1,0]
  buffer_load_dwordx4 a[84:87], v12, s[36:39], s22 offen offset:1024 sc1
  v_rcp_f32 v64, v64
  v_rcp_f32 v65, v65
  v_rcp_f32 v66, v66
  v_rcp_f32 v67, v67
  v_rcp_f32 v68, v68
  v_rcp_f32 v69, v69
  v_rcp_f32 v70, v70
  v_rcp_f32 v71, v71
  v_pk_fma_f32 v[64:65], v[160:161], v[64:65], v[160:161] neg_lo:[1,0,0] neg_hi:[1,0,0]
  v_pk_fma_f32 v[66:67], v[162:163], v[66:67], v[162:163] neg_lo:[1,0,0] neg_hi:[1,0,0]
  v_pk_fma_f32 v[68:69], v[164:165], v[68:69], v[164:165] neg_lo:[1,0,0] neg_hi:[1,0,0]
  v_pk_fma_f32 v[70:71], v[166:167], v[70:71], v[166:167] neg_lo:[1,0,0] neg_hi:[1,0,0]
  v_cvt_pk_bf16_f32 v160, v64, v65
  v_cvt_pk_bf16_f32 v161, v66, v67
  buffer_load_dwordx4 a[88:91], v12, s[36:39], s22 offen offset:2048 sc1
  v_cvt_pk_bf16_f32 v162, v68, v69
  v_cvt_pk_bf16_f32 v163, v70, v71
  buffer_store_dwordx4 v[160:163], v44, s[36:39], s13 offen offset:0 sc1
  v_pk_mul_f32 v[168:169], v[168:169], v[44:45] op_sel:[0,1] op_sel_hi:[1,1]
  v_pk_mul_f32 v[170:171], v[170:171], v[44:45] op_sel:[0,1] op_sel_hi:[1,1]
  v_pk_mul_f32 v[172:173], v[172:173], v[44:45] op_sel:[0,1] op_sel_hi:[1,1]
  v_pk_mul_f32 v[174:175], v[174:175], v[44:45] op_sel:[0,1] op_sel_hi:[1,1]
  v_exp_f32 v64, v168
  v_exp_f32 v65, v169
  v_exp_f32 v66, v170
  v_exp_f32 v67, v171
  v_exp_f32 v68, v172
  v_exp_f32 v69, v173
  v_exp_f32 v70, v174
  buffer_load_dwordx4 a[92:95], v12, s[36:39], s22 offen offset:3072 sc1
  v_exp_f32 v71, v175
  v_pk_fma_f32 v[72:73], v[64:65], 0.5, 1.0 op_sel_hi:[1,0,0]
  v_pk_fma_f32 v[74:75], v[66:67], 0.5, 1.0 op_sel_hi:[1,0,0]
  v_pk_fma_f32 v[76:77], v[68:69], 0.5, 1.0 op_sel_hi:[1,0,0]
  v_pk_fma_f32 v[78:79], v[70:71], 0.5, 1.0 op_sel_hi:[1,0,0]
  v_pk_fma_f32 v[64:65], v[64:65], v[72:73], 1.0 op_sel_hi:[1,1,0]
  v_pk_fma_f32 v[66:67], v[66:67], v[74:75], 1.0 op_sel_hi:[1,1,0]
  v_pk_fma_f32 v[68:69], v[68:69], v[76:77], 1.0 op_sel_hi:[1,1,0]
  v_pk_fma_f32 v[70:71], v[70:71], v[78:79], 1.0 op_sel_hi:[1,1,0]
  v_rcp_f32 v64, v64
  v_rcp_f32 v65, v65
  v_rcp_f32 v66, v66
  v_rcp_f32 v67, v67
  v_rcp_f32 v68, v68
  buffer_load_dwordx4 a[96:99], v13, s[36:39], s22 offen offset:0 sc1
  v_rcp_f32 v69, v69
  v_rcp_f32 v70, v70
  v_rcp_f32 v71, v71
  v_pk_fma_f32 v[64:65], v[168:169], v[64:65], v[168:169] neg_lo:[1,0,0] neg_hi:[1,0,0]
  v_pk_fma_f32 v[66:67], v[170:171], v[66:67], v[170:171] neg_lo:[1,0,0] neg_hi:[1,0,0]
  v_pk_fma_f32 v[68:69], v[172:173], v[68:69], v[172:173] neg_lo:[1,0,0] neg_hi:[1,0,0]
  v_pk_fma_f32 v[70:71], v[174:175], v[70:71], v[174:175] neg_lo:[1,0,0] neg_hi:[1,0,0]
  v_cvt_pk_bf16_f32 v168, v64, v65
  v_cvt_pk_bf16_f32 v169, v66, v67
  v_cvt_pk_bf16_f32 v170, v68, v69
  v_cvt_pk_bf16_f32 v171, v70, v71
  buffer_store_dwordx4 v[168:171], v44, s[36:39], s13 offen offset:512 sc1
f_q9:
  v_pk_mul_f32 v[176:177], v[176:177], v[44:45] op_sel:[0,1] op_sel_hi:[1,1]
  v_pk_mul_f32 v[178:179], v[178:179], v[44:45] op_sel:[0,1] op_sel_hi:[1,1]
  v_pk_mul_f32 v[180:181], v[180:181], v[44:45] op_sel:[0,1] op_sel_hi:[1,1]
  v_pk_mul_f32 v[182:183], v[182:183], v[44:45] op_sel:[0,1] op_sel_hi:[1,1]
  v_exp_f32 v64, v176
  v_exp_f32 v65, v177
  v_exp_f32 v66, v178
  v_exp_f32 v67, v179
  v_exp_f32 v68, v180
  v_exp_f32 v69, v181
  v_exp_f32 v70, v182
  v_exp_f32 v71, v183
  v_pk_fma_f32 v[72:73], v[64:65], 0.5, 1.0 op_sel_hi:[1,0,0]
  v_pk_fma_f32 v[74:75], v[66:67], 0.5, 1.0 op_sel_hi:[1,0,0]
  s_add_u32 s22, s8, 143360
  buffer_load_dwordx4 a[100:103], v12, s[36:39], s22 offen offset:0 sc1
  v_pk_fma_f32 v[76:77], v[68:69], 0.5, 1.0 op_sel_hi:[1,0,0]
  v_pk_fma_f32 v[78:79], v[70:71], 0.5, 1.0 op_sel_hi:[1,0,0]
  v_pk_fma_f32 v[64:65], v[64:65], v[72:73], 1.0 op_sel_hi:[1,1,0]
  v_pk_fma_f32 v[66:67], v[66:67], v[74:75], 1.0 op_sel_hi:[1,1,0]
  v_pk_fma_f32 v[68:69], v[68:69], v[76:77], 1.0 op_sel_hi:[1,1,0]
  v_pk_fma_f32 v[70:71], v[70:71], v[78:79], 1.0 op_sel_hi:[1,1,0]
  v_rcp_f32 v64, v64
  v_rcp_f32 v65, v65
  v_rcp_f32 v66, v66
  v_rcp_f32 v67, v67
  v_rcp_f32 v68, v68
  v_rcp_f32 v69, v69
  v_rcp_f32 v70, v70
  v_rcp_f32 v71, v71
  buffer_load_dwordx4 a[104:107], v12, s[36:39], s22 offen offset:1024 sc1
  v_pk_fma_f32 v[64:65], v[176:177], v[64:65], v[176:177] neg_lo:[1,0,0] neg_hi:[1,0,0]
  v_pk_fma_f32 v[66:67], v[178:179], v[66:67], v[178:179] neg_lo:[1,0,0] neg_hi:[1,0,0]
  v_pk_fma_f32 v[68:69], v[180:181], v[68:69], v[180:181] neg_lo:[1,0,0] neg_hi:[1,0,0]
  v_pk_fma_f32 v[70:71], v[182:183], v[70:71], v[182:183] neg_lo:[1,0,0] neg_hi:[1,0,0]
  v_cvt_pk_bf16_f32 v176, v64, v65
  v_cvt_pk_bf16_f32 v177, v66, v67
  v_cvt_pk_bf16_f32 v178, v68, v69
  v_cvt_pk_bf16_f32 v179, v70, v71
  buffer_store_dwordx4 v[176:179], v44, s[36:39], s13 offen offset:1024 sc1
  v_pk_mul_f32 v[184:185], v[184:185], v[44:45] op_sel:[0,1] op_sel_hi:[1,1]
  v_pk_mul_f32 v[186:187], v[186:187], v[44:45] op_sel:[0,1] op_sel_hi:[1,1]
  v_pk_mul_f32 v[188:189], v[188:189], v[44:45] op_sel:[0,1] op_sel_hi:[1,1]
  v_pk_mul_f32 v[190:191], v[190:191], v[44:45] op_sel:[0,1] op_sel_hi:[1,1]
  v_exp_f32 v64, v184
  buffer_load_dwordx4 a[108:111], v12, s[36:39], s22 offen offset:2048 sc1
  v_exp_f32 v65, v185
  v_exp_f32 v66, v186
  v_exp_f32 v67, v187
  v_exp_f32 v68, v188
  v_exp_f32 v69, v189
  v_exp_f32 v70, v190
  v_exp_f32 v71, v191
  v_pk_fma_f32 v[72:73], v[64:65], 0.5, 1.0 op_sel_hi:[1,0,0]
  v_pk_fma_f32 v[74:75], v[66:67], 0.5, 1.0 op_sel_hi:[1,0,0]
  v_pk_fma_f32 v[76:77], v[68:69], 0.5, 1.0 op_sel_hi:[1,0,0]
  v_pk_fma_f32 v[78:79], v[70:71], 0.5, 1.0 op_sel_hi:[1,0,0]
  v_pk_fma_f32 v[64:65], v[64:65], v[72:73], 1.0 op_sel_hi:[1,1,0]
  v_pk_fma_f32 v[66:67], v[66:67], v[74:75], 1.0 op_sel_hi:[1,1,0]
  v_pk_fma_f32 v[68:69], v[68:69], v[76:77], 1.0 op_sel_hi:[1,1,0]
  buffer_load_dwordx4 a[112:115], v12, s[36:39], s22 offen offset:3072 sc1
  v_pk_fma_f32 v[70:71], v[70:71], v[78:79], 1.0 op_sel_hi:[1,1,0]
  v_rcp_f32 v64, v64
  v_rcp_f32 v65, v65
  v_rcp_f32 v66, v66
  v_rcp_f32 v67, v67
  v_rcp_f32 v68, v68
  v_rcp_f32 v69, v69
  v_rcp_f32 v70, v70
  v_rcp_f32 v71, v71
  v_pk_fma_f32 v[64:65], v[184:185], v[64:65], v[184:185] neg_lo:[1,0,0] neg_hi:[1,0,0]
  v_pk_fma_f32 v[66:67], v[186:187], v[66:67], v[186:187] neg_lo:[1,0,0] neg_hi:[1,0,0]
  v_pk_fma_f32 v[68:69], v[188:189], v[68:69], v[188:189] neg_lo:[1,0,0] neg_hi:[1,0,0]
  v_pk_fma_f32 v[70:71], v[190:191], v[70:71], v[190:191] neg_lo:[1,0,0] neg_hi:[1,0,0]
  v_cvt_pk_bf16_f32 v184, v64, v65
  buffer_load_dwordx4 a[116:119], v13, s[36:39], s22 offen offset:0 sc1
  s_add_u32 s22, s8, 163840
  v_cvt_pk_bf16_f32 v185, v66, v67
  v_cvt_pk_bf16_f32 v186, v68, v69
  v_cvt_pk_bf16_f32 v187, v70, v71
  buffer_store_dwordx4 v[184:187], v44, s[36:39], s13 offen offset:1536 sc1
  buffer_load_dword v10, v11, s[36:39], 0 offen sc1
  v_pk_mul_f32 v[192:193], v[192:193], v[44:45] op_sel:[0,1] op_sel_hi:[1,1]
  v_pk_mul_f32 v[194:195], v[194:195], v[44:45] op_sel:[0,1] op_sel_hi:[1,1]
  v_pk_mul_f32 v[196:197], v[196:197], v[44:45] op_sel:[0,1] op_sel_hi:[1,1]
  v_pk_mul_f32 v[198:199], v[198:199], v[44:45] op_sel:[0,1] op_sel_hi:[1,1]
  v_exp_f32 v64, v192
  v_exp_f32 v65, v193
  v_exp_f32 v66, v194
  v_exp_f32 v67, v195
  v_exp_f32 v68, v196
  buffer_load_dwordx4 a[120:123], v12, s[36:39], s22 offen offset:0 sc1
  v_exp_f32 v69, v197
  v_exp_f32 v70, v198
  v_exp_f32 v71, v199
  v_pk_fma_f32 v[72:73], v[64:65], 0.5, 1.0 op_sel_hi:[1,0,0]
  v_pk_fma_f32 v[74:75], v[66:67], 0.5, 1.0 op_sel_hi:[1,0,0]
  v_pk_fma_f32 v[76:77], v[68:69], 0.5, 1.0 op_sel_hi:[1,0,0]
  v_pk_fma_f32 v[78:79], v[70:71], 0.5, 1.0 op_sel_hi:[1,0,0]
  v_pk_fma_f32 v[64:65], v[64:65], v[72:73], 1.0 op_sel_hi:[1,1,0]
  v_pk_fma_f32 v[66:67], v[66:67], v[74:75], 1.0 op_sel_hi:[1,1,0]
  v_pk_fma_f32 v[68:69], v[68:69], v[76:77], 1.0 op_sel_hi:[1,1,0]
  v_pk_fma_f32 v[70:71], v[70:71], v[78:79], 1.0 op_sel_hi:[1,1,0]
  v_rcp_f32 v64, v64
  v_rcp_f32 v65, v65
  v_rcp_f32 v66, v66
  buffer_load_dwordx4 a[124:127], v12, s[36:39], s22 offen offset:1024 sc1
  v_rcp_f32 v67, v67
  v_rcp_f32 v68, v68
  v_rcp_f32 v69, v69
  v_rcp_f32 v70, v70
  v_rcp_f32 v71, v71
  v_pk_fma_f32 v[64:65], v[192:193], v[64:65], v[192:193] neg_lo:[1,0,0] neg_hi:[1,0,0]
  v_pk_fma_f32 v[66:67], v[194:195], v[66:67], v[194:195] neg_lo:[1,0,0] neg_hi:[1,0,0]
  v_pk_fma_f32 v[68:69], v[196:197], v[68:69], v[196:197] neg_lo:[1,0,0] neg_hi:[1,0,0]
  v_pk_fma_f32 v[70:71], v[198:199], v[70:71], v[198:199] neg_lo:[1,0,0] neg_hi:[1,0,0]
  v_cvt_pk_bf16_f32 v192, v64, v65
  v_cvt_pk_bf16_f32 v193, v66, v67
  v_cvt_pk_bf16_f32 v194, v68, v69
  v_cvt_pk_bf16_f32 v195, v70, v71
  buffer_store_dwordx4 v[192:195], v44, s[36:39], s16 offen offset:0 sc1
  buffer_load_dwordx4 a[128:131], v12, s[36:39], s22 offen offset:2048 sc1
  v_pk_mul_f32 v[200:201], v[200:201], v[44:45] op_sel:[0,1] op_sel_hi:[1,1]
  v_pk_mul_f32 v[202:203], v[202:203], v[44:45] op_sel:[0,1] op_sel_hi:[1,1]
  v_pk_mul_f32 v[204:205], v[204:205], v[44:45] op_sel:[0,1] op_sel_hi:[1,1]
  v_pk_mul_f32 v[206:207], v[206:207], v[44:45] op_sel:[0,1] op_sel_hi:[1,1]
  v_exp_f32 v64, v200
  v_exp_f32 v65, v201
  v_exp_f32 v66, v202
  v_exp_f32 v67, v203
  v_exp_f32 v68, v204
  v_exp_f32 v69, v205
  v_exp_f32 v70, v206
  v_exp_f32 v71, v207
  v_pk_fma_f32 v[72:73], v[64:65], 0.5, 1.0 op_sel_hi:[1,0,0]
  v_pk_fma_f32 v[74:75], v[66:67], 0.5, 1.0 op_sel_hi:[1,0,0]
  buffer_load_dwordx4 a[132:135], v12, s[36:39], s22 offen offset:3072 sc1
  v_pk_fma_f32 v[76:77], v[68:69], 0.5, 1.0 op_sel_hi:[1,0,0]
  v_pk_fma_f32 v[78:79], v[70:71], 0.5, 1.0 op_sel_hi:[1,0,0]
  v_pk_fma_f32 v[64:65], v[64:65], v[72:73], 1.0 op_sel_hi:[1,1,0]
  v_pk_fma_f32 v[66:67], v[66:67], v[74:75], 1.0 op_sel_hi:[1,1,0]
  v_pk_fma_f32 v[68:69], v[68:69], v[76:77], 1.0 op_sel_hi:[1,1,0]
  v_pk_fma_f32 v[70:71], v[70:71], v[78:79], 1.0 op_sel_hi:[1,1,0]
  v_rcp_f32 v64, v64
  v_rcp_f32 v65, v65
  v_rcp_f32 v66, v66
  v_rcp_f32 v67, v67
  v_rcp_f32 v68, v68
  v_rcp_f32 v69, v69
  v_rcp_f32 v70, v70
  v_rcp_f32 v71, v71
  buffer_load_dwordx4 a[136:139], v13, s[36:39], s22 offen offset:0 sc1
  v_pk_fma_f32 v[64:65], v[200:201], v[64:65], v[200:201] neg_lo:[1,0,0] neg_hi:[1,0,0]
  v_pk_fma_f32 v[66:67], v[202:203], v[66:67], v[202:203] neg_lo:[1,0,0] neg_hi:[1,0,0]
  v_pk_fma_f32 v[68:69], v[204:205], v[68:69], v[204:205] neg_lo:[1,0,0] neg_hi:[1,0,0]
  v_pk_fma_f32 v[70:71], v[206:207], v[70:71], v[206:207] neg_lo:[1,0,0] neg_hi:[1,0,0]
  v_cvt_pk_bf16_f32 v200, v64, v65
  v_cvt_pk_bf16_f32 v201, v66, v67
  v_cvt_pk_bf16_f32 v202, v68, v69
  v_cvt_pk_bf16_f32 v203, v70, v71
  buffer_store_dwordx4 v[200:203], v44, s[36:39], s16 offen offset:512 sc1
  s_waitcnt vmcnt(8)
  s_barrier
  s_add_u32 s18, s64, 3
  v_mov_b32 v14, s18
  buffer_store_dword v14, v9, s[36:39], 0 offen sc1
  v_pk_mul_f32 v[208:209], v[208:209], v[44:45] op_sel:[0,1] op_sel_hi:[1,1]
  v_pk_mul_f32 v[210:211], v[210:211], v[44:45] op_sel:[0,1] op_sel_hi:[1,1]
  v_pk_mul_f32 v[212:213], v[212:213], v[44:45] op_sel:[0,1] op_sel_hi:[1,1]
  v_pk_mul_f32 v[214:215], v[214:215], v[44:45] op_sel:[0,1] op_sel_hi:[1,1]
  v_exp_f32 v64, v208
  v_exp_f32 v65, v209
  v_exp_f32 v66, v210
  v_exp_f32 v67, v211
  v_exp_f32 v68, v212
  v_exp_f32 v69, v213
  v_exp_f32 v70, v214
  v_exp_f32 v71, v215
  v_pk_fma_f32 v[72:73], v[64:65], 0.5, 1.0 op_sel_hi:[1,0,0]
  v_pk_fma_f32 v[74:75], v[66:67], 0.5, 1.0 op_sel_hi:[1,0,0]
  s_add_u32 s22, s8, 184320
  buffer_load_dwordx4 a[140:143], v12, s[36:39], s22 offen offset:0 sc1
  v_pk_fma_f32 v[76:77], v[68:69], 0.5, 1.0 op_sel_hi:[1,0,0]
  v_pk_fma_f32 v[78:79], v[70:71], 0.5, 1.0 op_sel_hi:[1,0,0]
  v_pk_fma_f32 v[64:65], v[64:65], v[72:73], 1.0 op_sel_hi:[1,1,0]
  v_pk_fma_f32 v[66:67], v[66:67], v[74:75], 1.0 op_sel_hi:[1,1,0]
  v_pk_fma_f32 v[68:69], v[68:69], v[76:77], 1.0 op_sel_hi:[1,1,0]
  v_pk_fma_f32 v[70:71], v[70:71], v[78:79], 1.0 op_sel_hi:[1,1,0]
  v_rcp_f32 v64, v64
  v_rcp_f32 v65, v65
  v_rcp_f32 v66, v66
  v_rcp_f32 v67, v67
  v_rcp_f32 v68, v68
  v_rcp_f32 v69, v69
  v_rcp_f32 v70, v70
  v_rcp_f32 v71, v71
  buffer_load_dwordx4 a[144:147], v12, s[36:39], s22 offen offset:1024 sc1
  v_pk_fma_f32 v[64:65], v[208:209], v[64:65], v[208:209] neg_lo:[1,0,0] neg_hi:[1,0,0]
  v_pk_fma_f32 v[66:67], v[210:211], v[66:67], v[210:211] neg_lo:[1,0,0] neg_hi:[1,0,0]
  v_pk_fma_f32 v[68:69], v[212:213], v[68:69], v[212:213] neg_lo:[1,0,0] neg_hi:[1,0,0]
  v_pk_fma_f32 v[70:71], v[214:215], v[70:71], v[214:215] neg_lo:[1,0,0] neg_hi:[1,0,0]
  v_cvt_pk_bf16_f32 v208, v64, v65
  v_cvt_pk_bf16_f32 v209, v66, v67
  v_cvt_pk_bf16_f32 v210, v68, v69
  v_cvt_pk_bf16_f32 v211, v70, v71
  buffer_store_dwordx4 v[208:211], v44, s[36:39], s16 offen offset:1024 sc1
  v_pk_mul_f32 v[216:217], v[216:217], v[44:45] op_sel:[0,1] op_sel_hi:[1,1]
  v_pk_mul_f32 v[218:219], v[218:219], v[44:45] op_sel:[0,1] op_sel_hi:[1,1]
  v_pk_mul_f32 v[220:221], v[220:221], v[44:45] op_sel:[0,1] op_sel_hi:[1,1]
  v_pk_mul_f32 v[222:223], v[222:223], v[44:45] op_sel:[0,1] op_sel_hi:[1,1]
  v_exp_f32 v64, v216
  buffer_load_dwordx4 a[148:151], v12, s[36:39], s22 offen offset:2048 sc1
  v_exp_f32 v65, v217
  v_exp_f32 v66, v218
  v_exp_f32 v67, v219
  v_exp_f32 v68, v220
  v_exp_f32 v69, v221
  v_exp_f32 v70, v222
  v_exp_f32 v71, v223
  v_pk_fma_f32 v[72:73], v[64:65], 0.5, 1.0 op_sel_hi:[1,0,0]
  v_pk_fma_f32 v[74:75], v[66:67], 0.5, 1.0 op_sel_hi:[1,0,0]
  v_pk_fma_f32 v[76:77], v[68:69], 0.5, 1.0 op_sel_hi:[1,0,0]
  v_pk_fma_f32 v[78:79], v[70:71], 0.5, 1.0 op_sel_hi:[1,0,0]
  v_pk_fma_f32 v[64:65], v[64:65], v[72:73], 1.0 op_sel_hi:[1,1,0]
  v_pk_fma_f32 v[66:67], v[66:67], v[74:75], 1.0 op_sel_hi:[1,1,0]
  v_pk_fma_f32 v[68:69], v[68:69], v[76:77], 1.0 op_sel_hi:[1,1,0]
  buffer_load_dwordx4 a[152:155], v12, s[36:39], s22 offen offset:3072 sc1
  v_pk_fma_f32 v[70:71], v[70:71], v[78:79], 1.0 op_sel_hi:[1,1,0]
  v_rcp_f32 v64, v64
  v_rcp_f32 v65, v65
  v_rcp_f32 v66, v66
  v_rcp_f32 v67, v67
  v_rcp_f32 v68, v68
  v_rcp_f32 v69, v69
  v_rcp_f32 v70, v70
  v_rcp_f32 v71, v71
  v_pk_fma_f32 v[64:65], v[216:217], v[64:65], v[216:217] neg_lo:[1,0,0] neg_hi:[1,0,0]
  v_pk_fma_f32 v[66:67], v[218:219], v[66:67], v[218:219] neg_lo:[1,0,0] neg_hi:[1,0,0]
  v_pk_fma_f32 v[68:69], v[220:221], v[68:69], v[220:221] neg_lo:[1,0,0] neg_hi:[1,0,0]
  v_pk_fma_f32 v[70:71], v[222:223], v[70:71], v[222:223] neg_lo:[1,0,0] neg_hi:[1,0,0]
  v_cvt_pk_bf16_f32 v216, v64, v65
  buffer_load_dwordx4 a[156:159], v13, s[36:39], s22 offen offset:0 sc1
  v_cvt_pk_bf16_f32 v217, v66, v67
  v_cvt_pk_bf16_f32 v218, v68, v69
  v_cvt_pk_bf16_f32 v219, v70, v71
  buffer_store_dwordx4 v[216:219], v44, s[36:39], s16 offen offset:1536 sc1
  s_add_u32 s18, s64, 2
  s_waitcnt vmcnt(15)
  v_subrev_u32 v14, s18, v10
  v_cmp_gt_u32_e64 s[100:101], 8, v14
  s_nop 0
  s_cmp_eq_u64 s[100:101], -1
  s_cbranch_scc0 f_spin4
f_back4:
  s_mul_i32 s18, s3, 96256
  s_add_u32 s18, s18, s9
  s_add_u32 s18, s18, 75776
  buffer_load_dwordx4 v[84:87], v20, s[36:39], s18 offen sc1
  buffer_load_dwordx4 v[88:91], v20, s[36:39], s18 offen offset:256 sc1
  buffer_load_dwordx2 v[92:93], v21, s[36:39], s18 offen offset:512 sc1
  s_lshl_b32 s18, s62, 2
  s_add_u32 s18, s18, s3
  s_lshl_b32 s18, s18, 7
  s_add_u32 s18, s18, 15859712
  buffer_load_dwordx2 v[96:97], v22, s[36:39], s18 offen sc1
  s_cmp_lt_u32 s61, 2
  s_cbranch_scc1 f_h3
  s_cmp_lt_u32 s61, 5
  s_cbranch_scc1 f_h4
  v_pk_mul_f32 v[240:241], v[240:241], v[44:45] op_sel:[0,1] op_sel_hi:[1,1]
  v_pk_mul_f32 v[242:243], v[242:243], v[44:45] op_sel:[0,1] op_sel_hi:[1,1]
  v_pk_mul_f32 v[244:245], v[244:245], v[44:45] op_sel:[0,1] op_sel_hi:[1,1]
  v_pk_mul_f32 v[246:247], v[246:247], v[44:45] op_sel:[0,1] op_sel_hi:[1,1]
  v_exp_f32 v64, v240
  v_exp_f32 v65, v241
  v_exp_f32 v66, v242
  s_add_u32 s22, s8, 204800
  buffer_load_dwordx4 a[160:163], v12, s[36:39], s22 offen offset:0 sc1
  v_exp_f32 v67, v243
  v_exp_f32 v68, v244
  v_exp_f32 v69, v245
  v_exp_f32 v70, v246
  v_exp_f32 v71, v247
  v_pk_fma_f32 v[72:73], v[64:65], 0.5, 1.0 op_sel_hi:[1,0,0]
  v_pk_fma_f32 v[74:75], v[66:67], 0.5, 1.0 op_sel_hi:[1,0,0]
  buffer_load_dwordx4 a[164:167], v12, s[36:39], s22 offen offset:1024 sc1
  v_pk_fma_f32 v[76:77], v[68:69], 0.5, 1.0 op_sel_hi:[1,0,0]
  v_pk_fma_f32 v[78:79], v[70:71], 0.5, 1.0 op_sel_hi:[1,0,0]
  v_pk_fma_f32 v[64:65], v[64:65], v[72:73], 1.0 op_sel_hi:[1,1,0]
  v_pk_fma_f32 v[66:67], v[66:67], v[74:75], 1.0 op_sel_hi:[1,1,0]
  v_pk_fma_f32 v[68:69], v[68:69], v[76:77], 1.0 op_sel_hi:[1,1,0]
  v_pk_fma_f32 v[70:71], v[70:71], v[78:79], 1.0 op_sel_hi:[1,1,0]
  v_rcp_f32 v64, v64
  buffer_load_dwordx4 a[168:171], v12, s[36:39], s22 offen offset:2048 sc1
  v_rcp_f32 v65, v65
  v_rcp_f32 v66, v66
  v_rcp_f32 v67, v67
  v_rcp_f32 v68, v68
  v_rcp_f32 v69, v69
  v_rcp_f32 v70, v70
  v_rcp_f32 v71, v71
  buffer_load_dwordx4 a[172:175], v12, s[36:39], s22 offen offset:3072 sc1
  v_pk_fma_f32 v[64:65], v[240:241], v[64:65], v[240:241] neg_lo:[1,0,0] neg_hi:[1,0,0]
  v_pk_fma_f32 v[66:67], v[242:243], v[66:67], v[242:243] neg_lo:[1,0,0] neg_hi:[1,0,0]
  v_pk_fma_f32 v[68:69], v[244:245], v[68:69], v[244:245] neg_lo:[1,0,0] neg_hi:[1,0,0]
  v_pk_fma_f32 v[70:71], v[246:247], v[70:71], v[246:247] neg_lo:[1,0,0] neg_hi:[1,0,0]
  v_cvt_pk_bf16_f32 v240, v64, v65
  v_cvt_pk_bf16_f32 v241, v66, v67
  v_cvt_pk_bf16_f32 v242, v68, v69
  buffer_load_dwordx4 a[176:179], v13, s[36:39], s22 offen offset:0 sc1
  s_add_u32 s22, s8, 225280
  v_cvt_pk_bf16_f32 v243, v70, v71
  buffer_store_dwordx4 v[240:243], v44, s[36:39], s17 offen offset:1024 sc1
  v_pk_mul_f32 v[248:249], v[248:249], v[44:45] op_sel:[0,1] op_sel_hi:[1,1]
  v_pk_mul_f32 v[250:251], v[250:251], v[44:45] op_sel:[0,1] op_sel_hi:[1,1]
  v_pk_mul_f32 v[252:253], v[252:253], v[44:45] op_sel:[0,1] op_sel_hi:[1,1]
  v_pk_mul_f32 v[254:255], v[254:255], v[44:45] op_sel:[0,1] op_sel_hi:[1,1]
  v_exp_f32 v64, v248
  buffer_load_dwordx4 a[180:183], v12, s[36:39], s22 offen offset:0 sc1
  v_exp_f32 v65, v249
  v_exp_f32 v66, v250
  v_exp_f32 v67, v251
  v_exp_f32 v68, v252
  v_exp_f32 v69, v253
  v_exp_f32 v70, v254
  v_exp_f32 v71, v255
  buffer_load_dwordx4 a[184:187], v12, s[36:39], s22 offen offset:1024 sc1
  v_pk_fma_f32 v[72:73], v[64:65], 0.5, 1.0 op_sel_hi:[1,0,0]
  v_pk_fma_f32 v[74:75], v[66:67], 0.5, 1.0 op_sel_hi:[1,0,0]
  v_pk_fma_f32 v[76:77], v[68:69], 0.5, 1.0 op_sel_hi:[1,0,0]
  v_pk_fma_f32 v[78:79], v[70:71], 0.5, 1.0 op_sel_hi:[1,0,0]
  v_pk_fma_f32 v[64:65], v[64:65], v[72:73], 1.0 op_sel_hi:[1,1,0]
  v_pk_fma_f32 v[66:67], v[66:67], v[74:75], 1.0 op_sel_hi:[1,1,0]
  v_pk_fma_f32 v[68:69], v[68:69], v[76:77], 1.0 op_sel_hi:[1,1,0]
  buffer_load_dwordx4 a[188:191], v12, s[36:39], s22 offen offset:2048 sc1
  v_pk_fma_f32 v[70:71], v[70:71], v[78:79], 1.0 op_sel_hi:[1,1,0]
  v_rcp_f32 v64, v64
  v_rcp_f32 v65, v65
  v_rcp_f32 v66, v66
  v_rcp_f32 v67, v67
  v_rcp_f32 v68, v68
  v_rcp_f32 v69, v69
  buffer_load_dwordx4 a[192:195], v12, s[36:39], s22 offen offset:3072 sc1
  v_rcp_f32 v70, v70
  v_rcp_f32 v71, v71
  v_pk_fma_f32 v[64:65], v[248:249], v[64:65], v[248:249] neg_lo:[1,0,0] neg_hi:[1,0,0]
  v_pk_fma_f32 v[66:67], v[250:251], v[66:67], v[250:251] neg_lo:[1,0,0] neg_hi:[1,0,0]
  v_pk_fma_f32 v[68:69], v[252:253], v[68:69], v[252:253] neg_lo:[1,0,0] neg_hi:[1,0,0]
  v_pk_fma_f32 v[70:71], v[254:255], v[70:71], v[254:255] neg_lo:[1,0,0] neg_hi:[1,0,0]
  v_cvt_pk_bf16_f32 v248, v64, v65
  buffer_load_dwordx4 a[196:199], v13, s[36:39], s22 offen offset:0 sc1
  v_cvt_pk_bf16_f32 v249, v66, v67
  v_cvt_pk_bf16_f32 v250, v68, v69
  v_cvt_pk_bf16_f32 v251, v70, v71
  buffer_store_dwordx4 v[248:251], v44, s[36:39], s17 offen offset:1536 sc1
  s_branch f_h9
f_h4:
  v_pk_mul_f32 v[224:225], v[224:225], v[44:45] op_sel:[0,1] op_sel_hi:[1,1]
  v_pk_mul_f32 v[226:227], v[226:227], v[44:45] op_sel:[0,1] op_sel_hi:[1,1]
  v_pk_mul_f32 v[228:229], v[228:229], v[44:45] op_sel:[0,1] op_sel_hi:[1,1]
  v_pk_mul_f32 v[230:231], v[230:231], v[44:45] op_sel:[0,1] op_sel_hi:[1,1]
  v_exp_f32 v64, v224
  v_exp_f32 v65, v225
  v_exp_f32 v66, v226
  s_add_u32 s22, s8, 204800
  buffer_load_dwordx4 a[160:163], v12, s[36:39], s22 offen offset:0 sc1
  v_exp_f32 v67, v227
  v_exp_f32 v68, v228
  v_exp_f32 v69, v229
  v_exp_f32 v70, v230
  v_exp_f32 v71, v231
  v_pk_fma_f32 v[72:73], v[64:65], 0.5, 1.0 op_sel_hi:[1,0,0]
  v_pk_fma_f32 v[74:75], v[66:67], 0.5, 1.0 op_sel_hi:[1,0,0]
  buffer_load_dwordx4 a[164:167], v12, s[36:39], s22 offen offset:1024 sc1
  v_pk_fma_f32 v[76:77], v[68:69], 0.5, 1.0 op_sel_hi:[1,0,0]
  v_pk_fma_f32 v[78:79], v[70:71], 0.5, 1.0 op_sel_hi:[1,0,0]
  v_pk_fma_f32 v[64:65], v[64:65], v[72:73], 1.0 op_sel_hi:[1,1,0]
  v_pk_fma_f32 v[66:67], v[66:67], v[74:75], 1.0 op_sel_hi:[1,1,0]
  v_pk_fma_f32 v[68:69], v[68:69], v[76:77], 1.0 op_sel_hi:[1,1,0]
  v_pk_fma_f32 v[70:71], v[70:71], v[78:79], 1.0 op_sel_hi:[1,1,0]
  v_rcp_f32 v64, v64
  buffer_load_dwordx4 a[168:171], v12, s[36:39], s22 offen offset:2048 sc1
  v_rcp_f32 v65, v65
  v_rcp_f32 v66, v66
  v_rcp_f32 v67, v67
  v_rcp_f32 v68, v68
  v_rcp_f32 v69, v69
  v_rcp_f32 v70, v70
  v_rcp_f32 v71, v71
  buffer_load_dwordx4 a[172:175], v12, s[36:39], s22 offen offset:3072 sc1
  v_pk_fma_f32 v[64:65], v[224:225], v[64:65], v[224:225] neg_lo:[1,0,0] neg_hi:[1,0,0]
  v_pk_fma_f32 v[66:67], v[226:227], v[66:67], v[226:227] neg_lo:[1,0,0] neg_hi:[1,0,0]
  v_pk_fma_f32 v[68:69], v[228:229], v[68:69], v[228:229] neg_lo:[1,0,0] neg_hi:[1,0,0]
  v_pk_fma_f32 v[70:71], v[230:231], v[70:71], v[230:231] neg_lo:[1,0,0] neg_hi:[1,0,0]
  v_cvt_pk_bf16_f32 v224, v64, v65
  v_cvt_pk_bf16_f32 v225, v66, v67
  v_cvt_pk_bf16_f32 v226, v68, v69
  buffer_load_dwordx4 a[176:179], v13, s[36:39], s22 offen offset:0 sc1
  s_add_u32 s22, s8, 225280
  v_cvt_pk_bf16_f32 v227, v70, v71
  buffer_store_dwordx4 v[224:227], v44, s[36:39], s17 offen offset:0 sc1
  v_pk_mul_f32 v[232:233], v[232:233], v[44:45] op_sel:[0,1] op_sel_hi:[1,1]
  v_pk_mul_f32 v[234:235], v[234:235], v[44:45] op_sel:[0,1] op_sel_hi:[1,1]
  v_pk_mul_f32 v[236:237], v[236:237], v[44:45] op_sel:[0,1] op_sel_hi:[1,1]
  v_pk_mul_f32 v[238:239], v[238:239], v[44:45] op_sel:[0,1] op_sel_hi:[1,1]
  v_exp_f32 v64, v232
  buffer_load_dwordx4 a[180:183], v12, s[36:39], s22 offen offset:0 sc1
  v_exp_f32 v65, v233
  v_exp_f32 v66, v234
  v_exp_f32 v67, v235
  v_exp_f32 v68, v236
  v_exp_f32 v69, v237
  v_exp_f32 v70, v238
  v_exp_f32 v71, v239
  buffer_load_dwordx4 a[184:187], v12, s[36:39], s22 offen offset:1024 sc1
  v_pk_fma_f32 v[72:73], v[64:65], 0.5, 1.0 op_sel_hi:[1,0,0]
  v_pk_fma_f32 v[74:75], v[66:67], 0.5, 1.0 op_sel_hi:[1,0,0]
  v_pk_fma_f32 v[76:77], v[68:69], 0.5, 1.0 op_sel_hi:[1,0,0]
  v_pk_fma_f32 v[78:79], v[70:71], 0.5, 1.0 op_sel_hi:[1,0,0]
  v_pk_fma_f32 v[64:65], v[64:65], v[72:73], 1.0 op_sel_hi:[1,1,0]
  v_pk_fma_f32 v[66:67], v[66:67], v[74:75], 1.0 op_sel_hi:[1,1,0]
  v_pk_fma_f32 v[68:69], v[68:69], v[76:77], 1.0 op_sel_hi:[1,1,0]
  buffer_load_dwordx4 a[188:191], v12, s[36:39], s22 offen offset:2048 sc1
  v_pk_fma_f32 v[70:71], v[70:71], v[78:79], 1.0 op_sel_hi:[1,1,0]
  v_rcp_f32 v64, v64
  v_rcp_f32 v65, v65
  v_rcp_f32 v66, v66
  v_rcp_f32 v67, v67
  v_rcp_f32 v68, v68
  v_rcp_f32 v69, v69
  buffer_load_dwordx4 a[192:195], v12, s[36:39], s22 offen offset:3072 sc1
  v_rcp_f32 v70, v70
  v_rcp_f32 v71, v71
  v_pk_fma_f32 v[64:65], v[232:233], v[64:65], v[232:233] neg_lo:[1,0,0] neg_hi:[1,0,0]
  v_pk_fma_f32 v[66:67], v[234:235], v[66:67], v[234:235] neg_lo:[1,0,0] neg_hi:[1,0,0]
  v_pk_fma_f32 v[68:69], v[236:237], v[68:69], v[236:237] neg_lo:[1,0,0] neg_hi:[1,0,0]
  v_pk_fma_f32 v[70:71], v[238:239], v[70:71], v[238:239] neg_lo:[1,0,0] neg_hi:[1,0,0]
  v_cvt_pk_bf16_f32 v232, v64, v65
  buffer_load_dwordx4 a[196:199], v13, s[36:39], s22 offen offset:0 sc1
  v_cvt_pk_bf16_f32 v233, v66, v67
  v_cvt_pk_bf16_f32 v234, v68, v69
  v_cvt_pk_bf16_f32 v235, v70, v71
  buffer_store_dwordx4 v[232:235], v44, s[36:39], s17 offen offset:512 sc1
  s_branch f_h9
f_h3:
  v_pk_mul_f32 v[224:225], v[224:225], v[44:45] op_sel:[0,1] op_sel_hi:[1,1]
  v_pk_mul_f32 v[226:227], v[226:227], v[44:45] op_sel:[0,1] op_sel_hi:[1,1]
  v_pk_mul_f32 v[228:229], v[228:229], v[44:45] op_sel:[0,1] op_sel_hi:[1,1]
  v_pk_mul_f32 v[230:231], v[230:231], v[44:45] op_sel:[0,1] op_sel_hi:[1,1]
  v_exp_f32 v64, v224
  v_exp_f32 v65, v225
  v_exp_f32 v66, v226
  v_exp_f32 v67, v227
  v_exp_f32 v68, v228
  v_exp_f32 v69, v229
  v_exp_f32 v70, v230
  v_exp_f32 v71, v231
  v_pk_fma_f32 v[72:73], v[64:65], 0.5, 1.0 op_sel_hi:[1,0,0]
  v_pk_fma_f32 v[74:75], v[66:67], 0.5, 1.0 op_sel_hi:[1,0,0]
  s_add_u32 s22, s8, 204800
  buffer_load_dwordx4 a[160:163], v12, s[36:39], s22 offen offset:0 sc1
  v_pk_fma_f32 v[76:77], v[68:69], 0.5, 1.0 op_sel_hi:[1,0,0]
  v_pk_fma_f32 v[78:79], v[70:71], 0.5, 1.0 op_sel_hi:[1,0,0]
  v_pk_fma_f32 v[64:65], v[64:65], v[72:73], 1.0 op_sel_hi:[1,1,0]
  v_pk_fma_f32 v[66:67], v[66:67], v[74:75], 1.0 op_sel_hi:[1,1,0]
  v_pk_fma_f32 v[68:69], v[68:69], v[76:77], 1.0 op_sel_hi:[1,1,0]
  v_pk_fma_f32 v[70:71], v[70:71], v[78:79], 1.0 op_sel_hi:[1,1,0]
  v_rcp_f32 v64, v64
  v_rcp_f32 v65, v65
  v_rcp_f32 v66, v66
  v_rcp_f32 v67, v67
  v_rcp_f32 v68, v68
  v_rcp_f32 v69, v69
  v_rcp_f32 v70, v70
  v_rcp_f32 v71, v71
  buffer_load_dwordx4 a[164:167], v12, s[36:39], s22 offen offset:1024 sc1
  v_pk_fma_f32 v[64:65], v[224:225], v[64:65], v[224:225] neg_lo:[1,0,0] neg_hi:[1,0,0]
  v_pk_fma_f32 v[66:67], v[226:227], v[66:67], v[226:227] neg_lo:[1,0,0] neg_hi:[1,0,0]
  v_pk_fma_f32 v[68:69], v[228:229], v[68:69], v[228:229] neg_lo:[1,0,0] neg_hi:[1,0,0]
  v_pk_fma_f32 v[70:71], v[230:231], v[70:71], v[230:231] neg_lo:[1,0,0] neg_hi:[1,0,0]
  v_cvt_pk_bf16_f32 v224, v64, v65
  v_cvt_pk_bf16_f32 v225, v66, v67
  v_cvt_pk_bf16_f32 v226, v68, v69
  v_cvt_pk_bf16_f32 v227, v70, v71
  buffer_store_dwordx4 v[224:227], v44, s[36:39], s17 offen offset:0 sc1
  v_pk_mul_f32 v[232:233], v[232:233], v[44:45] op_sel:[0,1] op_sel_hi:[1,1]
  v_pk_mul_f32 v[234:235], v[234:235], v[44:45] op_sel:[0,1] op_sel_hi:[1,1]
  v_pk_mul_f32 v[236:237], v[236:237], v[44:45] op_sel:[0,1] op_sel_hi:[1,1]
  v_pk_mul_f32 v[238:239], v[238:239], v[44:45] op_sel:[0,1] op_sel_hi:[1,1]
  v_exp_f32 v64, v232
  buffer_load_dwordx4 a[168:171], v12, s[36:39], s22 offen offset:2048 sc1
  v_exp_f32 v65, v233
  v_exp_f32 v66, v234
  v_exp_f32 v67, v235
  v_exp_f32 v68, v236
  v_exp_f32 v69, v237
  v_exp_f32 v70, v238
  v_exp_f32 v71, v239
  v_pk_fma_f32 v[72:73], v[64:65], 0.5, 1.0 op_sel_hi:[1,0,0]
  v_pk_fma_f32 v[74:75], v[66:67], 0.5, 1.0 op_sel_hi:[1,0,0]
  v_pk_fma_f32 v[76:77], v[68:69], 0.5, 1.0 op_sel_hi:[1,0,0]
  v_pk_fma_f32 v[78:79], v[70:71], 0.5, 1.0 op_sel_hi:[1,0,0]
  v_pk_fma_f32 v[64:65], v[64:65], v[72:73], 1.0 op_sel_hi:[1,1,0]
  v_pk_fma_f32 v[66:67], v[66:67], v[74:75], 1.0 op_sel_hi:[1,1,0]
  v_pk_fma_f32 v[68:69], v[68:69], v[76:77], 1.0 op_sel_hi:[1,1,0]
  buffer_load_dwordx4 a[172:175], v12, s[36:39], s22 offen offset:3072 sc1
  v_pk_fma_f32 v[70:71], v[70:71], v[78:79], 1.0 op_sel_hi:[1,1,0]
  v_rcp_f32 v64, v64
  v_rcp_f32 v65, v65
  v_rcp_f32 v66, v66
  v_rcp_f32 v67, v67
  v_rcp_f32 v68, v68
  v_rcp_f32 v69, v69
  v_rcp_f32 v70, v70
  v_rcp_f32 v71, v71
  v_pk_fma_f32 v[64:65], v[232:233], v[64:65], v[232:233] neg_lo:[1,0,0] neg_hi:[1,0,0]
  v_pk_fma_f32 v[66:67], v[234:235], v[66:67], v[234:235] neg_lo:[1,0,0] neg_hi:[1,0,0]
  v_pk_fma_f32 v[68:69], v[236:237], v[68:69], v[236:237] neg_lo:[1,0,0] neg_hi:[1,0,0]
  v_pk_fma_f32 v[70:71], v[238:239], v[70:71], v[238:239] neg_lo:[1,0,0] neg_hi:[1,0,0]
  v_cvt_pk_bf16_f32 v232, v64, v65
  buffer_load_dwordx4 a[176:179], v13, s[36:39], s22 offen offset:0 sc1
  s_add_u32 s22, s8, 225280
  v_cvt_pk_bf16_f32 v233, v66, v67
  v_cvt_pk_bf16_f32 v234, v68, v69
  v_cvt_pk_bf16_f32 v235, v70, v71
  buffer_store_dwordx4 v[232:235], v44, s[36:39], s17 offen offset:512 sc1
  v_pk_mul_f32 v[240:241], v[240:241], v[44:45] op_sel:[0,1] op_sel_hi:[1,1]
  v_pk_mul_f32 v[242:243], v[242:243], v[44:45] op_sel:[0,1] op_sel_hi:[1,1]
  v_pk_mul_f32 v[244:245], v[244:245], v[44:45] op_sel:[0,1] op_sel_hi:[1,1]
  v_pk_mul_f32 v[246:247], v[246:247], v[44:45] op_sel:[0,1] op_sel_hi:[1,1]
  v_exp_f32 v64, v240
  v_exp_f32 v65, v241
  v_exp_f32 v66, v242
  v_exp_f32 v67, v243
  v_exp_f32 v68, v244
  v_exp_f32 v69, v245
  buffer_load_dwordx4 a[180:183], v12, s[36:39], s22 offen offset:0 sc1
  v_exp_f32 v70, v246
  v_exp_f32 v71, v247
  v_pk_fma_f32 v[72:73], v[64:65], 0.5, 1.0 op_sel_hi:[1,0,0]
  v_pk_fma_f32 v[74:75], v[66:67], 0.5, 1.0 op_sel_hi:[1,0,0]
  v_pk_fma_f32 v[76:77], v[68:69], 0.5, 1.0 op_sel_hi:[1,0,0]
  v_pk_fma_f32 v[78:79], v[70:71], 0.5, 1.0 op_sel_hi:[1,0,0]
  v_pk_fma_f32 v[64:65], v[64:65], v[72:73], 1.0 op_sel_hi:[1,1,0]
  v_pk_fma_f32 v[66:67], v[66:67], v[74:75], 1.0 op_sel_hi:[1,1,0]
  v_pk_fma_f32 v[68:69], v[68:69], v[76:77], 1.0 op_sel_hi:[1,1,0]
  v_pk_fma_f32 v[70:71], v[70:71], v[78:79], 1.0 op_sel_hi:[1,1,0]
  v_rcp_f32 v64, v64
  v_rcp_f32 v65, v65
  v_rcp_f32 v66, v66
  v_rcp_f32 v67, v67
  buffer_load_dwordx4 a[184:187], v12, s[36:39], s22 offen offset:1024 sc1
  v_rcp_f32 v68, v68
  v_rcp_f32 v69, v69
  v_rcp_f32 v70, v70
  v_rcp_f32 v71, v71
  v_pk_fma_f32 v[64:65], v[240:241], v[64:65], v[240:241] neg_lo:[1,0,0] neg_hi:[1,0,0]
  v_pk_fma_f32 v[66:67], v[242:243], v[66:67], v[242:243] neg_lo:[1,0,0] neg_hi:[1,0,0]
  v_pk_fma_f32 v[68:69], v[244:245], v[68:69], v[244:245] neg_lo:[1,0,0] neg_hi:[1,0,0]
  v_pk_fma_f32 v[70:71], v[246:247], v[70:71], v[246:247] neg_lo:[1,0,0] neg_hi:[1,0,0]
  v_cvt_pk_bf16_f32 v240, v64, v65
  v_cvt_pk_bf16_f32 v241, v66, v67
  v_cvt_pk_bf16_f32 v242, v68, v69
  v_cvt_pk_bf16_f32 v243, v70, v71
  buffer_store_dwordx4 v[240:243], v44, s[36:39], s17 offen offset:1024 sc1
  v_pk_mul_f32 v[248:249], v[248:249], v[44:45] op_sel:[0,1] op_sel_hi:[1,1]
  buffer_load_dwordx4 a[188:191], v12, s[36:39], s22 offen offset:2048 sc1
  v_pk_mul_f32 v[250:251], v[250:251], v[44:45] op_sel:[0,1] op_sel_hi:[1,1]
  v_pk_mul_f32 v[252:253], v[252:253], v[44:45] op_sel:[0,1] op_sel_hi:[1,1]
  v_pk_mul_f32 v[254:255], v[254:255], v[44:45] op_sel:[0,1] op_sel_hi:[1,1]
  v_exp_f32 v64, v248
  v_exp_f32 v65, v249
  v_exp_f32 v66, v250
  v_exp_f32 v67, v251
  v_exp_f32 v68, v252
  v_exp_f32 v69, v253
  v_exp_f32 v70, v254
  v_exp_f32 v71, v255
  v_pk_fma_f32 v[72:73], v[64:65], 0.5, 1.0 op_sel_hi:[1,0,0]
  v_pk_fma_f32 v[74:75], v[66:67], 0.5, 1.0 op_sel_hi:[1,0,0]
  v_pk_fma_f32 v[76:77], v[68:69], 0.5, 1.0 op_sel_hi:[1,0,0]
  buffer_load_dwordx4 a[192:195], v12, s[36:39], s22 offen offset:3072 sc1
  v_pk_fma_f32 v[78:79], v[70:71], 0.5, 1.0 op_sel_hi:[1,0,0]
  v_pk_fma_f32 v[64:65], v[64:65], v[72:73], 1.0 op_sel_hi:[1,1,0]
  v_pk_fma_f32 v[66:67], v[66:67], v[74:75], 1.0 op_sel_hi:[1,1,0]
  v_pk_fma_f32 v[68:69], v[68:69], v[76:77], 1.0 op_sel_hi:[1,1,0]
  v_pk_fma_f32 v[70:71], v[70:71], v[78:79], 1.0 op_sel_hi:[1,1,0]
  v_rcp_f32 v64, v64
  v_rcp_f32 v65, v65
  v_rcp_f32 v66, v66
  v_rcp_f32 v67, v67
  v_rcp_f32 v68, v68
  v_rcp_f32 v69, v69
  v_rcp_f32 v70, v70
  v_rcp_f32 v71, v71
  v_pk_fma_f32 v[64:65], v[248:249], v[64:65], v[248:249] neg_lo:[1,0,0] neg_hi:[1,0,0]
  buffer_load_dwordx4 a[196:199], v13, s[36:39], s22 offen offset:0 sc1
  v_pk_fma_f32 v[66:67], v[250:251], v[66:67], v[250:251] neg_lo:[1,0,0] neg_hi:[1,0,0]
  v_pk_fma_f32 v[68:69], v[252:253], v[68:69], v[252:253] neg_lo:[1,0,0] neg_hi:[1,0,0]
  v_pk_fma_f32 v[70:71], v[254:255], v[70:71], v[254:255] neg_lo:[1,0,0] neg_hi:[1,0,0]
  v_cvt_pk_bf16_f32 v248, v64, v65
  v_cvt_pk_bf16_f32 v249, v66, v67
  v_cvt_pk_bf16_f32 v250, v68, v69
  v_cvt_pk_bf16_f32 v251, v70, v71
  buffer_store_dwordx4 v[248:251], v44, s[36:39], s17 offen offset:1536 sc1
f_h9:
  v_lshrrev_b32 v1, 4, v0
  v_and_b32 v2, 3, v0
  v_bfe_u32 v3, v0, 2, 2
  v_mul_u32_u24 v4, 960, v1
  v_add_u32 v4, 151552, v4
  v_mul_u32_u24 v5, 1920, v1
  v_add_u32 v5, 20480, v5
  v_mov_b32 v6, 155392
  v_cmp_eq_u32 vcc, v1, v2
  s_nop 1
  v_cndmask_b32 v4, v6, v4, vcc
  v_cndmask_b32 v5, v6, v5, vcc
  v_mad_u32_u24 v24, v3, 40, v4
  v_mad_u32_u24 v25, v3, 48, v5
  v_mov_b32 v94, 0
  v_mov_b32 v95, 0
  ds_read_b64_tr_b16 a[240:241], v24 offset:0
  ds_read_b64_tr_b16 a[242:243], v24 offset:160
  ds_read_b64_tr_b16 a[244:245], v24 offset:8
  ds_read_b64_tr_b16 a[246:247], v24 offset:168
  ds_read_b64_tr_b16 a[248:249], v24 offset:16
  ds_read_b64_tr_b16 a[250:251], v24 offset:176
  ds_read_b64_tr_b16 a[252:253], v24 offset:24
  ds_read_b64_tr_b16 a[254:255], v24 offset:184
  ds_read_b64_tr_b16 v[100:101], v24 offset:32
  ds_read_b64_tr_b16 v[102:103], v24 offset:192
  ds_read_b64_tr_b16 v[104:105], v24 offset:320
  ds_read_b64_tr_b16 v[106:107], v24 offset:480
  ds_read_b64_tr_b16 v[108:109], v24 offset:328
  ds_read_b64_tr_b16 v[110:111], v24 offset:488
  s_lshr_b32 s0, s62, 4
  s_lshl_b32 s0, s0, 2
  s_bfe_u32 s1, s62, 0x30001
  s_lshl_b32 s1, s1, 3
  s_add_u32 s0, s0, s1
  s_mov_b32 s1, 128
  v_bfe_u32 v1, v0, 2, 1
  v_and_b32 v2, 3, v0
  v_lshl_add_u32 v1, v1, 6, v2
  s_add_u32 s0, s0, s1
  s_lshl_b32 s0, s0, 8
  s_add_u32 s0, s0, 4096
  v_lshl_add_u32 v11, v1, 8, s0
  s_waitcnt vmcnt(12)
  s_waitcnt lgkmcnt(12)
  v_mfma_f32_16x16x32_bf16 v[64:67], a[240:243], v[84:87], 0
  ds_read_b64_tr_b16 a[240:241], v24 offset:336
  ds_read_b64_tr_b16 a[242:243], v24 offset:496
  s_waitcnt lgkmcnt(12)
  v_mfma_f32_16x16x32_bf16 v[68:71], a[244:247], v[84:87], 0
  ds_read_b64_tr_b16 a[244:245], v24 offset:344
  ds_read_b64_tr_b16 a[246:247], v24 offset:504
  s_waitcnt lgkmcnt(12)
  v_mfma_f32_16x16x32_bf16 v[72:75], a[248:251], v[84:87], 0
  ds_read_b64_tr_b16 a[248:249], v24 offset:352
  ds_read_b64_tr_b16 a[250:251], v24 offset:512
  s_waitcnt lgkmcnt(12)
  v_mfma_f32_16x16x32_bf16 v[76:79], a[252:255], v[84:87], 0
  ds_read_b64_tr_b16 a[252:253], v24 offset:640
  ds_read_b64_tr_b16 a[254:255], v24 offset:800
  s_waitcnt lgkmcnt(12)
  v_mfma_f32_16x16x32_bf16 v[80:83], v[100:103], v[84:87], 0
  ds_read_b64_tr_b16 v[100:101], v24 offset:648
  ds_read_b64_tr_b16 v[102:103], v24 offset:808
  s_waitcnt lgkmcnt(12)
  v_mfma_f32_16x16x32_bf16 v[64:67], v[104:107], v[88:91], v[64:67]
  ds_read_b64_tr_b16 v[104:105], v24 offset:656
  ds_read_b64_tr_b16 v[106:107], v24 offset:816
  s_waitcnt lgkmcnt(12)
  v_mfma_f32_16x16x32_bf16 v[68:71], v[108:111], v[88:91], v[68:71]
  ds_read_b64_tr_b16 v[108:109], v24 offset:664
  ds_read_b64_tr_b16 v[110:111], v24 offset:824
  s_waitcnt lgkmcnt(12)
  v_mfma_f32_16x16x32_bf16 v[72:75], a[240:243], v[88:91], v[72:75]
  ds_read_b64_tr_b16 a[240:241], v24 offset:672
  ds_read_b64_tr_b16 a[242:243], v24 offset:832
  s_waitcnt lgkmcnt(12)
  v_mfma_f32_16x16x32_bf16 v[76:79], a[244:247], v[88:91], v[76:79]
  s_waitcnt lgkmcnt(10)
  v_mfma_f32_16x16x32_bf16 v[80:83], a[248:251], v[88:91], v[80:83]
  s_waitcnt lgkmcnt(8)
  v_mfma_f32_16x16x32_bf16 v[64:67], a[252:255], v[92:95], v[64:67]
  s_waitcnt lgkmcnt(6)
  v_mfma_f32_16x16x32_bf16 v[68:71], v[100:103], v[92:95], v[68:71]
  s_waitcnt lgkmcnt(4)
  v_mfma_f32_16x16x32_bf16 v[72:75], v[104:107], v[92:95], v[72:75]
  s_waitcnt lgkmcnt(2)
  v_mfma_f32_16x16x32_bf16 v[76:79], v[108:111], v[92:95], v[76:79]
  s_waitcnt lgkmcnt(0)
  v_mfma_f32_16x16x32_bf16 v[80:83], a[240:243], v[92:95], v[80:83]
  v_rsq_f32 v96, v97
  s_nop 0
  v_mul_f32 v96, 0x3fb8aa3b, v96
  v_max3_f32 v2, v64, v65, v66
  v_min3_f32 v3, v64, v65, v66
  v_max3_f32 v2, v2, v67, v68
  v_min3_f32 v3, v3, v67, v68
  v_max3_f32 v2, v2, v69, v70
  v_min3_f32 v3, v3, v69, v70
  v_max3_f32 v2, v2, v71, v72
  v_min3_f32 v3, v3, v71, v72
  v_max3_f32 v2, v2, v73, v74
  v_min3_f32 v3, v3, v73, v74
  v_max3_f32 v2, v2, v75, v76
  v_min3_f32 v3, v3, v75, v76
  v_max3_f32 v2, v2, v77, v78
  v_min3_f32 v3, v3, v77, v78
  v_max3_f32 v2, v2, v79, v80
  v_min3_f32 v3, v3, v79, v80
  v_max3_f32 v2, v2, v81, v82
  v_min3_f32 v3, v3, v81, v82
  v_max_f32 v2, v2, v83
  v_min_f32 v3, v3, v83
  v_mul_f32 v2, v2, v96
  v_mul_f32 v3, v3, v96
  v_pk_fma_f32 v[44:45], v[64:65], v[96:97], v[2:3] op_sel:[0,0,0] op_sel_hi:[1,0,0] neg_lo:[0,0,1] neg_hi:[0,0,1]
  v_pk_fma_f32 v[64:65], v[64:65], v[96:97], v[2:3] op_sel:[0,0,1] op_sel_hi:[1,0,1] neg_lo:[1,0,0] neg_hi:[1,0,0]
  v_exp_f32 v44, v44
  v_exp_f32 v45, v45
  v_exp_f32 v64, v64
  v_exp_f32 v65, v65
  v_pk_fma_f32 v[46:47], v[66:67], v[96:97], v[2:3] op_sel:[0,0,0] op_sel_hi:[1,0,0] neg_lo:[0,0,1] neg_hi:[0,0,1]
  v_pk_fma_f32 v[66:67], v[66:67], v[96:97], v[2:3] op_sel:[0,0,1] op_sel_hi:[1,0,1] neg_lo:[1,0,0] neg_hi:[1,0,0]
  v_exp_f32 v46, v46
  v_exp_f32 v47, v47
  v_exp_f32 v66, v66
  v_exp_f32 v67, v67
  v_pk_fma_f32 v[48:49], v[68:69], v[96:97], v[2:3] op_sel:[0,0,0] op_sel_hi:[1,0,0] neg_lo:[0,0,1] neg_hi:[0,0,1]
  v_pk_fma_f32 v[68:69], v[68:69], v[96:97], v[2:3] op_sel:[0,0,1] op_sel_hi:[1,0,1] neg_lo:[1,0,0] neg_hi:[1,0,0]
  v_exp_f32 v48, v48
  v_exp_f32 v49, v49
  v_exp_f32 v68, v68
  v_exp_f32 v69, v69
  v_pk_fma_f32 v[50:51], v[70:71], v[96:97], v[2:3] op_sel:[0,0,0] op_sel_hi:[1,0,0] neg_lo:[0,0,1] neg_hi:[0,0,1]
  v_pk_fma_f32 v[70:71], v[70:71], v[96:97], v[2:3] op_sel:[0,0,1] op_sel_hi:[1,0,1] neg_lo:[1,0,0] neg_hi:[1,0,0]
  v_exp_f32 v50, v50
  v_exp_f32 v51, v51
  v_exp_f32 v70, v70
  v_exp_f32 v71, v71
  v_pk_fma_f32 v[52:53], v[72:73], v[96:97], v[2:3] op_sel:[0,0,0] op_sel_hi:[1,0,0] neg_lo:[0,0,1] neg_hi:[0,0,1]
  v_pk_fma_f32 v[72:73], v[72:73], v[96:97], v[2:3] op_sel:[0,0,1] op_sel_hi:[1,0,1] neg_lo:[1,0,0] neg_hi:[1,0,0]
  v_exp_f32 v52, v52
  v_exp_f32 v53, v53
  v_exp_f32 v72, v72
  v_exp_f32 v73, v73
  v_pk_fma_f32 v[54:55], v[74:75], v[96:97], v[2:3] op_sel:[0,0,0] op_sel_hi:[1,0,0] neg_lo:[0,0,1] neg_hi:[0,0,1]
  v_pk_fma_f32 v[74:75], v[74:75], v[96:97], v[2:3] op_sel:[0,0,1] op_sel_hi:[1,0,1] neg_lo:[1,0,0] neg_hi:[1,0,0]
  v_exp_f32 v54, v54
  v_exp_f32 v55, v55
  v_exp_f32 v74, v74
  v_exp_f32 v75, v75
  v_pk_fma_f32 v[56:57], v[76:77], v[96:97], v[2:3] op_sel:[0,0,0] op_sel_hi:[1,0,0] neg_lo:[0,0,1] neg_hi:[0,0,1]
  v_pk_fma_f32 v[76:77], v[76:77], v[96:97], v[2:3] op_sel:[0,0,1] op_sel_hi:[1,0,1] neg_lo:[1,0,0] neg_hi:[1,0,0]
  v_exp_f32 v56, v56
  v_exp_f32 v57, v57
  v_exp_f32 v76, v76
  v_exp_f32 v77, v77
  v_pk_fma_f32 v[58:59], v[78:79], v[96:97], v[2:3] op_sel:[0,0,0] op_sel_hi:[1,0,0] neg_lo:[0,0,1] neg_hi:[0,0,1]
  v_pk_fma_f32 v[78:79], v[78:79], v[96:97], v[2:3] op_sel:[0,0,1] op_sel_hi:[1,0,1] neg_lo:[1,0,0] neg_hi:[1,0,0]
  v_exp_f32 v58, v58
  v_exp_f32 v59, v59
  v_exp_f32 v78, v78
  v_exp_f32 v79, v79
  v_pk_fma_f32 v[60:61], v[80:81], v[96:97], v[2:3] op_sel:[0,0,0] op_sel_hi:[1,0,0] neg_lo:[0,0,1] neg_hi:[0,0,1]
  v_pk_fma_f32 v[80:81], v[80:81], v[96:97], v[2:3] op_sel:[0,0,1] op_sel_hi:[1,0,1] neg_lo:[1,0,0] neg_hi:[1,0,0]
  v_exp_f32 v60, v60
  v_exp_f32 v61, v61
  v_exp_f32 v80, v80
  v_exp_f32 v81, v81
  v_pk_fma_f32 v[62:63], v[82:83], v[96:97], v[2:3] op_sel:[0,0,0] op_sel_hi:[1,0,0] neg_lo:[0,0,1] neg_hi:[0,0,1]
  v_pk_fma_f32 v[82:83], v[82:83], v[96:97], v[2:3] op_sel:[0,0,1] op_sel_hi:[1,0,1] neg_lo:[1,0,0] neg_hi:[1,0,0]
  v_exp_f32 v62, v62
  v_exp_f32 v63, v63
  v_exp_f32 v82, v82
  v_exp_f32 v83, v83
  v_pk_add_f32 v[4:5], v[44:45], v[46:47]
  v_pk_add_f32 v[6:7], v[64:65], v[66:67]
  v_pk_add_f32 v[4:5], v[4:5], v[48:49]
  v_pk_add_f32 v[6:7], v[6:7], v[68:69]
  v_pk_add_f32 v[4:5], v[4:5], v[50:51]
  v_pk_add_f32 v[6:7], v[6:7], v[70:71]
  v_pk_add_f32 v[4:5], v[4:5], v[52:53]
  v_pk_add_f32 v[6:7], v[6:7], v[72:73]
  v_pk_add_f32 v[4:5], v[4:5], v[54:55]
  v_pk_add_f32 v[6:7], v[6:7], v[74:75]
  v_pk_add_f32 v[4:5], v[4:5], v[56:57]
  v_pk_add_f32 v[6:7], v[6:7], v[76:77]
  v_pk_add_f32 v[4:5], v[4:5], v[58:59]
  v_pk_add_f32 v[6:7], v[6:7], v[78:79]
  v_pk_add_f32 v[4:5], v[4:5], v[60:61]
  v_pk_add_f32 v[6:7], v[6:7], v[80:81]
  v_pk_add_f32 v[4:5], v[4:5], v[62:63]
  v_pk_add_f32 v[6:7], v[6:7], v[82:83]
  v_add_f32 v2, v4, v5
  v_add_f32 v3, v6, v7
  v_rcp_f32 v2, v2
  v_rcp_f32 v3, v3
  s_nop 0
  v_pk_mul_f32 v[44:45], v[44:45], v[2:3] op_sel:[0,0] op_sel_hi:[1,0]
  v_pk_mul_f32 v[46:47], v[46:47], v[2:3] op_sel:[0,0] op_sel_hi:[1,0]
  v_cvt_pk_bf16_f32 v44, v44, v45
  v_pk_mul_f32 v[48:49], v[48:49], v[2:3] op_sel:[0,0] op_sel_hi:[1,0]
  v_cvt_pk_bf16_f32 v45, v46, v47
  buffer_load_dword v10, v11, s[36:39], 0 offen sc1
  v_pk_mul_f32 v[50:51], v[50:51], v[2:3] op_sel:[0,0] op_sel_hi:[1,0]
  v_cvt_pk_bf16_f32 v46, v48, v49
  v_pk_mul_f32 v[52:53], v[52:53], v[2:3] op_sel:[0,0] op_sel_hi:[1,0]
  v_cvt_pk_bf16_f32 v47, v50, v51
  v_pk_mul_f32 v[54:55], v[54:55], v[2:3] op_sel:[0,0] op_sel_hi:[1,0]
  v_cvt_pk_bf16_f32 v48, v52, v53
  v_pk_mul_f32 v[56:57], v[56:57], v[2:3] op_sel:[0,0] op_sel_hi:[1,0]
  v_cvt_pk_bf16_f32 v49, v54, v55
  v_pk_mul_f32 v[58:59], v[58:59], v[2:3] op_sel:[0,0] op_sel_hi:[1,0]
  v_cvt_pk_bf16_f32 v50, v56, v57
  v_pk_mul_f32 v[60:61], v[60:61], v[2:3] op_sel:[0,0] op_sel_hi:[1,0]
  v_cvt_pk_bf16_f32 v51, v58, v59
  v_pk_mul_f32 v[62:63], v[62:63], v[2:3] op_sel:[0,0] op_sel_hi:[1,0]
  v_cvt_pk_bf16_f32 v52, v60, v61
  v_pk_mul_f32 v[64:65], v[64:65], v[2:3] op_sel:[0,1] op_sel_hi:[1,1]
  v_cvt_pk_bf16_f32 v53, v62, v63
  v_pk_mul_f32 v[66:67], v[66:67], v[2:3] op_sel:[0,1] op_sel_hi:[1,1]
  v_cvt_pk_bf16_f32 v54, v64, v65
  v_pk_mul_f32 v[68:69], v[68:69], v[2:3] op_sel:[0,1] op_sel_hi:[1,1]
  v_cvt_pk_bf16_f32 v55, v66, v67
  v_pk_mul_f32 v[70:71], v[70:71], v[2:3] op_sel:[0,1] op_sel_hi:[1,1]
  v_cvt_pk_bf16_f32 v56, v68, v69
  v_pk_mul_f32 v[72:73], v[72:73], v[2:3] op_sel:[0,1] op_sel_hi:[1,1]
  v_cvt_pk_bf16_f32 v57, v70, v71
  v_pk_mul_f32 v[74:75], v[74:75], v[2:3] op_sel:[0,1] op_sel_hi:[1,1]
  v_cvt_pk_bf16_f32 v58, v72, v73
  v_pk_mul_f32 v[76:77], v[76:77], v[2:3] op_sel:[0,1] op_sel_hi:[1,1]
  v_cvt_pk_bf16_f32 v59, v74, v75
  v_pk_mul_f32 v[78:79], v[78:79], v[2:3] op_sel:[0,1] op_sel_hi:[1,1]
  v_cvt_pk_bf16_f32 v60, v76, v77
  v_pk_mul_f32 v[80:81], v[80:81], v[2:3] op_sel:[0,1] op_sel_hi:[1,1]
  v_cvt_pk_bf16_f32 v61, v78, v79
  v_pk_mul_f32 v[82:83], v[82:83], v[2:3] op_sel:[0,1] op_sel_hi:[1,1]
  v_cvt_pk_bf16_f32 v62, v80, v81
  v_cvt_pk_bf16_f32 v63, v82, v83
  s_waitcnt vmcnt(1)
  s_barrier
  s_add_u32 s18, s64, 4
  v_mov_b32 v14, s18
  buffer_store_dword v14, v9, s[36:39], 0 offen sc1
f_tail:
  s_add_u32 s18, s64, 3
  s_waitcnt vmcnt(1)
  v_subrev_u32 v14, s18, v10
  v_cmp_gt_u32_e64 s[100:101], 8, v14
  s_nop 0
  s_cmp_eq_u64 s[100:101], -1
  s_cbranch_scc0 f_spin5
f_back5:
  buffer_load_dwordx4 v[112:115], v16, s[36:39], s7 offen sc1
  s_and_b32 s0, s63, 1
  s_lshl_b32 s0, s0, 6
  buffer_load_dwordx4 v[116:119], v17, s[36:39], s7 offen sc1
  s_lshr_b32 s1, s63, 1
  s_add_u32 s0, s0, s1
  buffer_load_dwordx4 v[120:123], v18, s[36:39], s7 offen sc1
  s_lshl_b32 s0, s0, 8
  s_add_u32 s0, s0, 4096
  buffer_load_dwordx4 v[124:127], v19, s[36:39], s7 offen sc1
  s_add_u32 s7, s7, 4096
  v_and_b32 v1, 15, v0
  v_lshl_add_u32 v1, v1, 10, s0
  buffer_load_dwordx4 v[128:131], v16, s[36:39], s7 offen sc1
  v_cmp_gt_u32 vcc, 32, v0
  s_nop 1
  v_cndmask_b32 v11, v11, v1, vcc
  buffer_load_dwordx4 v[132:135], v17, s[36:39], s7 offen sc1
  v_lshlrev_b32 v32, 4, v8
  v_add_u32 v33, 4096, v32
  buffer_load_dwordx4 v[136:139], v18, s[36:39], s7 offen sc1
  v_add_u32 v34, 8192, v32
  v_add_u32 v35, 12288, v32
  buffer_load_dwordx4 v[140:143], v19, s[36:39], s7 offen sc1
  s_add_u32 s7, s7, 4096
  s_mul_i32 s67, s3, 5120
  v_add_u32 v36, 61440, v12
  buffer_load_dwordx4 v[144:147], v16, s[36:39], s7 offen sc1
  v_add_u32 v37, 102400, v12
  buffer_load_dwordx4 v[148:151], v17, s[36:39], s7 offen sc1
  buffer_load_dwordx4 v[152:155], v18, s[36:39], s7 offen sc1
  buffer_load_dwordx4 v[156:159], v19, s[36:39], s7 offen sc1
  s_add_u32 s7, s7, 4096
  buffer_load_dwordx4 v[160:163], v16, s[36:39], s7 offen sc1
  buffer_load_dwordx4 v[164:167], v17, s[36:39], s7 offen sc1
  buffer_load_dwordx4 v[168:171], v18, s[36:39], s7 offen sc1
  buffer_load_dwordx4 v[172:175], v19, s[36:39], s7 offen sc1
  s_add_u32 m0, s67, 0
  s_add_u32 s21, s23, 0
  buffer_load_dwordx4 v12, s[36:39], s21 offen offset:0 sc1 lds
  buffer_load_dwordx4 v12, s[36:39], s21 offen offset:1024 sc1 lds
  buffer_load_dwordx4 v12, s[36:39], s21 offen offset:2048 sc1 lds
  buffer_load_dwordx4 v12, s[36:39], s21 offen offset:3072 sc1 lds
  s_add_u32 m0, s67, 4096
  s_nop 0
  buffer_load_dwordx4 v13, s[36:39], s21 offen offset:0 sc1 lds
  s_waitcnt vmcnt(20)
  v_mfma_f32_16x16x32_bf16 v[176:179], a[200:203], v[112:115], 0
  v_mfma_f32_16x16x32_bf16 v[180:183], a[204:207], v[112:115], 0
  v_mfma_f32_16x16x32_bf16 v[184:187], a[208:211], v[112:115], 0
  v_mfma_f32_16x16x32_bf16 v[188:191], a[212:215], v[112:115], 0
  v_mfma_f32_16x16x32_bf16 v[192:195], a[216:219], v[112:115], 0
  s_add_u32 s7, s7, 4096
  buffer_load_dwordx4 v[112:115], v16, s[36:39], s7 offen sc1
  s_waitcnt vmcnt(20)
  v_mfma_f32_16x16x32_bf16 v[196:199], a[200:203], v[116:119], 0
  v_mfma_f32_16x16x32_bf16 v[200:203], a[204:207], v[116:119], 0
  v_mfma_f32_16x16x32_bf16 v[204:207], a[208:211], v[116:119], 0
  v_mfma_f32_16x16x32_bf16 v[208:211], a[212:215], v[116:119], 0
  v_mfma_f32_16x16x32_bf16 v[212:215], a[216:219], v[116:119], 0
  buffer_load_dwordx4 v[116:119], v17, s[36:39], s7 offen sc1
  s_waitcnt vmcnt(20)
  v_mfma_f32_16x16x32_bf16 v[216:219], a[200:203], v[120:123], 0
  v_mfma_f32_16x16x32_bf16 v[220:223], a[204:207], v[120:123], 0
  v_mfma_f32_16x16x32_bf16 v[224:227], a[208:211], v[120:123], 0
  v_mfma_f32_16x16x32_bf16 v[228:231], a[212:215], v[120:123], 0
  v_mfma_f32_16x16x32_bf16 v[232:235], a[216:219], v[120:123], 0
  buffer_load_dwordx4 v[120:123], v18, s[36:39], s7 offen sc1
  s_waitcnt vmcnt(20)
  v_mfma_f32_16x16x32_bf16 v[236:239], a[200:203], v[124:127], 0
  v_mfma_f32_16x16x32_bf16 v[240:243], a[204:207], v[124:127], 0
  v_mfma_f32_16x16x32_bf16 v[244:247], a[208:211], v[124:127], 0
  v_mfma_f32_16x16x32_bf16 v[248:251], a[212:215], v[124:127], 0
  v_mfma_f32_16x16x32_bf16 v[252:255], a[216:219], v[124:127], 0
  buffer_load_dwordx4 v[124:127], v19, s[36:39], s7 offen sc1
  buffer_load_dword v10, v11, s[36:39], 0 offen sc1
  s_waitcnt vmcnt(21)
  v_mfma_f32_16x16x32_bf16 v[176:179], a[220:223], v[128:131], v[176:179]
  v_mfma_f32_16x16x32_bf16 v[180:183], a[224:227], v[128:131], v[180:183]
  s_add_u32 s22, s8, 245760
  buffer_load_dwordx4 a[200:203], v12, s[36:39], s22 offen offset:0 sc1
  v_mfma_f32_16x16x32_bf16 v[184:187], a[228:231], v[128:131], v[184:187]
  v_mfma_f32_16x16x32_bf16 v[188:191], a[232:235], v[128:131], v[188:191]
  v_mfma_f32_16x16x32_bf16 v[192:195], a[236:239], v[128:131], v[192:195]
  s_add_u32 s7, s7, 4096
  buffer_load_dwordx4 v[128:131], v16, s[36:39], s7 offen sc1
  s_waitcnt vmcnt(22)
  v_mfma_f32_16x16x32_bf16 v[196:199], a[220:223], v[132:135], v[196:199]
  buffer_load_dwordx4 a[204:207], v12, s[36:39], s22 offen offset:1024 sc1
  v_mfma_f32_16x16x32_bf16 v[200:203], a[224:227], v[132:135], v[200:203]
  v_mfma_f32_16x16x32_bf16 v[204:207], a[228:231], v[132:135], v[204:207]
  v_mfma_f32_16x16x32_bf16 v[208:211], a[232:235], v[132:135], v[208:211]
  v_mfma_f32_16x16x32_bf16 v[212:215], a[236:239], v[132:135], v[212:215]
  buffer_load_dwordx4 a[208:211], v12, s[36:39], s22 offen offset:2048 sc1
  buffer_load_dwordx4 v[132:135], v17, s[36:39], s7 offen sc1
  s_waitcnt vmcnt(24)
  v_mfma_f32_16x16x32_bf16 v[216:219], a[220:223], v[136:139], v[216:219]
  v_mfma_f32_16x16x32_bf16 v[220:223], a[224:227], v[136:139], v[220:223]
  v_mfma_f32_16x16x32_bf16 v[224:227], a[228:231], v[136:139], v[224:227]
  v_mfma_f32_16x16x32_bf16 v[228:231], a[232:235], v[136:139], v[228:231]
  buffer_load_dwordx4 a[212:215], v12, s[36:39], s22 offen offset:3072 sc1
  v_mfma_f32_16x16x32_bf16 v[232:235], a[236:239], v[136:139], v[232:235]
  buffer_load_dwordx4 v[136:139], v18, s[36:39], s7 offen sc1
  s_waitcnt vmcnt(25)
  v_mfma_f32_16x16x32_bf16 v[236:239], a[220:223], v[140:143], v[236:239]
  v_mfma_f32_16x16x32_bf16 v[240:243], a[224:227], v[140:143], v[240:243]
  v_mfma_f32_16x16x32_bf16 v[244:247], a[228:231], v[140:143], v[244:247]
  buffer_load_dwordx4 a[216:219], v13, s[36:39], s22 offen offset:0 sc1
  v_mfma_f32_16x16x32_bf16 v[248:251], a[232:235], v[140:143], v[248:251]
  v_mfma_f32_16x16x32_bf16 v[252:255], a[236:239], v[140:143], v[252:255]
  buffer_load_dwordx4 v[140:143], v19, s[36:39], s7 offen sc1
  s_add_u32 s18, s64, 4
  s_waitcnt vmcnt(9)
  v_subrev_u32 v14, s18, v10
  v_cmp_gt_u32_e64 s[100:101], 8, v14
  s_nop 0
  s_cmp_eq_u64 s[100:101], -1
  s_cbranch_scc0 f_spin6
f_back6:
  s_mul_i32 s18, s63, 15360
  s_add_u32 s18, s18, 15597568
  s_add_u32 s19, s18, 122880
  buffer_load_dwordx4 v[88:91], v32, s[36:39], s18 offen sc1
  buffer_load_dwordx4 v[64:67], v32, s[36:39], s19 offen sc1
  buffer_load_dwordx4 v[92:95], v33, s[36:39], s18 offen sc1
  buffer_load_dwordx4 v[68:71], v33, s[36:39], s19 offen sc1
  buffer_load_dwordx4 v[96:99], v34, s[36:39], s18 offen sc1
  buffer_load_dwordx4 v[72:75], v34, s[36:39], s19 offen sc1
  buffer_load_dwordx4 v[100:103], v35, s[36:39], s18 offen sc1
  buffer_load_dwordx4 v[76:79], v35, s[36:39], s19 offen sc1
  v_mfma_f32_16x16x32_bf16 v[176:179], a[0:3], v[144:147], v[176:179]
  s_lshr_b32 s68, s63, 1
  s_mul_i32 s68, s68, 5
  v_mfma_f32_16x16x32_bf16 v[180:183], a[4:7], v[144:147], v[180:183]
  buffer_load_dwordx4 a[220:223], v12, s[36:39], s20 offen offset:0 sc1
  s_add_u32 s68, s68, 54
  s_lshl_b32 s68, s68, 10
  v_mfma_f32_16x16x32_bf16 v[184:187], a[8:11], v[144:147], v[184:187]
  s_add_u32 m0, s67, 61440
  s_add_u32 s21, s23, 5120
  buffer_load_dwordx4 v12, s[36:39], s21 offen offset:0 sc1 lds
  s_mul_i32 s69, s3, 96256
  s_add_u32 s68, s68, s69
  v_mfma_f32_16x16x32_bf16 v[188:191], a[12:15], v[144:147], v[188:191]
  s_add_u32 s68, s68, s9
  s_and_b32 s69, s63, 1
  v_mfma_f32_16x16x32_bf16 v[192:195], a[16:19], v[144:147], v[192:195]
  s_add_u32 s7, s7, 4096
  buffer_load_dwordx4 v[144:147], v16, s[36:39], s7 offen sc1
  s_lshl_b32 s70, s69, 11
  s_add_u32 s70, s70, s68
  v_mfma_f32_16x16x32_bf16 v[196:199], a[0:3], v[148:151], v[196:199]
  buffer_load_dwordx4 a[224:227], v12, s[36:39], s20 offen offset:1024 sc1
  s_lshl_b32 s69, s69, 9
  s_add_u32 s69, s69, s68
  v_mfma_f32_16x16x32_bf16 v[200:203], a[4:7], v[148:151], v[200:203]
  buffer_load_dwordx4 v12, s[36:39], s21 offen offset:1024 sc1 lds
  s_add_u32 s69, s69, 4096
  v_lshrrev_b32 v3, 5, v0
  v_mfma_f32_16x16x32_bf16 v[204:207], a[8:11], v[148:151], v[204:207]
  v_lshlrev_b32 v3, 8, v3
  v_and_b32 v4, 15, v0
  v_mfma_f32_16x16x32_bf16 v[208:211], a[12:15], v[148:151], v[208:211]
  v_lshl_add_u32 v3, v4, 4, v3
  v_bfe_u32 v4, v0, 4, 1
  v_mfma_f32_16x16x32_bf16 v[212:215], a[16:19], v[148:151], v[212:215]
  buffer_load_dwordx4 a[228:231], v12, s[36:39], s20 offen offset:2048 sc1
  buffer_load_dwordx4 v[148:151], v17, s[36:39], s7 offen sc1
  v_lshl_add_u32 v23, v4, 3, v3
  v_lshlrev_b32 v2, 3, v8
  v_mfma_f32_16x16x32_bf16 v[216:219], a[0:3], v[152:155], v[216:219]
  buffer_load_dwordx4 v12, s[36:39], s21 offen offset:2048 sc1 lds
  v_add_u32 v2, 20480, v2
  v_mfma_f32_16x16x32_bf16 v[220:223], a[4:7], v[152:155], v[220:223]
  v_mfma_f32_16x16x32_bf16 v[224:227], a[8:11], v[152:155], v[224:227]
  v_mfma_f32_16x16x32_bf16 v[228:231], a[12:15], v[152:155], v[228:231]
  buffer_load_dwordx4 a[232:235], v12, s[36:39], s20 offen offset:3072 sc1
  v_mfma_f32_16x16x32_bf16 v[232:235], a[16:19], v[152:155], v[232:235]
  buffer_load_dwordx4 v12, s[36:39], s21 offen offset:3072 sc1 lds
  buffer_load_dwordx4 v[152:155], v18, s[36:39], s7 offen sc1
  v_mfma_f32_16x16x32_bf16 v[236:239], a[0:3], v[156:159], v[236:239]
  v_mfma_f32_16x16x32_bf16 v[240:243], a[4:7], v[156:159], v[240:243]
  v_mfma_f32_16x16x32_bf16 v[244:247], a[8:11], v[156:159], v[244:247]
  buffer_load_dwordx4 a[236:239], v13, s[36:39], s20 offen offset:0 sc1
  v_mfma_f32_16x16x32_bf16 v[248:251], a[12:15], v[156:159], v[248:251]
  s_add_u32 m0, s67, 65536
  s_nop 0
  buffer_load_dwordx4 v13, s[36:39], s21 offen offset:0 sc1 lds
  v_mfma_f32_16x16x32_bf16 v[252:255], a[16:19], v[156:159], v[252:255]
  buffer_load_dwordx4 v[156:159], v19, s[36:39], s7 offen sc1
  v_mfma_f32_16x16x32_bf16 v[176:179], a[20:23], v[160:163], v[176:179]
  v_mfma_f32_16x16x32_bf16 v[180:183], a[24:27], v[160:163], v[180:183]
  v_mfma_f32_16x16x32_bf16 v[184:187], a[28:31], v[160:163], v[184:187]
  s_add_u32 m0, s67, 81920
  s_add_u32 s21, s23, 10240
  buffer_load_dwordx4 v12, s[36:39], s21 offen offset:0 sc1 lds
  v_mfma_f32_16x16x32_bf16 v[188:191], a[32:35], v[160:163], v[188:191]
  v_mfma_f32_16x16x32_bf16 v[192:195], a[36:39], v[160:163], v[192:195]
  s_add_u32 s7, s7, 4096
  buffer_load_dwordx4 v[160:163], v16, s[36:39], s7 offen sc1
  v_mfma_f32_16x16x32_bf16 v[196:199], a[20:23], v[164:167], v[196:199]
  v_mfma_f32_16x16x32_bf16 v[200:203], a[24:27], v[164:167], v[200:203]
  buffer_load_dwordx4 v12, s[36:39], s21 offen offset:1024 sc1 lds
  s_waitcnt vmcnt(23)
  v_add_f32 v88, v88, v64
  v_add_f32 v89, v89, v65
  v_mfma_f32_16x16x32_bf16 v[204:207], a[28:31], v[164:167], v[204:207]
  v_add_f32 v90, v90, v66
  v_add_f32 v91, v91, v67
  v_mfma_f32_16x16x32_bf16 v[208:211], a[32:35], v[164:167], v[208:211]
  v_cvt_pk_bf16_f32 v88, v88, v89
  v_cvt_pk_bf16_f32 v89, v90, v91
  v_mfma_f32_16x16x32_bf16 v[212:215], a[36:39], v[164:167], v[212:215]
  buffer_load_dwordx4 v[164:167], v17, s[36:39], s7 offen sc1
  ds_write_b64 v2, v[88:89] offset:0
  s_waitcnt vmcnt(22)
  v_add_f32 v92, v92, v68
  v_mfma_f32_16x16x32_bf16 v[216:219], a[20:23], v[168:171], v[216:219]
  buffer_load_dwordx4 v12, s[36:39], s21 offen offset:2048 sc1 lds
  v_add_f32 v93, v93, v69
  v_add_f32 v94, v94, v70
  v_mfma_f32_16x16x32_bf16 v[220:223], a[24:27], v[168:171], v[220:223]
  v_add_f32 v95, v95, v71
  v_cvt_pk_bf16_f32 v92, v92, v93
  v_mfma_f32_16x16x32_bf16 v[224:227], a[28:31], v[168:171], v[224:227]
  v_cvt_pk_bf16_f32 v93, v94, v95
  ds_write_b64 v2, v[92:93] offset:2048
  v_mfma_f32_16x16x32_bf16 v[228:231], a[32:35], v[168:171], v[228:231]
  s_waitcnt vmcnt(21)
  v_add_f32 v96, v96, v72
  v_add_f32 v97, v97, v73
  v_mfma_f32_16x16x32_bf16 v[232:235], a[36:39], v[168:171], v[232:235]
  buffer_load_dwordx4 v12, s[36:39], s21 offen offset:3072 sc1 lds
  buffer_load_dwordx4 v[168:171], v18, s[36:39], s7 offen sc1
  v_add_f32 v98, v98, v74
  v_add_f32 v99, v99, v75
  v_mfma_f32_16x16x32_bf16 v[236:239], a[20:23], v[172:175], v[236:239]
  v_cvt_pk_bf16_f32 v96, v96, v97
  v_cvt_pk_bf16_f32 v97, v98, v99
  v_mfma_f32_16x16x32_bf16 v[240:243], a[24:27], v[172:175], v[240:243]
  ds_write_b64 v2, v[96:97] offset:4096
  s_waitcnt vmcnt(21)
  v_add_f32 v100, v100, v76
  v_mfma_f32_16x16x32_bf16 v[244:247], a[28:31], v[172:175], v[244:247]
  v_add_f32 v101, v101, v77
  v_add_f32 v102, v102, v78
  v_mfma_f32_16x16x32_bf16 v[248:251], a[32:35], v[172:175], v[248:251]
  s_add_u32 m0, s67, 86016
  s_nop 0
  buffer_load_dwordx4 v13, s[36:39], s21 offen offset:0 sc1 lds
  v_add_f32 v103, v103, v79
  v_cvt_pk_bf16_f32 v100, v100, v101
  v_mfma_f32_16x16x32_bf16 v[252:255], a[36:39], v[172:175], v[252:255]
  buffer_load_dwordx4 v[172:175], v19, s[36:39], s7 offen sc1
  v_cvt_pk_bf16_f32 v101, v102, v103
  ds_write_b64 v2, v[100:101] offset:6144
  s_waitcnt lgkmcnt(0)
  s_barrier
  v_mfma_f32_16x16x32_bf16 v[176:179], a[40:43], v[112:115], v[176:179]
  s_add_u32 m0, s67, 102400
  s_add_u32 s21, s23, 15360
  buffer_load_dwordx4 v12, s[36:39], s21 offen offset:0 sc1 lds
  ds_read_b64_tr_b16 a[240:241], v25 offset:0
  ds_read_b64_tr_b16 a[242:243], v25 offset:192
  ds_read_b64_tr_b16 a[244:245], v25 offset:8
  ds_read_b64_tr_b16 a[246:247], v25 offset:200
  ds_read_b64_tr_b16 a[248:249], v25 offset:16
  ds_read_b64_tr_b16 a[250:251], v25 offset:208
  ds_read_b64_tr_b16 a[252:253], v25 offset:24
  v_mfma_f32_16x16x32_bf16 v[180:183], a[44:47], v[112:115], v[180:183]
  ds_read_b64_tr_b16 a[254:255], v25 offset:216
  ds_read_b64_tr_b16 v[100:101], v25 offset:32
  ds_read_b64_tr_b16 v[102:103], v25 offset:224
  ds_read_b64_tr_b16 v[104:105], v25 offset:40
  ds_read_b64_tr_b16 v[106:107], v25 offset:232
  ds_read_b64_tr_b16 v[108:109], v25 offset:384
  ds_read_b64_tr_b16 v[110:111], v25 offset:576
  v_mfma_f32_16x16x32_bf16 v[184:187], a[48:51], v[112:115], v[184:187]
  buffer_load_dwordx4 v12, s[36:39], s21 offen offset:1024 sc1 lds
  s_waitcnt lgkmcnt(12)
  v_mfma_f32_16x16x32_bf16 v[64:67], a[240:243], v[44:47], 0
  ds_read_b64_tr_b16 a[240:241], v25 offset:392
  ds_read_b64_tr_b16 a[242:243], v25 offset:584
  s_waitcnt lgkmcnt(12)
  v_mfma_f32_16x16x32_bf16 v[68:71], a[244:247], v[44:47], 0
  ds_read_b64_tr_b16 a[244:245], v25 offset:400
  ds_read_b64_tr_b16 a[246:247], v25 offset:592
  v_mfma_f32_16x16x32_bf16 v[188:191], a[52:55], v[112:115], v[188:191]
  s_waitcnt lgkmcnt(12)
  v_mfma_f32_16x16x32_bf16 v[72:75], a[248:251], v[44:47], 0
  ds_read_b64_tr_b16 a[248:249], v25 offset:408
  ds_read_b64_tr_b16 a[250:251], v25 offset:600
  s_waitcnt lgkmcnt(12)
  v_mfma_f32_16x16x32_bf16 v[76:79], a[252:255], v[44:47], 0
  ds_read_b64_tr_b16 a[252:253], v25 offset:416
  ds_read_b64_tr_b16 a[254:255], v25 offset:608
  v_mfma_f32_16x16x32_bf16 v[192:195], a[56:59], v[112:115], v[192:195]
  buffer_load_dwordx4 v12, s[36:39], s21 offen offset:2048 sc1 lds
  s_add_u32 s7, s7, 4096
  buffer_load_dwordx4 v[112:115], v16, s[36:39], s7 offen sc1
  s_waitcnt lgkmcnt(12)
  v_mfma_f32_16x16x32_bf16 v[80:83], v[100:103], v[44:47], 0
  ds_read_b64_tr_b16 v[100:101], v25 offset:424
  ds_read_b64_tr_b16 v[102:103], v25 offset:616
  s_waitcnt lgkmcnt(12)
  v_mfma_f32_16x16x32_bf16 v[84:87], v[104:107], v[44:47], 0
  ds_read_b64_tr_b16 v[104:105], v25 offset:768
  ds_read_b64_tr_b16 v[106:107], v25 offset:960
  v_mfma_f32_16x16x32_bf16 v[196:199], a[40:43], v[116:119], v[196:199]
  s_waitcnt lgkmcnt(12)
  v_mfma_f32_16x16x32_bf16 v[64:67], v[108:111], v[48:51], v[64:67]
  ds_read_b64_tr_b16 v[108:109], v25 offset:776
  ds_read_b64_tr_b16 v[110:111], v25 offset:968
  s_waitcnt lgkmcnt(12)
  v_mfma_f32_16x16x32_bf16 v[68:71], a[240:243], v[48:51], v[68:71]
  ds_read_b64_tr_b16 a[240:241], v25 offset:784
  ds_read_b64_tr_b16 a[242:243], v25 offset:976
  v_mfma_f32_16x16x32_bf16 v[200:203], a[44:47], v[116:119], v[200:203]
  buffer_load_dwordx4 v12, s[36:39], s21 offen offset:3072 sc1 lds
  s_waitcnt lgkmcnt(12)
  v_mfma_f32_16x16x32_bf16 v[72:75], a[244:247], v[48:51], v[72:75]
  ds_read_b64_tr_b16 a[244:245], v25 offset:792
  ds_read_b64_tr_b16 a[246:247], v25 offset:984
  s_waitcnt lgkmcnt(12)
  v_mfma_f32_16x16x32_bf16 v[76:79], a[248:251], v[48:51], v[76:79]
  ds_read_b64_tr_b16 a[248:249], v25 offset:800
  ds_read_b64_tr_b16 a[250:251], v25 offset:992
  v_mfma_f32_16x16x32_bf16 v[204:207], a[48:51], v[116:119], v[204:207]
  s_waitcnt lgkmcnt(12)
  v_mfma_f32_16x16x32_bf16 v[80:83], a[252:255], v[48:51], v[80:83]
  ds_read_b64_tr_b16 a[252:253], v25 offset:808
  ds_read_b64_tr_b16 a[254:255], v25 offset:1000
  s_waitcnt lgkmcnt(12)
  v_mfma_f32_16x16x32_bf16 v[84:87], v[100:103], v[48:51], v[84:87]
  ds_read_b64_tr_b16 v[100:101], v25 offset:1152
  ds_read_b64_tr_b16 v[102:103], v25 offset:1344
  v_mfma_f32_16x16x32_bf16 v[208:211], a[52:55], v[116:119], v[208:211]
  s_add_u32 m0, s67, 106496
  s_nop 0
  buffer_load_dwordx4 v13, s[36:39], s21 offen offset:0 sc1 lds
  s_waitcnt lgkmcnt(12)
  v_mfma_f32_16x16x32_bf16 v[64:67], v[104:107], v[52:55], v[64:67]
  ds_read_b64_tr_b16 v[104:105], v25 offset:1160
  ds_read_b64_tr_b16 v[106:107], v25 offset:1352
  s_waitcnt lgkmcnt(12)
  v_mfma_f32_16x16x32_bf16 v[68:71], v[108:111], v[52:55], v[68:71]
  ds_read_b64_tr_b16 v[108:109], v25 offset:1168
  ds_read_b64_tr_b16 v[110:111], v25 offset:1360
  v_mfma_f32_16x16x32_bf16 v[212:215], a[56:59], v[116:119], v[212:215]
  buffer_load_dwordx4 v[116:119], v17, s[36:39], s7 offen sc1
  s_waitcnt lgkmcnt(12)
  v_mfma_f32_16x16x32_bf16 v[72:75], a[240:243], v[52:55], v[72:75]
  ds_read_b64_tr_b16 a[240:241], v25 offset:1176
  ds_read_b64_tr_b16 a[242:243], v25 offset:1368
  s_waitcnt lgkmcnt(12)
  v_mfma_f32_16x16x32_bf16 v[76:79], a[244:247], v[52:55], v[76:79]
  ds_read_b64_tr_b16 a[244:245], v25 offset:1184
  ds_read_b64_tr_b16 a[246:247], v25 offset:1376
  v_mfma_f32_16x16x32_bf16 v[216:219], a[40:43], v[120:123], v[216:219]
  s_add_u32 m0, s67, 122880
  s_add_u32 s21, s23, 20480
  buffer_load_dwordx4 v12, s[36:39], s21 offen offset:0 sc1 lds
  s_waitcnt lgkmcnt(12)
  v_mfma_f32_16x16x32_bf16 v[80:83], a[248:251], v[52:55], v[80:83]
  ds_read_b64_tr_b16 a[248:249], v25 offset:1192
  ds_read_b64_tr_b16 a[250:251], v25 offset:1384
  s_waitcnt lgkmcnt(12)
  v_mfma_f32_16x16x32_bf16 v[84:87], a[252:255], v[52:55], v[84:87]
  ds_read_b64_tr_b16 a[252:253], v25 offset:1536
  ds_read_b64_tr_b16 a[254:255], v25 offset:1728
  v_mfma_f32_16x16x32_bf16 v[220:223], a[44:47], v[120:123], v[220:223]
  s_waitcnt lgkmcnt(12)
  v_mfma_f32_16x16x32_bf16 v[64:67], v[100:103], v[56:59], v[64:67]
  ds_read_b64_tr_b16 v[100:101], v25 offset:1544
  ds_read_b64_tr_b16 v[102:103], v25 offset:1736
  s_waitcnt lgkmcnt(12)
  v_mfma_f32_16x16x32_bf16 v[68:71], v[104:107], v[56:59], v[68:71]
  ds_read_b64_tr_b16 v[104:105], v25 offset:1552
  ds_read_b64_tr_b16 v[106:107], v25 offset:1744
  v_mfma_f32_16x16x32_bf16 v[224:227], a[48:51], v[120:123], v[224:227]
  buffer_load_dwordx4 v12, s[36:39], s21 offen offset:1024 sc1 lds
  s_waitcnt lgkmcnt(12)
  v_mfma_f32_16x16x32_bf16 v[72:75], v[108:111], v[56:59], v[72:75]
  ds_read_b64_tr_b16 v[108:109], v25 offset:1560
  ds_read_b64_tr_b16 v[110:111], v25 offset:1752
  s_waitcnt lgkmcnt(12)
  v_mfma_f32_16x16x32_bf16 v[76:79], a[240:243], v[56:59], v[76:79]
  ds_read_b64_tr_b16 a[240:241], v25 offset:1568
  v_mfma_f32_16x16x32_bf16 v[228:231], a[52:55], v[120:123], v[228:231]
  ds_read_b64_tr_b16 a[242:243], v25 offset:1760
  s_waitcnt lgkmcnt(12)
  v_mfma_f32_16x16x32_bf16 v[80:83], a[244:247], v[56:59], v[80:83]
  ds_read_b64_tr_b16 a[244:245], v25 offset:1576
  ds_read_b64_tr_b16 a[246:247], v25 offset:1768
  s_waitcnt lgkmcnt(12)
  v_mfma_f32_16x16x32_bf16 v[84:87], a[248:251], v[56:59], v[84:87]
  v_mfma_f32_16x16x32_bf16 v[232:235], a[56:59], v[120:123], v[232:235]
  buffer_load_dwordx4 v12, s[36:39], s21 offen offset:2048 sc1 lds
  buffer_load_dwordx4 v[120:123], v18, s[36:39], s7 offen sc1
  s_waitcnt lgkmcnt(10)
  v_mfma_f32_16x16x32_bf16 v[64:67], a[252:255], v[60:63], v[64:67]
  s_waitcnt lgkmcnt(8)
  v_mfma_f32_16x16x32_bf16 v[68:71], v[100:103], v[60:63], v[68:71]
  s_waitcnt lgkmcnt(6)
  v_mfma_f32_16x16x32_bf16 v[72:75], v[104:107], v[60:63], v[72:75]
  s_waitcnt lgkmcnt(4)
  v_mfma_f32_16x16x32_bf16 v[76:79], v[108:111], v[60:63], v[76:79]
  v_mfma_f32_16x16x32_bf16 v[236:239], a[40:43], v[124:127], v[236:239]
  s_waitcnt lgkmcnt(2)
  v_mfma_f32_16x16x32_bf16 v[80:83], a[240:243], v[60:63], v[80:83]
  s_waitcnt lgkmcnt(0)
  v_mfma_f32_16x16x32_bf16 v[84:87], a[244:247], v[60:63], v[84:87]
  s_nop 7
  v_add_f32 v1, 0x358637bd, v84
  v_rcp_f32 v1, v1
  s_nop 0
  v_mul_f32 v1, 0x3fb8aa3b, v1
  v_mfma_f32_16x16x32_bf16 v[240:243], a[44:47], v[124:127], v[240:243]
  buffer_load_dwordx4 v12, s[36:39], s21 offen offset:3072 sc1 lds
  v_mul_f32 v64, v64, v1
  v_mul_f32 v65, v65, v1
  v_cvt_pk_bf16_f32 v64, v64, v65
  v_mul_f32 v66, v66, v1
  v_mul_f32 v67, v67, v1
  v_cvt_pk_bf16_f32 v65, v66, v67
  v_mul_f32 v68, v68, v1
  v_mul_f32 v69, v69, v1
  v_mfma_f32_16x16x32_bf16 v[244:247], a[48:51], v[124:127], v[244:247]
  v_cvt_pk_bf16_f32 v66, v68, v69
  v_mul_f32 v70, v70, v1
  v_mul_f32 v71, v71, v1
  v_cvt_pk_bf16_f32 v67, v70, v71
  v_mul_f32 v72, v72, v1
  v_mul_f32 v73, v73, v1
  v_cvt_pk_bf16_f32 v68, v72, v73
  v_mul_f32 v74, v74, v1
  v_mfma_f32_16x16x32_bf16 v[248:251], a[52:55], v[124:127], v[248:251]
  s_add_u32 m0, s67, 126976
  s_nop 0
  buffer_load_dwordx4 v13, s[36:39], s21 offen offset:0 sc1 lds
  v_mul_f32 v75, v75, v1
  v_cvt_pk_bf16_f32 v69, v74, v75
  v_mul_f32 v76, v76, v1
  v_mul_f32 v77, v77, v1
  v_cvt_pk_bf16_f32 v70, v76, v77
  v_mul_f32 v78, v78, v1
  v_mul_f32 v79, v79, v1
  v_cvt_pk_bf16_f32 v71, v78, v79
  v_mfma_f32_16x16x32_bf16 v[252:255], a[56:59], v[124:127], v[252:255]
  buffer_load_dwordx4 v[124:127], v19, s[36:39], s7 offen sc1
  v_mul_f32 v80, v80, v1
  v_mul_f32 v81, v81, v1
  v_cvt_pk_bf16_f32 v72, v80, v81
  v_mul_f32 v82, v82, v1
  v_mul_f32 v83, v83, v1
  v_cvt_pk_bf16_f32 v73, v82, v83
  buffer_store_dwordx4 v[64:67], v12, s[36:39], s70 offen sc1
  buffer_store_dwordx4 v[68:71], v12, s[36:39], s70 offen offset:1024 sc1
  buffer_store_dwordx2 v[72:73], v23, s[36:39], s69 offen sc1
  v_mfma_f32_16x16x32_bf16 v[176:179], a[60:63], v[128:131], v[176:179]
  ds_read_b128 a[0:3], v12 offset:0
  s_and_b32 s0, s62, 7
  s_lshl_b32 s0, s0, 5
  v_mfma_f32_16x16x32_bf16 v[180:183], a[64:67], v[128:131], v[180:183]
  ds_read_b128 a[4:7], v12 offset:1024
  s_lshr_b32 s1, s62, 3
  s_lshl_b32 s1, s1, 1
  v_mfma_f32_16x16x32_bf16 v[184:187], a[68:71], v[128:131], v[184:187]
  v_bfe_u32 v1, v0, 1, 2
  v_and_b32 v2, 1, v0
  v_mfma_f32_16x16x32_bf16 v[188:191], a[72:75], v[128:131], v[188:191]
  ds_read_b128 a[8:11], v12 offset:2048
  v_lshl_add_u32 v1, v1, 3, v2
  s_add_u32 s0, s0, s1
  v_mfma_f32_16x16x32_bf16 v[192:195], a[76:79], v[128:131], v[192:195]
  s_add_u32 s7, s7, 4096
  buffer_load_dwordx4 v[128:131], v16, s[36:39], s7 offen sc1
  s_lshl_b32 s0, s0, 8
  s_add_u32 s0, s0, 4096
  v_mfma_f32_16x16x32_bf16 v[196:199], a[60:63], v[132:135], v[196:199]
  ds_read_b128 a[12:15], v12 offset:3072
  v_lshl_add_u32 v11, v1, 8, s0
  v_and_b32 v1, 15, v0
  v_mfma_f32_16x16x32_bf16 v[200:203], a[64:67], v[132:135], v[200:203]
  ds_read_b128 a[16:19], v12 offset:4096
  s_lshl_b32 s68, s3, 4
  v_add_u32 v1, s68, v1
  v_mfma_f32_16x16x32_bf16 v[204:207], a[68:71], v[132:135], v[204:207]
  v_mul_u32_u24 v1, 1280, v1
  v_lshrrev_b32 v2, 4, v0
  v_mfma_f32_16x16x32_bf16 v[208:211], a[72:75], v[132:135], v[208:211]
  ds_read_b128 a[20:23], v12 offset:5120
  v_lshl_add_u32 v26, v2, 4, v1
  v_lshl_add_u32 v27, v2, 3, v1
  v_mfma_f32_16x16x32_bf16 v[212:215], a[76:79], v[132:135], v[212:215]
  buffer_load_dwordx4 v[132:135], v17, s[36:39], s7 offen sc1
  s_mul_i32 s65, s62, 81920
  s_mul_i32 s68, s63, 160
  v_mfma_f32_16x16x32_bf16 v[216:219], a[60:63], v[136:139], v[216:219]
  ds_read_b128 a[24:27], v12 offset:6144
  s_add_u32 s65, s65, s68
  s_add_u32 s68, s3, 1
  v_mfma_f32_16x16x32_bf16 v[220:223], a[64:67], v[136:139], v[220:223]
  ds_read_b128 a[28:31], v12 offset:7168
  s_and_b32 s68, s68, 3
  s_mul_i32 s68, s68, 15360
  v_mfma_f32_16x16x32_bf16 v[224:227], a[68:71], v[136:139], v[224:227]
  s_add_u32 s68, s68, 0
  v_add_u32 v28, s68, v12
  v_mfma_f32_16x16x32_bf16 v[228:231], a[72:75], v[136:139], v[228:231]
  ds_read_b128 a[32:35], v12 offset:8192
  s_add_u32 s68, s3, 2
  s_and_b32 s68, s68, 3
  v_mfma_f32_16x16x32_bf16 v[232:235], a[76:79], v[136:139], v[232:235]
  buffer_load_dwordx4 v[136:139], v18, s[36:39], s7 offen sc1
  s_mul_i32 s68, s68, 15360
  s_add_u32 s68, s68, 5120
  v_mfma_f32_16x16x32_bf16 v[236:239], a[60:63], v[140:143], v[236:239]
  ds_read_b128 a[36:39], v12 offset:9216
  v_add_u32 v29, s68, v12
  s_add_u32 s68, s3, 3
  v_mfma_f32_16x16x32_bf16 v[240:243], a[64:67], v[140:143], v[240:243]
  s_and_b32 s68, s68, 3
  s_mul_i32 s68, s68, 15360
  v_mfma_f32_16x16x32_bf16 v[244:247], a[68:71], v[140:143], v[244:247]
  s_add_u32 s68, s68, 10240
  v_add_u32 v30, s68, v12
  v_mfma_f32_16x16x32_bf16 v[248:251], a[72:75], v[140:143], v[248:251]
  s_mul_i32 s68, s3, 15360
  v_add_u32 v31, s68, v12
  v_mfma_f32_16x16x32_bf16 v[252:255], a[76:79], v[140:143], v[252:255]
  buffer_load_dwordx4 v[140:143], v19, s[36:39], s7 offen sc1
  buffer_load_dwordx4 v[88:91], v26, s[24:27], s65 offen
  buffer_load_dwordx4 v[92:95], v26, s[24:27], s65 offen offset:64
  s_waitcnt vmcnt(6)
  s_barrier
  s_add_u32 s18, s64, 5
  v_mov_b32 v14, s18
  buffer_store_dword v14, v9, s[36:39], 0 offen sc1
  v_mfma_f32_16x16x32_bf16 v[176:179], a[80:83], v[144:147], v[176:179]
  ds_read_b128 a[40:43], v12 offset:10240
  buffer_load_dwordx2 v[96:97], v27, s[24:27], s65 offen offset:128
  v_mfma_f32_16x16x32_bf16 v[180:183], a[84:87], v[144:147], v[180:183]
  ds_read_b128 a[44:47], v12 offset:11264
  v_mfma_f32_16x16x32_bf16 v[184:187], a[88:91], v[144:147], v[184:187]
  v_mfma_f32_16x16x32_bf16 v[188:191], a[92:95], v[144:147], v[188:191]
  ds_read_b128 a[48:51], v12 offset:12288
  v_mfma_f32_16x16x32_bf16 v[192:195], a[96:99], v[144:147], v[192:195]
  s_add_u32 s7, s7, 4096
  buffer_load_dwordx4 v[144:147], v16, s[36:39], s7 offen sc1
  v_mfma_f32_16x16x32_bf16 v[196:199], a[80:83], v[148:151], v[196:199]
  ds_read_b128 a[52:55], v12 offset:13312
  v_mfma_f32_16x16x32_bf16 v[200:203], a[84:87], v[148:151], v[200:203]
  v_mfma_f32_16x16x32_bf16 v[204:207], a[88:91], v[148:151], v[204:207]
  ds_read_b128 a[56:59], v12 offset:14336
  v_mfma_f32_16x16x32_bf16 v[208:211], a[92:95], v[148:151], v[208:211]
  v_mfma_f32_16x16x32_bf16 v[212:215], a[96:99], v[148:151], v[212:215]
  ds_read_b128 a[60:63], v12 offset:15360
  buffer_load_dwordx4 v[148:151], v17, s[36:39], s7 offen sc1
  v_mfma_f32_16x16x32_bf16 v[216:219], a[80:83], v[152:155], v[216:219]
  v_mfma_f32_16x16x32_bf16 v[220:223], a[84:87], v[152:155], v[220:223]
  ds_read_b128 a[64:67], v12 offset:16384
  v_mfma_f32_16x16x32_bf16 v[224:227], a[88:91], v[152:155], v[224:227]
  v_mfma_f32_16x16x32_bf16 v[228:231], a[92:95], v[152:155], v[228:231]
  ds_read_b128 a[68:71], v12 offset:17408
  v_mfma_f32_16x16x32_bf16 v[232:235], a[96:99], v[152:155], v[232:235]
  buffer_load_dwordx4 v[152:155], v18, s[36:39], s7 offen sc1
  v_mfma_f32_16x16x32_bf16 v[236:239], a[80:83], v[156:159], v[236:239]
  ds_read_b128 a[72:75], v12 offset:18432
  v_mfma_f32_16x16x32_bf16 v[240:243], a[84:87], v[156:159], v[240:243]
  v_mfma_f32_16x16x32_bf16 v[244:247], a[88:91], v[156:159], v[244:247]
  v_mfma_f32_16x16x32_bf16 v[248:251], a[92:95], v[156:159], v[248:251]
  v_mfma_f32_16x16x32_bf16 v[252:255], a[96:99], v[156:159], v[252:255]
  buffer_load_dwordx4 v[156:159], v19, s[36:39], s7 offen sc1
  v_mfma_f32_16x16x32_bf16 v[176:179], a[100:103], v[160:163], v[176:179]
  ds_read_b128 a[76:79], v12 offset:19456
  v_mfma_f32_16x16x32_bf16 v[180:183], a[104:107], v[160:163], v[180:183]
  ds_read_b128 a[80:83], v36 offset:0
  v_mfma_f32_16x16x32_bf16 v[184:187], a[108:111], v[160:163], v[184:187]
  v_mfma_f32_16x16x32_bf16 v[188:191], a[112:115], v[160:163], v[188:191]
  ds_read_b128 a[84:87], v36 offset:1024
  v_mfma_f32_16x16x32_bf16 v[192:195], a[116:119], v[160:163], v[192:195]
  s_add_u32 s7, s7, 4096
  buffer_load_dwordx4 v[160:163], v16, s[36:39], s7 offen sc1
  v_mfma_f32_16x16x32_bf16 v[196:199], a[100:103], v[164:167], v[196:199]
  ds_read_b128 a[88:91], v36 offset:2048
  v_mfma_f32_16x16x32_bf16 v[200:203], a[104:107], v[164:167], v[200:203]
  v_mfma_f32_16x16x32_bf16 v[204:207], a[108:111], v[164:167], v[204:207]
  ds_read_b128 a[92:95], v36 offset:3072
  v_mfma_f32_16x16x32_bf16 v[208:211], a[112:115], v[164:167], v[208:211]
  v_mfma_f32_16x16x32_bf16 v[212:215], a[116:119], v[164:167], v[212:215]
  ds_read_b128 a[96:99], v36 offset:4096
  buffer_load_dwordx4 v[164:167], v17, s[36:39], s7 offen sc1
  v_mfma_f32_16x16x32_bf16 v[216:219], a[100:103], v[168:171], v[216:219]
  v_mfma_f32_16x16x32_bf16 v[220:223], a[104:107], v[168:171], v[220:223]
  ds_read_b128 a[240:243], v36 offset:25600
  v_mfma_f32_16x16x32_bf16 v[224:227], a[108:111], v[168:171], v[224:227]
  v_mfma_f32_16x16x32_bf16 v[228:231], a[112:115], v[168:171], v[228:231]
  ds_read_b128 a[244:247], v36 offset:26624
  v_mfma_f32_16x16x32_bf16 v[232:235], a[116:119], v[168:171], v[232:235]
  buffer_load_dwordx4 v[168:171], v18, s[36:39], s7 offen sc1
  v_mfma_f32_16x16x32_bf16 v[236:239], a[100:103], v[172:175], v[236:239]
  ds_read_b128 a[248:251], v36 offset:27648
  v_mfma_f32_16x16x32_bf16 v[240:243], a[104:107], v[172:175], v[240:243]
  v_mfma_f32_16x16x32_bf16 v[244:247], a[108:111], v[172:175], v[244:247]
  v_mfma_f32_16x16x32_bf16 v[248:251], a[112:115], v[172:175], v[248:251]
  v_mfma_f32_16x16x32_bf16 v[252:255], a[116:119], v[172:175], v[252:255]
  buffer_load_dwordx4 v[172:175], v19, s[36:39], s7 offen sc1
  buffer_load_dword v10, v11, s[36:39], 0 offen sc1
  v_mfma_f32_16x16x32_bf16 v[176:179], a[120:123], v[112:115], v[176:179]
  ds_read_b128 a[100:103], v36 offset:5120
  v_mfma_f32_16x16x32_bf16 v[180:183], a[124:127], v[112:115], v[180:183]
  ds_read_b128 a[104:107], v36 offset:6144
  v_mfma_f32_16x16x32_bf16 v[184:187], a[128:131], v[112:115], v[184:187]
  v_mfma_f32_16x16x32_bf16 v[188:191], a[132:135], v[112:115], v[188:191]
  ds_read_b128 a[108:111], v36 offset:7168
  v_mfma_f32_16x16x32_bf16 v[192:195], a[136:139], v[112:115], v[192:195]
  s_add_u32 s7, s7, 4096
  buffer_load_dwordx4 v[112:115], v16, s[36:39], s7 offen sc1
  v_mfma_f32_16x16x32_bf16 v[196:199], a[120:123], v[116:119], v[196:199]
  ds_read_b128 a[112:115], v36 offset:8192
  v_mfma_f32_16x16x32_bf16 v[200:203], a[124:127], v[116:119], v[200:203]
  v_mfma_f32_16x16x32_bf16 v[204:207], a[128:131], v[116:119], v[204:207]
  ds_read_b128 a[116:119], v36 offset:9216
  v_mfma_f32_16x16x32_bf16 v[208:211], a[132:135], v[116:119], v[208:211]
  v_mfma_f32_16x16x32_bf16 v[212:215], a[136:139], v[116:119], v[212:215]
  ds_read_b128 a[252:255], v36 offset:28672
  buffer_load_dwordx4 v[116:119], v17, s[36:39], s7 offen sc1
  v_mfma_f32_16x16x32_bf16 v[216:219], a[120:123], v[120:123], v[216:219]
  v_mfma_f32_16x16x32_bf16 v[220:223], a[124:127], v[120:123], v[220:223]
  ds_read_b128 v[100:103], v36 offset:29696
  v_mfma_f32_16x16x32_bf16 v[224:227], a[128:131], v[120:123], v[224:227]
  v_mfma_f32_16x16x32_bf16 v[228:231], a[132:135], v[120:123], v[228:231]
  ds_read_b128 v[104:107], v36 offset:30720
  v_mfma_f32_16x16x32_bf16 v[232:235], a[136:139], v[120:123], v[232:235]
  buffer_load_dwordx4 v[120:123], v18, s[36:39], s7 offen sc1
  v_mfma_f32_16x16x32_bf16 v[236:239], a[120:123], v[124:127], v[236:239]
  ds_read_b128 v[108:111], v36 offset:31744
  v_mfma_f32_16x16x32_bf16 v[240:243], a[124:127], v[124:127], v[240:243]
  v_mfma_f32_16x16x32_bf16 v[244:247], a[128:131], v[124:127], v[244:247]
  v_mfma_f32_16x16x32_bf16 v[248:251], a[132:135], v[124:127], v[248:251]
  v_mfma_f32_16x16x32_bf16 v[252:255], a[136:139], v[124:127], v[252:255]
  buffer_load_dwordx4 v[124:127], v19, s[36:39], s7 offen sc1
  s_waitcnt vmcnt(20)
  v_mfma_f32_16x16x32_bf16 v[176:179], a[140:143], v[128:131], v[176:179]
  ds_read_b128 a[120:123], v36 offset:10240
  s_waitcnt vmcnt(16)
  v_and_b32 v32, 0xffff0000, v88
  v_mfma_f32_16x16x32_bf16 v[180:183], a[144:147], v[128:131], v[180:183]
  ds_read_b128 a[124:127], v36 offset:11264
  v_lshlrev_b32 v88, 16, v88
  v_mfma_f32_16x16x32_bf16 v[184:187], a[148:151], v[128:131], v[184:187]
  v_and_b32 v33, 0xffff0000, v89
  v_mfma_f32_16x16x32_bf16 v[188:191], a[152:155], v[128:131], v[188:191]
  ds_read_b128 a[128:131], v36 offset:12288
  v_lshlrev_b32 v89, 16, v89
  v_mfma_f32_16x16x32_bf16 v[192:195], a[156:159], v[128:131], v[192:195]
  v_and_b32 v34, 0xffff0000, v90
  s_add_u32 s7, s7, 4096
  s_cmp_lt_u32 s3, 2
  s_cselect_b32 s7, s7, 0x40000000
  buffer_load_dwordx4 v[128:131], v16, s[36:39], s7 offen sc1
  v_mfma_f32_16x16x32_bf16 v[196:199], a[140:143], v[132:135], v[196:199]
  ds_read_b128 a[132:135], v36 offset:13312
  v_lshlrev_b32 v90, 16, v90
  v_mfma_f32_16x16x32_bf16 v[200:203], a[144:147], v[132:135], v[200:203]
  v_and_b32 v35, 0xffff0000, v91
  v_mfma_f32_16x16x32_bf16 v[204:207], a[148:151], v[132:135], v[204:207]
  ds_read_b128 a[136:139], v36 offset:14336
  v_lshlrev_b32 v91, 16, v91
  v_mfma_f32_16x16x32_bf16 v[208:211], a[152:155], v[132:135], v[208:211]
  s_waitcnt vmcnt(16)
  v_and_b32 v20, 0xffff0000, v92
  v_mfma_f32_16x16x32_bf16 v[212:215], a[156:159], v[132:135], v[212:215]
  ds_read_b128 v[40:43], v36 offset:32768
  v_lshlrev_b32 v92, 16, v92
  buffer_load_dwordx4 v[132:135], v17, s[36:39], s7 offen sc1
  v_mfma_f32_16x16x32_bf16 v[216:219], a[140:143], v[136:139], v[216:219]
  v_and_b32 v21, 0xffff0000, v93
  v_mfma_f32_16x16x32_bf16 v[220:223], a[144:147], v[136:139], v[220:223]
  ds_read_b128 v[80:83], v36 offset:33792
  v_lshlrev_b32 v93, 16, v93
  v_mfma_f32_16x16x32_bf16 v[224:227], a[148:151], v[136:139], v[224:227]
  v_and_b32 v22, 0xffff0000, v94
  v_mfma_f32_16x16x32_bf16 v[228:231], a[152:155], v[136:139], v[228:231]
  ds_read_b128 v[84:87], v36 offset:34816
  v_lshlrev_b32 v94, 16, v94
  v_mfma_f32_16x16x32_bf16 v[232:235], a[156:159], v[136:139], v[232:235]
  v_and_b32 v23, 0xffff0000, v95
  buffer_load_dwordx4 v[136:139], v18, s[36:39], s7 offen sc1
  v_mfma_f32_16x16x32_bf16 v[236:239], a[140:143], v[140:143], v[236:239]
  ds_read_b128 v[44:47], v36 offset:35840
  v_lshlrev_b32 v95, 16, v95
  v_mfma_f32_16x16x32_bf16 v[240:243], a[144:147], v[140:143], v[240:243]
  s_waitcnt vmcnt(16)
  v_and_b32 v98, 0xffff0000, v96
  v_mfma_f32_16x16x32_bf16 v[244:247], a[148:151], v[140:143], v[244:247]
  v_lshlrev_b32 v96, 16, v96
  v_mfma_f32_16x16x32_bf16 v[248:251], a[152:155], v[140:143], v[248:251]
  v_and_b32 v99, 0xffff0000, v97
  v_mfma_f32_16x16x32_bf16 v[252:255], a[156:159], v[140:143], v[252:255]
  v_lshlrev_b32 v97, 16, v97
  buffer_load_dwordx4 v[140:143], v19, s[36:39], s7 offen sc1
  s_waitcnt vmcnt(16)
  v_mfma_f32_16x16x32_bf16 v[176:179], a[160:163], v[144:147], v[176:179]
  ds_read_b128 a[140:143], v36 offset:15360
  v_mfma_f32_16x16x32_bf16 v[180:183], a[164:167], v[144:147], v[180:183]
  ds_read_b128 a[144:147], v36 offset:16384
  v_mfma_f32_16x16x32_bf16 v[184:187], a[168:171], v[144:147], v[184:187]
  v_mfma_f32_16x16x32_bf16 v[188:191], a[172:175], v[144:147], v[188:191]
  ds_read_b128 a[148:151], v36 offset:17408
  v_mfma_f32_16x16x32_bf16 v[192:195], a[176:179], v[144:147], v[192:195]
  s_waitcnt vmcnt(15)
  v_mfma_f32_16x16x32_bf16 v[196:199], a[160:163], v[148:151], v[196:199]
  ds_read_b128 a[152:155], v36 offset:18432
  v_mfma_f32_16x16x32_bf16 v[200:203], a[164:167], v[148:151], v[200:203]
  v_mfma_f32_16x16x32_bf16 v[204:207], a[168:171], v[148:151], v[204:207]
  ds_read_b128 a[156:159], v36 offset:19456
  v_mfma_f32_16x16x32_bf16 v[208:211], a[172:175], v[148:151], v[208:211]
  v_mfma_f32_16x16x32_bf16 v[212:215], a[176:179], v[148:151], v[212:215]
  ds_read_b128 v[48:51], v36 offset:36864
  s_waitcnt vmcnt(14)
  v_mfma_f32_16x16x32_bf16 v[216:219], a[160:163], v[152:155], v[216:219]
  v_mfma_f32_16x16x32_bf16 v[220:223], a[164:167], v[152:155], v[220:223]
  ds_read_b128 v[52:55], v36 offset:37888
  v_mfma_f32_16x16x32_bf16 v[224:227], a[168:171], v[152:155], v[224:227]
  v_mfma_f32_16x16x32_bf16 v[228:231], a[172:175], v[152:155], v[228:231]
  ds_read_b128 v[56:59], v36 offset:38912
  v_mfma_f32_16x16x32_bf16 v[232:235], a[176:179], v[152:155], v[232:235]
  s_waitcnt vmcnt(13)
  v_mfma_f32_16x16x32_bf16 v[236:239], a[160:163], v[156:159], v[236:239]
  ds_read_b128 v[60:63], v36 offset:39936
  v_mfma_f32_16x16x32_bf16 v[240:243], a[164:167], v[156:159], v[240:243]
  v_mfma_f32_16x16x32_bf16 v[244:247], a[168:171], v[156:159], v[244:247]
  v_mfma_f32_16x16x32_bf16 v[248:251], a[172:175], v[156:159], v[248:251]
  v_mfma_f32_16x16x32_bf16 v[252:255], a[176:179], v[156:159], v[252:255]
  s_add_u32 s7, s9, 55296
  v_add_u32 v17, 5120, v16
  v_add_u32 v18, 10240, v16
  v_add_u32 v19, 15360, v16
  s_add_u32 s18, s64, 5
  s_waitcnt vmcnt(8)
  v_subrev_u32 v14, s18, v10
  v_cmp_gt_u32_e64 s[100:101], 8, v14
  s_nop 0
  s_cmp_eq_u64 s[100:101], -1
  s_cbranch_scc0 f_spin7
f_back7:
  s_add_u32 s19, s7, 4096
  buffer_load_dwordx4 v[64:67], v16, s[36:39], s7 offen offset:0 sc1
  buffer_load_dwordx4 v[68:71], v17, s[36:39], s7 offen offset:0 sc1
  s_waitcnt lgkmcnt(0)
  s_barrier
  v_mfma_f32_16x16x32_bf16 v[196:199], a[180:183], v[164:167], v[196:199]
  ds_read_b128 a[160:163], v36 offset:20480
  v_mfma_f32_16x16x32_bf16 v[200:203], a[184:187], v[164:167], v[200:203]
  v_mfma_f32_16x16x32_bf16 v[204:207], a[188:191], v[164:167], v[204:207]
  v_mfma_f32_16x16x32_bf16 v[208:211], a[192:195], v[164:167], v[208:211]
  buffer_load_dwordx4 v[72:75], v18, s[36:39], s7 offen offset:0 sc1
  ds_read_b128 a[164:167], v36 offset:21504
  v_mfma_f32_16x16x32_bf16 v[212:215], a[196:199], v[164:167], v[212:215]
  s_waitcnt vmcnt(9)
  v_mfma_f32_16x16x32_bf16 v[196:199], a[200:203], v[116:119], v[196:199]
  v_mfma_f32_16x16x32_bf16 v[200:203], a[204:207], v[116:119], v[200:203]
  ds_read_b128 a[168:171], v36 offset:22528
  v_mfma_f32_16x16x32_bf16 v[204:207], a[208:211], v[116:119], v[204:207]
  buffer_load_dwordx4 v[76:79], v19, s[36:39], s7 offen offset:0 sc1
  v_mfma_f32_16x16x32_bf16 v[208:211], a[212:215], v[116:119], v[208:211]
  v_mfma_f32_16x16x32_bf16 v[212:215], a[216:219], v[116:119], v[212:215]
  ds_read_b128 a[172:175], v36 offset:23552
  s_waitcnt vmcnt(6)
  v_mfma_f32_16x16x32_bf16 v[196:199], a[220:223], v[132:135], v[196:199]
  v_mfma_f32_16x16x32_bf16 v[200:203], a[224:227], v[132:135], v[200:203]
  buffer_load_dwordx4 v[144:147], v16, s[36:39], s7 offen offset:1024 sc1
  v_mfma_f32_16x16x32_bf16 v[204:207], a[228:231], v[132:135], v[204:207]
  ds_read_b128 a[176:179], v36 offset:24576
  v_mfma_f32_16x16x32_bf16 v[208:211], a[232:235], v[132:135], v[208:211]
  v_mfma_f32_16x16x32_bf16 v[212:215], a[236:239], v[132:135], v[212:215]
  v_mfma_f32_16x16x32_bf16 v[216:219], a[180:183], v[168:171], v[216:219]
  buffer_load_dwordx4 v[148:151], v17, s[36:39], s7 offen offset:1024 sc1
  v_mfma_f32_16x16x32_bf16 v[220:223], a[184:187], v[168:171], v[220:223]
  v_mfma_f32_16x16x32_bf16 v[224:227], a[188:191], v[168:171], v[224:227]
  ds_write_b128 v28, v[196:199] offset:0
  v_mfma_f32_16x16x32_bf16 v[228:231], a[192:195], v[168:171], v[228:231]
  v_mfma_f32_16x16x32_bf16 v[232:235], a[196:199], v[168:171], v[232:235]
  buffer_load_dwordx4 v[152:155], v18, s[36:39], s7 offen offset:1024 sc1
  v_mfma_f32_16x16x32_bf16 v[216:219], a[200:203], v[120:123], v[216:219]
  ds_write_b128 v28, v[200:203] offset:1024
  v_mfma_f32_16x16x32_bf16 v[220:223], a[204:207], v[120:123], v[220:223]
  v_mfma_f32_16x16x32_bf16 v[224:227], a[208:211], v[120:123], v[224:227]
  v_mfma_f32_16x16x32_bf16 v[228:231], a[212:215], v[120:123], v[228:231]
  buffer_load_dwordx4 v[156:159], v19, s[36:39], s7 offen offset:1024 sc1
  ds_write_b128 v28, v[204:207] offset:2048
  v_mfma_f32_16x16x32_bf16 v[232:235], a[216:219], v[120:123], v[232:235]
  s_waitcnt vmcnt(9)
  v_mfma_f32_16x16x32_bf16 v[216:219], a[220:223], v[136:139], v[216:219]
  v_mfma_f32_16x16x32_bf16 v[220:223], a[224:227], v[136:139], v[220:223]
  ds_write_b128 v28, v[208:211] offset:3072
  v_mfma_f32_16x16x32_bf16 v[224:227], a[228:231], v[136:139], v[224:227]
  buffer_load_dwordx4 v[164:167], v16, s[36:39], s7 offen offset:2048 sc1
  v_mfma_f32_16x16x32_bf16 v[228:231], a[232:235], v[136:139], v[228:231]
  v_mfma_f32_16x16x32_bf16 v[232:235], a[236:239], v[136:139], v[232:235]
  ds_write_b128 v28, v[212:215] offset:4096
  v_mfma_f32_16x16x32_bf16 v[236:239], a[180:183], v[172:175], v[236:239]
  v_mfma_f32_16x16x32_bf16 v[240:243], a[184:187], v[172:175], v[240:243]
  buffer_load_dwordx4 v[116:119], v17, s[36:39], s7 offen offset:2048 sc1
  v_mfma_f32_16x16x32_bf16 v[244:247], a[188:191], v[172:175], v[244:247]
  ds_write_b128 v29, v[216:219] offset:0
  v_mfma_f32_16x16x32_bf16 v[248:251], a[192:195], v[172:175], v[248:251]
  v_mfma_f32_16x16x32_bf16 v[252:255], a[196:199], v[172:175], v[252:255]
  v_mfma_f32_16x16x32_bf16 v[236:239], a[200:203], v[124:127], v[236:239]
  buffer_load_dwordx4 v[132:135], v18, s[36:39], s7 offen offset:2048 sc1
  ds_write_b128 v29, v[220:223] offset:1024
  v_mfma_f32_16x16x32_bf16 v[240:243], a[204:207], v[124:127], v[240:243]
  v_mfma_f32_16x16x32_bf16 v[244:247], a[208:211], v[124:127], v[244:247]
  v_mfma_f32_16x16x32_bf16 v[248:251], a[212:215], v[124:127], v[248:251]
  ds_write_b128 v29, v[224:227] offset:2048
  v_mfma_f32_16x16x32_bf16 v[252:255], a[216:219], v[124:127], v[252:255]
  buffer_load_dwordx4 v[168:171], v19, s[36:39], s7 offen offset:2048 sc1
  s_waitcnt vmcnt(12)
  v_mfma_f32_16x16x32_bf16 v[236:239], a[220:223], v[140:143], v[236:239]
  v_mfma_f32_16x16x32_bf16 v[240:243], a[224:227], v[140:143], v[240:243]
  ds_write_b128 v29, v[228:231] offset:3072
  v_mfma_f32_16x16x32_bf16 v[244:247], a[228:231], v[140:143], v[244:247]
  v_mfma_f32_16x16x32_bf16 v[248:251], a[232:235], v[140:143], v[248:251]
  buffer_load_dwordx4 v[120:123], v16, s[36:39], s7 offen offset:3072 sc1
  v_mfma_f32_16x16x32_bf16 v[252:255], a[236:239], v[140:143], v[252:255]
  ds_write_b128 v29, v[232:235] offset:4096
  v_mfma_f32_16x16x32_bf16 v[176:179], a[180:183], v[160:163], v[176:179]
  v_mfma_f32_16x16x32_bf16 v[180:183], a[184:187], v[160:163], v[180:183]
  v_mfma_f32_16x16x32_bf16 v[184:187], a[188:191], v[160:163], v[184:187]
  buffer_load_dwordx4 v[136:139], v17, s[36:39], s7 offen offset:3072 sc1
  ds_write_b128 v30, v[236:239] offset:0
  v_mfma_f32_16x16x32_bf16 v[188:191], a[192:195], v[160:163], v[188:191]
  v_mfma_f32_16x16x32_bf16 v[192:195], a[196:199], v[160:163], v[192:195]
  v_mfma_f32_16x16x32_bf16 v[176:179], a[200:203], v[112:115], v[176:179]
  ds_write_b128 v30, v[240:243] offset:1024
  v_mfma_f32_16x16x32_bf16 v[180:183], a[204:207], v[112:115], v[180:183]
  buffer_load_dwordx4 v[172:175], v18, s[36:39], s7 offen offset:3072 sc1
  v_mfma_f32_16x16x32_bf16 v[184:187], a[208:211], v[112:115], v[184:187]
  v_mfma_f32_16x16x32_bf16 v[188:191], a[212:215], v[112:115], v[188:191]
  ds_write_b128 v30, v[244:247] offset:2048
  v_mfma_f32_16x16x32_bf16 v[192:195], a[216:219], v[112:115], v[192:195]
  v_mfma_f32_16x16x32_bf16 v[176:179], a[220:223], v[128:131], v[176:179]
  buffer_load_dwordx4 v[124:127], v19, s[36:39], s7 offen offset:3072 sc1
  v_mfma_f32_16x16x32_bf16 v[180:183], a[224:227], v[128:131], v[180:183]
  ds_write_b128 v30, v[248:251] offset:3072
  v_mfma_f32_16x16x32_bf16 v[184:187], a[228:231], v[128:131], v[184:187]
  v_mfma_f32_16x16x32_bf16 v[188:191], a[232:235], v[128:131], v[188:191]
  v_mfma_f32_16x16x32_bf16 v[192:195], a[236:239], v[128:131], v[192:195]
  buffer_load_dwordx4 v[140:143], v16, s[36:39], s19 offen offset:0 sc1
  ds_write_b128 v30, v[252:255] offset:4096
  s_mov_b32 s68, 0x3f317218
  s_mov_b32 s69, 0x3f317218
  s_waitcnt vmcnt(16)
  v_mfma_f32_16x16x32_bf16 v[176:179], a[0:3], v[64:67], v[176:179]
  v_mfma_f32_16x16x32_bf16 v[180:183], a[4:7], v[64:67], v[180:183]
  v_mfma_f32_16x16x32_bf16 v[184:187], a[8:11], v[64:67], v[184:187]
  s_waitcnt lgkmcnt(0)
  s_barrier
  ds_read_b128 v[196:199], v31 offset:0
  v_mfma_f32_16x16x32_bf16 v[188:191], a[12:15], v[64:67], v[188:191]
  buffer_load_dwordx4 v[160:163], v17, s[36:39], s19 offen offset:0 sc1
  ds_read_b128 v[200:203], v31 offset:5120
  v_mfma_f32_16x16x32_bf16 v[192:195], a[16:19], v[64:67], v[192:195]
  ds_read_b128 v[204:207], v31 offset:10240
  s_waitcnt vmcnt(16)
  v_mfma_f32_16x16x32_bf16 v[176:179], a[20:23], v[68:71], v[176:179]
  ds_read_b128 v[208:211], v31 offset:1024
  v_mfma_f32_16x16x32_bf16 v[180:183], a[24:27], v[68:71], v[180:183]
  ds_read_b128 v[212:215], v31 offset:6144
  v_mfma_f32_16x16x32_bf16 v[184:187], a[28:31], v[68:71], v[184:187]
  buffer_load_dwordx4 v[112:115], v18, s[36:39], s19 offen offset:0 sc1
  ds_read_b128 v[216:219], v31 offset:11264
  v_mfma_f32_16x16x32_bf16 v[188:191], a[32:35], v[68:71], v[188:191]
  ds_read_b128 v[220:223], v31 offset:2048
  v_mfma_f32_16x16x32_bf16 v[192:195], a[36:39], v[68:71], v[192:195]
  ds_read_b128 v[224:227], v31 offset:7168
  s_waitcnt vmcnt(16)
  v_mfma_f32_16x16x32_bf16 v[176:179], a[40:43], v[72:75], v[176:179]
  ds_read_b128 v[228:231], v31 offset:12288
  v_mfma_f32_16x16x32_bf16 v[180:183], a[44:47], v[72:75], v[180:183]
  buffer_load_dwordx4 v[128:131], v19, s[36:39], s19 offen offset:0 sc1
  ds_read_b128 v[232:235], v31 offset:3072
  v_mfma_f32_16x16x32_bf16 v[184:187], a[48:51], v[72:75], v[184:187]
  ds_read_b128 v[236:239], v31 offset:8192
  v_mfma_f32_16x16x32_bf16 v[188:191], a[52:55], v[72:75], v[188:191]
  ds_read_b128 v[240:243], v31 offset:13312
  v_mfma_f32_16x16x32_bf16 v[192:195], a[56:59], v[72:75], v[192:195]
  ds_read_b128 v[244:247], v31 offset:4096
  s_waitcnt lgkmcnt(11)
  v_add_f32 v196, v196, v200
  s_waitcnt vmcnt(16)
  v_mfma_f32_16x16x32_bf16 v[176:179], a[60:63], v[76:79], v[176:179]
  ds_read_b128 v[248:251], v31 offset:9216
  v_add_f32 v197, v197, v201
  v_mfma_f32_16x16x32_bf16 v[180:183], a[64:67], v[76:79], v[180:183]
  ds_read_b128 v[252:255], v31 offset:14336
  v_add_f32 v198, v198, v202
  v_mfma_f32_16x16x32_bf16 v[184:187], a[68:71], v[76:79], v[184:187]
  ds_read_b128 a[180:183], v37 offset:0
  v_add_f32 v199, v199, v203
  v_mfma_f32_16x16x32_bf16 v[188:191], a[72:75], v[76:79], v[188:191]
  s_waitcnt lgkmcnt(13)
  v_add_f32 v196, v196, v204
  v_mfma_f32_16x16x32_bf16 v[192:195], a[76:79], v[76:79], v[192:195]
  ds_read_b128 a[184:187], v37 offset:1024
  v_add_f32 v197, v197, v205
  s_waitcnt vmcnt(15)
  v_mfma_f32_16x16x32_bf16 v[176:179], a[80:83], v[144:147], v[176:179]
  v_add_f32 v198, v198, v206
  v_mfma_f32_16x16x32_bf16 v[180:183], a[84:87], v[144:147], v[180:183]
  ds_read_b128 a[188:191], v37 offset:2048
  v_add_f32 v199, v199, v207
  v_mfma_f32_16x16x32_bf16 v[184:187], a[88:91], v[144:147], v[184:187]
  v_fma_f32 v200, v196, s68, v88
  v_mfma_f32_16x16x32_bf16 v[188:191], a[92:95], v[144:147], v[188:191]
  ds_read_b128 a[192:195], v37 offset:3072
  v_fma_f32 v201, v197, s68, v32
  v_mfma_f32_16x16x32_bf16 v[192:195], a[96:99], v[144:147], v[192:195]
  ds_read_b128 a[196:199], v37 offset:4096
  v_fma_f32 v202, v198, s68, v89
  s_waitcnt vmcnt(14)
  v_mfma_f32_16x16x32_bf16 v[176:179], a[100:103], v[148:151], v[176:179]
  v_fma_f32 v203, v199, s68, v33
  v_mfma_f32_16x16x32_bf16 v[180:183], a[104:107], v[148:151], v[180:183]
  ds_read_b128 a[200:203], v37 offset:5120
  s_waitcnt lgkmcnt(15)
  v_add_f32 v208, v208, v212
  v_mfma_f32_16x16x32_bf16 v[184:187], a[108:111], v[148:151], v[184:187]
  v_add_f32 v209, v209, v213
  v_mfma_f32_16x16x32_bf16 v[188:191], a[112:115], v[148:151], v[188:191]
  ds_read_b128 a[204:207], v37 offset:6144
  v_add_f32 v210, v210, v214
  v_mfma_f32_16x16x32_bf16 v[192:195], a[116:119], v[148:151], v[192:195]
  ds_read_b128 a[208:211], v37 offset:7168
  v_add_f32 v211, v211, v215
  s_waitcnt vmcnt(13)
  v_mfma_f32_16x16x32_bf16 v[176:179], a[120:123], v[152:155], v[176:179]
  v_add_f32 v208, v208, v216
  v_mfma_f32_16x16x32_bf16 v[180:183], a[124:127], v[152:155], v[180:183]
  ds_read_b128 a[212:215], v37 offset:8192
  v_add_f32 v209, v209, v217
  v_mfma_f32_16x16x32_bf16 v[184:187], a[128:131], v[152:155], v[184:187]
  v_add_f32 v210, v210, v218
  v_mfma_f32_16x16x32_bf16 v[188:191], a[132:135], v[152:155], v[188:191]
  ds_read_b128 a[216:219], v37 offset:9216
  v_add_f32 v211, v211, v219
  v_mfma_f32_16x16x32_bf16 v[192:195], a[136:139], v[152:155], v[192:195]
  ds_read_b128 a[220:223], v37 offset:10240
  v_fma_f32 v212, v208, s68, v90
  s_waitcnt vmcnt(12)
  v_mfma_f32_16x16x32_bf16 v[176:179], a[140:143], v[156:159], v[176:179]
  v_fma_f32 v213, v209, s68, v34
  v_mfma_f32_16x16x32_bf16 v[180:183], a[144:147], v[156:159], v[180:183]
  ds_read_b128 a[224:227], v37 offset:11264
  v_fma_f32 v214, v210, s68, v91
  v_mfma_f32_16x16x32_bf16 v[184:187], a[148:151], v[156:159], v[184:187]
  v_fma_f32 v215, v211, s68, v35
  v_mfma_f32_16x16x32_bf16 v[188:191], a[152:155], v[156:159], v[188:191]
  ds_read_b128 a[228:231], v37 offset:12288
  s_waitcnt lgkmcnt(15)
  v_add_f32 v220, v220, v224
  v_mfma_f32_16x16x32_bf16 v[192:195], a[156:159], v[156:159], v[192:195]
  ds_read_b128 a[232:235], v37 offset:13312
  v_add_f32 v221, v221, v225
  s_waitcnt vmcnt(11)
  v_mfma_f32_16x16x32_bf16 v[176:179], a[160:163], v[164:167], v[176:179]
  v_add_f32 v222, v222, v226
  v_mfma_f32_16x16x32_bf16 v[180:183], a[164:167], v[164:167], v[180:183]
  ds_read_b128 a[236:239], v37 offset:14336
  v_add_f32 v223, v223, v227
  v_mfma_f32_16x16x32_bf16 v[184:187], a[168:171], v[164:167], v[184:187]
  v_add_f32 v220, v220, v228
  v_mfma_f32_16x16x32_bf16 v[188:191], a[172:175], v[164:167], v[188:191]
  ds_read_b128 a[0:3], v37 offset:15360
  v_add_f32 v221, v221, v229
  v_mfma_f32_16x16x32_bf16 v[192:195], a[176:179], v[164:167], v[192:195]
  ds_read_b128 a[4:7], v37 offset:16384
  v_add_f32 v222, v222, v230
  s_waitcnt vmcnt(10)
  v_mfma_f32_16x16x32_bf16 v[176:179], a[240:243], v[116:119], v[176:179]
  v_add_f32 v223, v223, v231
  v_mfma_f32_16x16x32_bf16 v[180:183], a[244:247], v[116:119], v[180:183]
  ds_read_b128 a[8:11], v37 offset:17408
  v_fma_f32 v224, v220, s68, v92
  v_mfma_f32_16x16x32_bf16 v[184:187], a[248:251], v[116:119], v[184:187]
  v_fma_f32 v225, v221, s68, v20
  v_mfma_f32_16x16x32_bf16 v[188:191], a[252:255], v[116:119], v[188:191]
  ds_read_b128 a[12:15], v37 offset:18432
  v_fma_f32 v226, v222, s68, v93
  v_mfma_f32_16x16x32_bf16 v[192:195], v[100:103], v[116:119], v[192:195]
  ds_read_b128 a[16:19], v37 offset:19456
  v_fma_f32 v227, v223, s68, v21
  s_waitcnt vmcnt(9)
  v_mfma_f32_16x16x32_bf16 v[176:179], v[104:107], v[132:135], v[176:179]
  v_add_f32 v232, v232, v236
  v_mfma_f32_16x16x32_bf16 v[180:183], v[108:111], v[132:135], v[180:183]
  ds_read_b128 a[20:23], v37 offset:20480
  v_add_f32 v233, v233, v237
  v_mfma_f32_16x16x32_bf16 v[184:187], v[40:43], v[132:135], v[184:187]
  v_add_f32 v234, v234, v238
  v_mfma_f32_16x16x32_bf16 v[188:191], v[80:83], v[132:135], v[188:191]
  ds_read_b128 a[24:27], v37 offset:21504
  v_add_f32 v235, v235, v239
  v_mfma_f32_16x16x32_bf16 v[192:195], v[84:87], v[132:135], v[192:195]
  ds_read_b128 a[28:31], v37 offset:22528
  v_add_f32 v232, v232, v240
  s_waitcnt vmcnt(8)
  v_mfma_f32_16x16x32_bf16 v[176:179], v[44:47], v[168:171], v[176:179]
  v_add_f32 v233, v233, v241
  v_mfma_f32_16x16x32_bf16 v[180:183], v[48:51], v[168:171], v[180:183]
  ds_read_b128 a[32:35], v37 offset:23552
  v_add_f32 v234, v234, v242
  v_mfma_f32_16x16x32_bf16 v[184:187], v[52:55], v[168:171], v[184:187]
  v_add_f32 v235, v235, v243
  v_mfma_f32_16x16x32_bf16 v[188:191], v[56:59], v[168:171], v[188:191]
  ds_read_b128 a[36:39], v37 offset:24576
  v_fma_f32 v236, v232, s68, v94
  v_mfma_f32_16x16x32_bf16 v[192:195], v[60:63], v[168:171], v[192:195]
  ds_read_b128 a[40:43], v37 offset:25600
  v_fma_f32 v237, v233, s68, v22
  s_waitcnt vmcnt(7) lgkmcnt(15)
  v_mfma_f32_16x16x32_bf16 v[176:179], a[180:183], v[120:123], v[176:179]
  v_fma_f32 v238, v234, s68, v95
  v_mfma_f32_16x16x32_bf16 v[180:183], a[184:187], v[120:123], v[180:183]
  ds_read_b128 a[44:47], v37 offset:26624
  v_fma_f32 v239, v235, s68, v23
  v_mfma_f32_16x16x32_bf16 v[184:187], a[188:191], v[120:123], v[184:187]
  v_add_f32 v244, v244, v248
  v_mfma_f32_16x16x32_bf16 v[188:191], a[192:195], v[120:123], v[188:191]
  ds_read_b128 a[48:51], v37 offset:27648
  v_add_f32 v245, v245, v249
  v_mfma_f32_16x16x32_bf16 v[192:195], a[196:199], v[120:123], v[192:195]
  ds_read_b128 a[52:55], v37 offset:28672
  v_add_f32 v246, v246, v250
  s_waitcnt vmcnt(6)
  v_mfma_f32_16x16x32_bf16 v[176:179], a[200:203], v[136:139], v[176:179]
  v_add_f32 v247, v247, v251
  v_mfma_f32_16x16x32_bf16 v[180:183], a[204:207], v[136:139], v[180:183]
  ds_read_b128 a[56:59], v37 offset:29696
  v_add_f32 v244, v244, v252
  v_mfma_f32_16x16x32_bf16 v[184:187], a[208:211], v[136:139], v[184:187]
  v_add_f32 v245, v245, v253
  v_mfma_f32_16x16x32_bf16 v[188:191], a[212:215], v[136:139], v[188:191]
  ds_read_b128 a[60:63], v37 offset:30720
  v_add_f32 v246, v246, v254
  v_mfma_f32_16x16x32_bf16 v[192:195], a[216:219], v[136:139], v[192:195]
  ds_read_b128 a[64:67], v37 offset:31744
  v_add_f32 v247, v247, v255
  s_waitcnt vmcnt(5)
  v_mfma_f32_16x16x32_bf16 v[176:179], a[220:223], v[172:175], v[176:179]
  v_fma_f32 v248, v244, s68, v96
  s_waitcnt lgkmcnt(15)
  v_mfma_f32_16x16x32_bf16 v[180:183], a[224:227], v[172:175], v[180:183]
  ds_read_b128 a[68:71], v37 offset:32768
  v_fma_f32 v249, v245, s68, v98
  v_mfma_f32_16x16x32_bf16 v[184:187], a[228:231], v[172:175], v[184:187]
  v_fma_f32 v250, v246, s68, v97
  v_mfma_f32_16x16x32_bf16 v[188:191], a[232:235], v[172:175], v[188:191]
  ds_read_b128 a[72:75], v37 offset:33792
  v_fma_f32 v251, v247, s68, v99
  v_mfma_f32_16x16x32_bf16 v[192:195], a[236:239], v[172:175], v[192:195]
  ds_read_b128 a[76:79], v37 offset:34816
  s_waitcnt vmcnt(4)
  v_mfma_f32_16x16x32_bf16 v[176:179], a[0:3], v[124:127], v[176:179]
  v_mfma_f32_16x16x32_bf16 v[180:183], a[4:7], v[124:127], v[180:183]
  ds_read_b128 a[80:83], v37 offset:35840
  s_waitcnt lgkmcnt(15)
  v_mfma_f32_16x16x32_bf16 v[184:187], a[8:11], v[124:127], v[184:187]
  v_mfma_f32_16x16x32_bf16 v[188:191], a[12:15], v[124:127], v[188:191]
  ds_read_b128 a[84:87], v37 offset:36864
  v_mfma_f32_16x16x32_bf16 v[192:195], a[16:19], v[124:127], v[192:195]
  ds_read_b128 a[88:91], v37 offset:37888
  s_waitcnt vmcnt(3)
  v_mfma_f32_16x16x32_bf16 v[176:179], a[20:23], v[140:143], v[176:179]
  s_waitcnt lgkmcnt(15)
  v_mfma_f32_16x16x32_bf16 v[180:183], a[24:27], v[140:143], v[180:183]
  ds_read_b128 a[92:95], v37 offset:38912
  v_mfma_f32_16x16x32_bf16 v[184:187], a[28:31], v[140:143], v[184:187]
  s_waitcnt lgkmcnt(15)
  v_mfma_f32_16x16x32_bf16 v[188:191], a[32:35], v[140:143], v[188:191]
  ds_read_b128 a[96:99], v37 offset:39936
  s_waitcnt lgkmcnt(15)
  v_mfma_f32_16x16x32_bf16 v[192:195], a[36:39], v[140:143], v[192:195]
  s_waitcnt vmcnt(2) lgkmcnt(14)
  v_mfma_f32_16x16x32_bf16 v[176:179], a[40:43], v[160:163], v[176:179]
  s_waitcnt lgkmcnt(13)
  v_mfma_f32_16x16x32_bf16 v[180:183], a[44:47], v[160:163], v[180:183]
  s_waitcnt lgkmcnt(12)
  v_mfma_f32_16x16x32_bf16 v[184:187], a[48:51], v[160:163], v[184:187]
  s_waitcnt lgkmcnt(11)
  v_mfma_f32_16x16x32_bf16 v[188:191], a[52:55], v[160:163], v[188:191]
  s_waitcnt lgkmcnt(10)
  v_mfma_f32_16x16x32_bf16 v[192:195], a[56:59], v[160:163], v[192:195]
  s_waitcnt vmcnt(1) lgkmcnt(9)
  v_mfma_f32_16x16x32_bf16 v[176:179], a[60:63], v[112:115], v[176:179]
  s_waitcnt lgkmcnt(8)
  v_mfma_f32_16x16x32_bf16 v[180:183], a[64:67], v[112:115], v[180:183]
  s_waitcnt lgkmcnt(7)
  v_mfma_f32_16x16x32_bf16 v[184:187], a[68:71], v[112:115], v[184:187]
  s_waitcnt lgkmcnt(6)
  v_mfma_f32_16x16x32_bf16 v[188:191], a[72:75], v[112:115], v[188:191]
  s_waitcnt lgkmcnt(5)
  v_mfma_f32_16x16x32_bf16 v[192:195], a[76:79], v[112:115], v[192:195]
  s_waitcnt vmcnt(0) lgkmcnt(4)
  v_mfma_f32_16x16x32_bf16 v[176:179], a[80:83], v[128:131], v[176:179]
  s_waitcnt lgkmcnt(3)
  v_mfma_f32_16x16x32_bf16 v[180:183], a[84:87], v[128:131], v[180:183]
  s_waitcnt lgkmcnt(2)
  v_mfma_f32_16x16x32_bf16 v[184:187], a[88:91], v[128:131], v[184:187]
  s_waitcnt lgkmcnt(1)
  v_mfma_f32_16x16x32_bf16 v[188:191], a[92:95], v[128:131], v[188:191]
  s_waitcnt lgkmcnt(0)
  v_mfma_f32_16x16x32_bf16 v[192:195], a[96:99], v[128:131], v[192:195]
  v_pk_fma_f32 v[176:177], v[176:177], s[68:69], v[200:201]
  v_pk_fma_f32 v[178:179], v[178:179], s[68:69], v[202:203]
  v_cvt_pk_bf16_f32 v64, v176, v177
  v_cvt_pk_bf16_f32 v65, v178, v179
  v_pk_fma_f32 v[180:181], v[180:181], s[68:69], v[212:213]
  v_pk_fma_f32 v[182:183], v[182:183], s[68:69], v[214:215]
  v_cvt_pk_bf16_f32 v66, v180, v181
  v_cvt_pk_bf16_f32 v67, v182, v183
  buffer_store_dwordx4 v[64:67], v26, s[48:51], s65 offen
  v_pk_fma_f32 v[184:185], v[184:185], s[68:69], v[224:225]
  v_pk_fma_f32 v[186:187], v[186:187], s[68:69], v[226:227]
  v_cvt_pk_bf16_f32 v68, v184, v185
  v_cvt_pk_bf16_f32 v69, v186, v187
  v_pk_fma_f32 v[188:189], v[188:189], s[68:69], v[236:237]
  v_pk_fma_f32 v[190:191], v[190:191], s[68:69], v[238:239]
  v_cvt_pk_bf16_f32 v70, v188, v189
  v_cvt_pk_bf16_f32 v71, v190, v191
  buffer_store_dwordx4 v[68:71], v26, s[48:51], s65 offen offset:64
  v_pk_fma_f32 v[192:193], v[192:193], s[68:69], v[248:249]
  v_pk_fma_f32 v[194:195], v[194:195], s[68:69], v[250:251]
  v_cvt_pk_bf16_f32 v72, v192, v193
  v_cvt_pk_bf16_f32 v73, v194, v195
  buffer_store_dwordx2 v[72:73], v27, s[48:51], s65 offen offset:128
  s_add_u32 s18, s64, 16
  v_mov_b32 v1, s18
  s_cmp_eq_u32 s2, 0
  s_cselect_b32 s19, 0, 0x40000000
  v_subrev_u32 v2, 4096, v9
  buffer_store_dword v1, v2, s[36:39], s19 offen sc1
  s_endpgm
f_spin1:
  s_mov_b32 s19, 0
f_loop1:
  buffer_load_dword v10, v11, s[36:39], 0 offen sc1
  s_add_u32 s19, s19, 1
  s_cmp_gt_u32 s19, 0x8000
  s_cbranch_scc1 f_back1
  s_waitcnt vmcnt(0)
  v_subrev_u32 v14, s18, v10
  v_cmp_gt_u32_e64 s[100:101], 8, v14
  s_nop 0
  s_cmp_eq_u64 s[100:101], -1
  s_cbranch_scc0 f_loop1
  s_branch f_back1
f_spin2:
  s_mov_b32 s19, 0
f_loop2:
  buffer_load_dword v10, v11, s[36:39], 0 offen sc1
  s_add_u32 s19, s19, 1
  s_cmp_gt_u32 s19, 0x8000
  s_cbranch_scc1 f_back2
  s_waitcnt vmcnt(0)
  v_subrev_u32 v14, s18, v10
  v_cmp_gt_u32_e64 s[100:101], 8, v14
  s_nop 0
  s_cmp_eq_u64 s[100:101], -1
  s_cbranch_scc0 f_loop2
  s_branch f_back2
f_spin3:
  s_mov_b32 s19, 0
f_loop3:
  buffer_load_dword v10, v11, s[36:39], 0 offen sc1
  s_add_u32 s19, s19, 1
  s_cmp_gt_u32 s19, 0x8000
  s_cbranch_scc1 f_back3
  s_waitcnt vmcnt(0)
  v_subrev_u32 v14, s18, v10
  v_cmp_gt_u32_e64 s[100:101], 8, v14
  s_nop 0
  s_cmp_eq_u64 s[100:101], -1
  s_cbranch_scc0 f_loop3
  s_branch f_back3
f_spin4:
  s_mov_b32 s19, 0
f_loop4:
  buffer_load_dword v10, v11, s[36:39], 0 offen sc1
  s_add_u32 s19, s19, 1
  s_cmp_gt_u32 s19, 0x8000
  s_cbranch_scc1 f_back4
  s_waitcnt vmcnt(0)
  v_subrev_u32 v14, s18, v10
  v_cmp_gt_u32_e64 s[100:101], 8, v14
  s_nop 0
  s_cmp_eq_u64 s[100:101], -1
  s_cbranch_scc0 f_loop4
  s_branch f_back4
f_spin5:
  s_mov_b32 s19, 0
f_loop5:
  buffer_load_dword v10, v11, s[36:39], 0 offen sc1
  s_add_u32 s19, s19, 1
  s_cmp_gt_u32 s19, 0x8000
  s_cbranch_scc1 f_back5
  s_waitcnt vmcnt(0)
  v_subrev_u32 v14, s18, v10
  v_cmp_gt_u32_e64 s[100:101], 8, v14
  s_nop 0
  s_cmp_eq_u64 s[100:101], -1
  s_cbranch_scc0 f_loop5
  s_branch f_back5
f_spin6:
  s_mov_b32 s19, 0
f_loop6:
  buffer_load_dword v10, v11, s[36:39], 0 offen sc1
  s_add_u32 s19, s19, 1
  s_cmp_gt_u32 s19, 0x8000
  s_cbranch_scc1 f_back6
  s_waitcnt vmcnt(0)
  v_subrev_u32 v14, s18, v10
  v_cmp_gt_u32_e64 s[100:101], 8, v14
  s_nop 0
  s_cmp_eq_u64 s[100:101], -1
  s_cbranch_scc0 f_loop6
  s_branch f_back6
f_spin7:
  s_mov_b32 s19, 0
f_loop7:
  buffer_load_dword v10, v11, s[36:39], 0 offen sc1
  s_add_u32 s19, s19, 1
  s_cmp_gt_u32 s19, 0x8000
  s_cbranch_scc1 f_back7
  s_waitcnt vmcnt(0)
  v_subrev_u32 v14, s18, v10
  v_cmp_gt_u32_e64 s[100:101], 8, v14
  s_nop 0
  s_cmp_eq_u64 s[100:101], -1
  s_cbranch_scc0 f_loop7
  s_branch f_back7
f_end:
  s_endpgm
.section .rodata,"a"
.p2align 6
.amdhsa_kernel parallel_sum__linear_kernel_hedgehog__dense_activation_mish__prompt_kernel
  .amdhsa_next_free_vgpr 512
  .amdhsa_next_free_sgpr 102
  .amdhsa_accum_offset 256
  .amdhsa_group_segment_fixed_size 0
  .amdhsa_kernarg_size 88
  .amdhsa_user_sgpr_count 2
  .amdhsa_user_sgpr_kernarg_segment_ptr 1
  .amdhsa_system_sgpr_workgroup_id_x 1
.end_amdhsa_kernel
```
